```python
import torch

def _softmax(x, axis=-1):
    return torch.softmax(x, dim=axis)
def _gelu(x):
    return torch.nn.functional.gelu(x, approximate="tanh")
def _silu(x):
    return torch.nn.functional.silu(x)
def _sigmoid(x):
    return torch.sigmoid(x)
def _layernorm(x, axis=-1, eps=1e-5):
    m = x.mean(dim=axis, keepdim=True)
    v = x.var(dim=axis, keepdim=True, unbiased=False)
    return (x - m) / torch.sqrt(v + eps)
def _scatter_add(tgt, idx, src, axis=0):
    return tgt.clone().index_add_(axis, idx, src)
def _segment_sum(src, seg, n):
    out = torch.zeros((n,) + src.shape[1:], dtype=src.dtype)
    return out.index_add_(0, seg, src)
def _pad(x, pw):
    flat = tuple(v for pair in reversed(pw) for v in pair)
    return torch.nn.functional.pad(x, flat)

kernel_name = 'interleave_layers__linear_kernel_hedgehog__dense_activation_gelu__prompt'

def setup_inputs():

    _w = (lambda a: (lambda t: t.to(torch.bfloat16) if t.is_floating_point() else t)(torch.as_tensor(a)))
    def _A_setup():
        B, S, D, H = 1, 2048, 448, 16
        Dh = D // H
        return {
            "x": _w((lambda *s: torch.randn(*s, dtype=torch.bfloat16) * 0.05)(B, S, D)),
            "wqkv": _w((lambda *s: torch.randn(*s, dtype=torch.bfloat16) * 0.4)(D, 3 * D)),
            "w_phi": _w((lambda *s: torch.randn(*s, dtype=torch.bfloat16) * 0.4)(H, Dh, Dh) * (Dh ** -0.5)),
            "wo": _w((lambda *s: torch.randn(*s, dtype=torch.bfloat16) * 0.05)(D, D)),
        }
    _A_in = _A_setup()

    def _B_setup():
        B, S, D, F = 1, 2048, 448, 1792
        return {
            "x": _w((lambda *s: torch.randn(*s, dtype=torch.bfloat16) * 0.05)(B, S, D)),
            "w1": _w((lambda *s: torch.randn(*s, dtype=torch.bfloat16) * 1.6)(D, F) * (D ** -0.5)),
            "b1": _w((lambda *s: torch.randn(*s, dtype=torch.bfloat16) * 1.6)(F) * 0.01),
            "w2": _w((lambda *s: torch.randn(*s, dtype=torch.bfloat16) * 1.6)(F, D) * (F ** -0.5)),
            "b2": _w((lambda *s: torch.randn(*s, dtype=torch.bfloat16) * 1.6)(D) * 0.01),
        }
    _B_in = _B_setup()

    return {
        "A_x": _A_in["x"],
        "A_wqkv": _A_in["wqkv"],
        "A_w_phi": _A_in["w_phi"],
        "A_wo": _A_in["wo"],
        "B_x": _B_in["x"],
        "B_w1": _B_in["w1"],
        "B_b1": _B_in["b1"],
        "B_w2": _B_in["w2"],
        "B_b2": _B_in["b2"],
    }

def reference(A_x, A_wqkv, A_w_phi, A_wo, B_x, B_w1, B_b1, B_w2, B_b2):
    def _A_ref(x, wqkv, w_phi, wo):
        B, S, D = x.shape
        H = 16; Dh = D // H
        qkv = (lambda x, *d: x.permute(*d))((x @ wqkv).reshape(B, S, 3, H, Dh), 2, 0, 3, 1, 4)
        q, k, v = qkv[0], qkv[1], qkv[2]
        pq = torch.einsum("bhsd,hdf->bhsf", q, w_phi)
        pk = torch.einsum("bhsd,hdf->bhsf", k, w_phi)
        phi_q = torch.concatenate([_softmax(pq, axis=-1), _softmax(-pq, axis=-1)], axis=-1)
        phi_k = torch.concatenate([_softmax(pk, axis=-1), _softmax(-pk, axis=-1)], axis=-1)
        kv = torch.einsum("bhsf,bhsd->bhfd", phi_k, v)
        z  = torch.einsum("bhsf->bhf", phi_k)
        num = torch.einsum("bhqf,bhfd->bhqd", phi_q, kv)
        den = torch.einsum("bhqf,bhf->bhq", phi_q, z)[..., None] + 1e-6
        o = num / den
        return (lambda x, *d: x.permute(*d))(o, 0, 2, 1, 3).reshape(B, S, D) @ wo

    def _B_ref(x, w1, b1, w2, b2):
        h = torch.einsum("bsd,df->bsf", x, w1) + b1
        h = _gelu(h)
        return torch.einsum("bsf,fd->bsd", h, w2) + b2

    x = A_x
    x = x + _A_ref(_layernorm(x, axis=-1), A_wqkv, A_w_phi, A_wo)
    x = x + _B_ref(_layernorm(x, axis=-1), B_w1, B_b1, B_w2, B_b2)
    x = x + _A_ref(_layernorm(x, axis=-1), A_wqkv, A_w_phi, A_wo)
    x = x + _B_ref(_layernorm(x, axis=-1), B_w1, B_b1, B_w2, B_b2)
    return x
```

```asm
; @launch kernel=fused_kernel grid=(256,1,1) block=(256,1,1) lds=163840
.amdgcn_target "amdgcn-amd-amdhsa--gfx950"
.text
.globl fused_kernel
.p2align 8
.type fused_kernel,@function
fused_kernel:
    s_cmp_ge_u32 s2, 256
    s_cbranch_scc1 fused_kernel_end
    s_load_dwordx16 s[16:31], s[0:1], 0
    s_load_dwordx8 s[32:39], s[0:1], 64
    v_and_b32 v1, 63, v0
    v_lshrrev_b32 v2, 6, v0
    v_and_b32 v3, 31, v0
    v_readfirstlane_b32 s3, v2
    v_lshrrev_b32 v4, 5, v1
    s_waitcnt lgkmcnt(0)
    s_add_u32 s72, s38, 0x1100000
    s_addc_u32 s73, s39, 0
    s_and_b32 s73, s73, 0xffff
    s_mov_b32 s74, 0x8000
    s_mov_b32 s75, 0x20000
    s_mov_b32 s76, s36
    s_mov_b32 s77, s37
    s_and_b32 s77, s77, 0xffff
    s_mov_b32 s78, 0x100
    s_mov_b32 s79, 0x20000
    s_mov_b32 s56, s38
    s_mov_b32 s57, s39
    s_and_b32 s57, s57, 0xffff
    s_mov_b32 s58, 0x4000000
    s_mov_b32 s59, 0x20000
    v_lshlrev_b32 v9, 4, v1
    s_cmp_eq_u32 s2, 0
    s_cbranch_scc0 k0_nn
    s_cmp_eq_u32 s3, 0
    s_cbranch_scc0 k0_nn
    s_memrealtime s[60:61]
    s_waitcnt lgkmcnt(0)
    s_or_b32 s60, s60, 1
    v_mov_b32 v5, s60
    v_mov_b32 v6, 0
    buffer_store_dword v5, v6, s[76:79], 0 offen sc1
k0_nn:
    v_mov_b32 v32, 0
    v_mov_b32 v33, 0
    v_mov_b32 v34, 0
    v_mov_b32 v35, 0
    s_cmp_lt_u32 s2, 48
    s_cbranch_scc0 k0_nz
    s_mul_hi_u32 s8, s2, 0x55555556
    s_mul_i32 s10, s8, 3
    s_sub_u32 s10, s2, s10
    s_cmp_eq_u32 s10, 2
    s_cbranch_scc1 k0_nz
    s_lshl_b32 s8, s8, 13
    s_lshl_b32 s10, s10, 17
    s_add_u32 s8, s8, s10
    s_lshl_b32 s10, s3, 11
    s_add_u32 s8, s8, s10
    s_add_u32 s8, s8, 0x1000000
    buffer_store_dwordx4 v[32:35], v9, s[56:59], s8 offen sc1
    buffer_store_dwordx4 v[32:35], v9, s[56:59], s8 offen offset:1024 sc1
k0_nz:
    s_nop 1
    s_cmp_ge_u32 s2, 238
    s_cbranch_scc1 k0_end
    v_and_b32 v12, 15, v1
    v_lshrrev_b32 v13, 2, v12
    v_and_b32 v12, 3, v12
    v_lshlrev_b32 v12, 3, v12
    v_lshl_add_u32 v13, v4, 3, v13
    v_lshl_add_u32 v11, v13, 6, v12
    v_bfe_u32 v12, v1, 4, 1
    v_lshl_add_u32 v11, v12, 5, v11
    v_mov_b32 v19, 0x3f803f80
    s_cmp_ge_u32 s2, 174
    s_cbranch_scc1 k0_x
    s_cmp_ge_u32 s2, 118
    s_cbranch_scc1 k0_w2
    s_cmp_ge_u32 s2, 104
    s_cbranch_scc1 k0_wo
    s_cmp_ge_u32 s2, 48
    s_cbranch_scc1 k0_w1
k0_qkv:
    s_mov_b32 s44, s18
    s_mov_b32 s45, s19
    s_and_b32 s45, s45, 0xffff
    s_mov_b32 s46, 0x126000
    s_mov_b32 s47, 0x20000
    s_mul_hi_u32 s4, s2, 0x55555556
    s_mul_i32 s5, s4, 3
    s_sub_u32 s5, s2, s5
    s_mul_i32 s8, s5, 896
    s_mul_i32 s6, s4, 56
    s_add_u32 s8, s8, s6
    s_mul_i32 s9, s2, 28672
    s_add_u32 s9, s9, 0x2200000
    s_lshl_b32 s10, s2, 7
    s_add_u32 s10, s10, 0x2900000
    v_lshrrev_b32 v8, 2, v1
    v_mul_u32_u24 v7, 2688, v8
    v_and_b32 v8, 3, v1
    v_lshl_add_u32 v7, v8, 4, v7
    s_mul_i32 s11, s3, 43008
    s_add_u32 s8, s8, s11
    s_lshl_b32 s12, s3, 10
    s_add_u32 s11, s8, 0
    s_add_u32 m0, s12, 0
    s_nop 0
    buffer_load_dwordx4 v7, s[44:47], s11 offen lds
    s_add_u32 s11, s8, 172032
    s_add_u32 m0, s12, 4096
    s_nop 0
    buffer_load_dwordx4 v7, s[44:47], s11 offen lds
    s_add_u32 s11, s8, 344064
    s_add_u32 m0, s12, 8192
    s_nop 0
    buffer_load_dwordx4 v7, s[44:47], s11 offen lds
    s_add_u32 s11, s8, 516096
    s_add_u32 m0, s12, 12288
    s_nop 0
    buffer_load_dwordx4 v7, s[44:47], s11 offen lds
    s_add_u32 s11, s8, 688128
    s_add_u32 m0, s12, 16384
    s_nop 0
    buffer_load_dwordx4 v7, s[44:47], s11 offen lds
    s_add_u32 s11, s8, 860160
    s_add_u32 m0, s12, 20480
    s_nop 0
    buffer_load_dwordx4 v7, s[44:47], s11 offen lds
    s_add_u32 s11, s8, 1032192
    s_add_u32 m0, s12, 24576
    s_nop 0
    buffer_load_dwordx4 v7, s[44:47], s11 offen lds
    v_mov_b32 v20, 0
    s_waitcnt vmcnt(0)
    s_barrier
    s_mul_i32 s11, s3, 7168
    v_add_u32 v12, s11, v11
    s_add_u32 s9, s9, s11
    ds_read_b64_tr_b16 v[32:33], v12 offset:0
    ds_read_b64_tr_b16 v[34:35], v12 offset:256
    ds_read_b64_tr_b16 v[36:37], v12 offset:1024
    ds_read_b64_tr_b16 v[38:39], v12 offset:1280
    ds_read_b64_tr_b16 v[40:41], v12 offset:2048
    ds_read_b64_tr_b16 v[42:43], v12 offset:2304
    ds_read_b64_tr_b16 v[44:45], v12 offset:3072
    ds_read_b64_tr_b16 v[46:47], v12 offset:3328
    ds_read_b64_tr_b16 v[48:49], v12 offset:4096
    ds_read_b64_tr_b16 v[50:51], v12 offset:4352
    ds_read_b64_tr_b16 v[52:53], v12 offset:5120
    ds_read_b64_tr_b16 v[54:55], v12 offset:5376
    ds_read_b64_tr_b16 v[56:57], v12 offset:6144
    ds_read_b64_tr_b16 v[58:59], v12 offset:6400
    s_waitcnt lgkmcnt(0)
    buffer_store_dwordx4 v[32:35], v9, s[56:59], s9 offen sc1
    s_add_u32 s9, s9, 1024
    buffer_store_dwordx4 v[36:39], v9, s[56:59], s9 offen sc1
    s_add_u32 s9, s9, 1024
    buffer_store_dwordx4 v[40:43], v9, s[56:59], s9 offen sc1
    s_add_u32 s9, s9, 1024
    buffer_store_dwordx4 v[44:47], v9, s[56:59], s9 offen sc1
    s_add_u32 s9, s9, 1024
    buffer_store_dwordx4 v[48:51], v9, s[56:59], s9 offen sc1
    s_add_u32 s9, s9, 1024
    buffer_store_dwordx4 v[52:55], v9, s[56:59], s9 offen sc1
    s_add_u32 s9, s9, 1024
    buffer_store_dwordx4 v[56:59], v9, s[56:59], s9 offen sc1
    s_add_u32 s9, s9, 1024
    v_dot2_f32_bf16 v20, v32, v19, v20
    v_dot2_f32_bf16 v20, v33, v19, v20
    v_dot2_f32_bf16 v20, v34, v19, v20
    v_dot2_f32_bf16 v20, v35, v19, v20
    v_dot2_f32_bf16 v20, v36, v19, v20
    v_dot2_f32_bf16 v20, v37, v19, v20
    v_dot2_f32_bf16 v20, v38, v19, v20
    v_dot2_f32_bf16 v20, v39, v19, v20
    v_dot2_f32_bf16 v20, v40, v19, v20
    v_dot2_f32_bf16 v20, v41, v19, v20
    v_dot2_f32_bf16 v20, v42, v19, v20
    v_dot2_f32_bf16 v20, v43, v19, v20
    v_dot2_f32_bf16 v20, v44, v19, v20
    v_dot2_f32_bf16 v20, v45, v19, v20
    v_dot2_f32_bf16 v20, v46, v19, v20
    v_dot2_f32_bf16 v20, v47, v19, v20
    v_dot2_f32_bf16 v20, v48, v19, v20
    v_dot2_f32_bf16 v20, v49, v19, v20
    v_dot2_f32_bf16 v20, v50, v19, v20
    v_dot2_f32_bf16 v20, v51, v19, v20
    v_dot2_f32_bf16 v20, v52, v19, v20
    v_dot2_f32_bf16 v20, v53, v19, v20
    v_dot2_f32_bf16 v20, v54, v19, v20
    v_dot2_f32_bf16 v20, v55, v19, v20
    v_dot2_f32_bf16 v20, v56, v19, v20
    v_dot2_f32_bf16 v20, v57, v19, v20
    v_dot2_f32_bf16 v20, v58, v19, v20
    v_dot2_f32_bf16 v20, v59, v19, v20
    s_nop 3
    v_mov_b32 v21, v20
    s_nop 1
    v_permlane32_swap_b32 v20, v21
    s_nop 0
    v_add_f32 v20, v20, v21
    v_lshlrev_b32 v12, 2, v3
    s_lshl_b32 s11, s3, 7
    v_add_u32 v12, s11, v12
    ds_write_b32 v12, v20 offset:28672
    s_waitcnt lgkmcnt(0)
    s_barrier
    v_lshlrev_b32 v12, 2, v3
    ds_read_b32 v22, v12 offset:28672
    ds_read_b32 v23, v12 offset:28800
    ds_read_b32 v24, v12 offset:28928
    ds_read_b32 v25, v12 offset:29056
    s_waitcnt lgkmcnt(0)
    v_add_f32 v22, v22, v23
    v_add_f32 v24, v24, v25
    v_add_f32 v22, v22, v24
    buffer_store_dword v22, v12, s[56:59], s10 offen sc1
    s_branch k0_end
k0_w1:
    s_mov_b32 s44, s26
    s_mov_b32 s45, s27
    s_and_b32 s45, s45, 0xffff
    s_mov_b32 s46, 0x188000
    s_mov_b32 s47, 0x20000
    s_sub_u32 s4, s2, 48
    s_lshl_b32 s8, s4, 6
    s_mul_i32 s9, s4, 28672
    s_add_u32 s9, s9, 0x2400000
    s_lshl_b32 s10, s4, 7
    s_add_u32 s10, s10, 0x2902000
    v_lshrrev_b32 v8, 2, v1
    v_mul_u32_u24 v7, 3584, v8
    v_and_b32 v8, 3, v1
    v_lshl_add_u32 v7, v8, 4, v7
    s_mul_i32 s11, s3, 57344
    s_add_u32 s8, s8, s11
    s_lshl_b32 s12, s3, 10
    s_add_u32 s11, s8, 0
    s_add_u32 m0, s12, 0
    s_nop 0
    buffer_load_dwordx4 v7, s[44:47], s11 offen lds
    s_add_u32 s11, s8, 229376
    s_add_u32 m0, s12, 4096
    s_nop 0
    buffer_load_dwordx4 v7, s[44:47], s11 offen lds
    s_add_u32 s11, s8, 458752
    s_add_u32 m0, s12, 8192
    s_nop 0
    buffer_load_dwordx4 v7, s[44:47], s11 offen lds
    s_add_u32 s11, s8, 688128
    s_add_u32 m0, s12, 12288
    s_nop 0
    buffer_load_dwordx4 v7, s[44:47], s11 offen lds
    s_add_u32 s11, s8, 917504
    s_add_u32 m0, s12, 16384
    s_nop 0
    buffer_load_dwordx4 v7, s[44:47], s11 offen lds
    s_add_u32 s11, s8, 1146880
    s_add_u32 m0, s12, 20480
    s_nop 0
    buffer_load_dwordx4 v7, s[44:47], s11 offen lds
    s_add_u32 s11, s8, 1376256
    s_add_u32 m0, s12, 24576
    s_nop 0
    buffer_load_dwordx4 v7, s[44:47], s11 offen lds
    v_mov_b32 v20, 0
    s_waitcnt vmcnt(0)
    s_barrier
    s_mul_i32 s11, s3, 7168
    v_add_u32 v12, s11, v11
    s_add_u32 s9, s9, s11
    ds_read_b64_tr_b16 v[32:33], v12 offset:0
    ds_read_b64_tr_b16 v[34:35], v12 offset:256
    ds_read_b64_tr_b16 v[36:37], v12 offset:1024
    ds_read_b64_tr_b16 v[38:39], v12 offset:1280
    ds_read_b64_tr_b16 v[40:41], v12 offset:2048
    ds_read_b64_tr_b16 v[42:43], v12 offset:2304
    ds_read_b64_tr_b16 v[44:45], v12 offset:3072
    ds_read_b64_tr_b16 v[46:47], v12 offset:3328
    ds_read_b64_tr_b16 v[48:49], v12 offset:4096
    ds_read_b64_tr_b16 v[50:51], v12 offset:4352
    ds_read_b64_tr_b16 v[52:53], v12 offset:5120
    ds_read_b64_tr_b16 v[54:55], v12 offset:5376
    ds_read_b64_tr_b16 v[56:57], v12 offset:6144
    ds_read_b64_tr_b16 v[58:59], v12 offset:6400
    s_waitcnt lgkmcnt(0)
    buffer_store_dwordx4 v[32:35], v9, s[56:59], s9 offen sc1
    s_add_u32 s9, s9, 1024
    buffer_store_dwordx4 v[36:39], v9, s[56:59], s9 offen sc1
    s_add_u32 s9, s9, 1024
    buffer_store_dwordx4 v[40:43], v9, s[56:59], s9 offen sc1
    s_add_u32 s9, s9, 1024
    buffer_store_dwordx4 v[44:47], v9, s[56:59], s9 offen sc1
    s_add_u32 s9, s9, 1024
    buffer_store_dwordx4 v[48:51], v9, s[56:59], s9 offen sc1
    s_add_u32 s9, s9, 1024
    buffer_store_dwordx4 v[52:55], v9, s[56:59], s9 offen sc1
    s_add_u32 s9, s9, 1024
    buffer_store_dwordx4 v[56:59], v9, s[56:59], s9 offen sc1
    s_add_u32 s9, s9, 1024
    v_dot2_f32_bf16 v20, v32, v19, v20
    v_dot2_f32_bf16 v20, v33, v19, v20
    v_dot2_f32_bf16 v20, v34, v19, v20
    v_dot2_f32_bf16 v20, v35, v19, v20
    v_dot2_f32_bf16 v20, v36, v19, v20
    v_dot2_f32_bf16 v20, v37, v19, v20
    v_dot2_f32_bf16 v20, v38, v19, v20
    v_dot2_f32_bf16 v20, v39, v19, v20
    v_dot2_f32_bf16 v20, v40, v19, v20
    v_dot2_f32_bf16 v20, v41, v19, v20
    v_dot2_f32_bf16 v20, v42, v19, v20
    v_dot2_f32_bf16 v20, v43, v19, v20
    v_dot2_f32_bf16 v20, v44, v19, v20
    v_dot2_f32_bf16 v20, v45, v19, v20
    v_dot2_f32_bf16 v20, v46, v19, v20
    v_dot2_f32_bf16 v20, v47, v19, v20
    v_dot2_f32_bf16 v20, v48, v19, v20
    v_dot2_f32_bf16 v20, v49, v19, v20
    v_dot2_f32_bf16 v20, v50, v19, v20
    v_dot2_f32_bf16 v20, v51, v19, v20
    v_dot2_f32_bf16 v20, v52, v19, v20
    v_dot2_f32_bf16 v20, v53, v19, v20
    v_dot2_f32_bf16 v20, v54, v19, v20
    v_dot2_f32_bf16 v20, v55, v19, v20
    v_dot2_f32_bf16 v20, v56, v19, v20
    v_dot2_f32_bf16 v20, v57, v19, v20
    v_dot2_f32_bf16 v20, v58, v19, v20
    v_dot2_f32_bf16 v20, v59, v19, v20
    s_nop 3
    v_mov_b32 v21, v20
    s_nop 1
    v_permlane32_swap_b32 v20, v21
    s_nop 0
    v_add_f32 v20, v20, v21
    v_lshlrev_b32 v12, 2, v3
    s_lshl_b32 s11, s3, 7
    v_add_u32 v12, s11, v12
    ds_write_b32 v12, v20 offset:28672
    s_waitcnt lgkmcnt(0)
    s_barrier
    v_lshlrev_b32 v12, 2, v3
    ds_read_b32 v22, v12 offset:28672
    ds_read_b32 v23, v12 offset:28800
    ds_read_b32 v24, v12 offset:28928
    ds_read_b32 v25, v12 offset:29056
    s_waitcnt lgkmcnt(0)
    v_add_f32 v22, v22, v23
    v_add_f32 v24, v24, v25
    v_add_f32 v22, v22, v24
    buffer_store_dword v22, v12, s[56:59], s10 offen sc1
    s_branch k0_end
k0_wo:
    s_mov_b32 s44, s22
    s_mov_b32 s45, s23
    s_and_b32 s45, s45, 0xffff
    s_mov_b32 s46, 0x62000
    s_mov_b32 s47, 0x20000
    s_sub_u32 s4, s2, 104
    s_lshl_b32 s8, s4, 6
    s_lshl_b32 s9, s4, 15
    s_add_u32 s9, s9, 0x2600000
    v_lshrrev_b32 v8, 2, v1
    v_mul_u32_u24 v7, 896, v8
    v_and_b32 v8, 3, v1
    v_lshl_add_u32 v7, v8, 4, v7
    s_mul_i32 s11, s3, 14336
    s_add_u32 s8, s8, s11
    s_lshl_b32 s12, s3, 10
    s_add_u32 s11, s8, 0
    s_add_u32 m0, s12, 0
    s_nop 0
    buffer_load_dwordx4 v7, s[44:47], s11 offen lds
    s_add_u32 s11, s8, 57344
    s_add_u32 m0, s12, 4096
    s_nop 0
    buffer_load_dwordx4 v7, s[44:47], s11 offen lds
    s_add_u32 s11, s8, 114688
    s_add_u32 m0, s12, 8192
    s_nop 0
    buffer_load_dwordx4 v7, s[44:47], s11 offen lds
    s_add_u32 s11, s8, 172032
    s_add_u32 m0, s12, 12288
    s_nop 0
    buffer_load_dwordx4 v7, s[44:47], s11 offen lds
    s_add_u32 s11, s8, 229376
    s_add_u32 m0, s12, 16384
    s_nop 0
    buffer_load_dwordx4 v7, s[44:47], s11 offen lds
    s_add_u32 s11, s8, 286720
    s_add_u32 m0, s12, 20480
    s_nop 0
    buffer_load_dwordx4 v7, s[44:47], s11 offen lds
    s_add_u32 s11, s8, 344064
    s_add_u32 m0, s12, 24576
    s_nop 0
    buffer_load_dwordx4 v7, s[44:47], s11 offen lds
    v_mov_b32 v20, 0
    s_waitcnt vmcnt(0)
    s_barrier
    v_lshlrev_b32 v12, 8, v4
    v_sub_u32 v12, v11, v12
    s_mul_i32 s11, s3, 7168
    v_add_u32 v12, s11, v12
    s_lshl_b32 s11, s3, 13
    s_add_u32 s9, s9, s11
    s_mov_b32 s60, 0
    s_mov_b32 s61, -1
    ds_read_b64_tr_b16 v[32:33], v12 offset:0
    ds_read_b64_tr_b16 v[34:35], v12 offset:512
    ds_read_b64_tr_b16 v[36:37], v12 offset:1024
    ds_read_b64_tr_b16 v[38:39], v12 offset:1536
    ds_read_b64_tr_b16 v[40:41], v12 offset:1792
    ds_read_b64_tr_b16 v[42:43], v12 offset:2304
    ds_read_b64_tr_b16 v[44:45], v12 offset:2816
    ds_read_b64_tr_b16 v[46:47], v12 offset:3328
    ds_read_b64_tr_b16 v[48:49], v12 offset:3584
    ds_read_b64_tr_b16 v[50:51], v12 offset:4096
    ds_read_b64_tr_b16 v[52:53], v12 offset:4608
    ds_read_b64_tr_b16 v[54:55], v12 offset:5120
    ds_read_b64_tr_b16 v[56:57], v12 offset:5376
    ds_read_b64_tr_b16 v[58:59], v12 offset:5888
    ds_read_b64_tr_b16 v[60:61], v12 offset:6400
    ds_read_b64_tr_b16 v[62:63], v12 offset:6912
    s_waitcnt lgkmcnt(0)
    v_cndmask_b32 v38, v38, 0, s[60:61]
    v_cndmask_b32 v39, v39, 0, s[60:61]
    v_cndmask_b32 v46, v46, 0, s[60:61]
    v_cndmask_b32 v47, v47, 0, s[60:61]
    v_cndmask_b32 v54, v54, 0, s[60:61]
    v_cndmask_b32 v55, v55, 0, s[60:61]
    v_cndmask_b32 v62, v62, 0, s[60:61]
    v_cndmask_b32 v63, v63, 0, s[60:61]
    buffer_store_dwordx4 v[32:35], v9, s[56:59], s9 offen sc1
    s_add_u32 s9, s9, 1024
    buffer_store_dwordx4 v[36:39], v9, s[56:59], s9 offen sc1
    s_add_u32 s9, s9, 1024
    buffer_store_dwordx4 v[40:43], v9, s[56:59], s9 offen sc1
    s_add_u32 s9, s9, 1024
    buffer_store_dwordx4 v[44:47], v9, s[56:59], s9 offen sc1
    s_add_u32 s9, s9, 1024
    buffer_store_dwordx4 v[48:51], v9, s[56:59], s9 offen sc1
    s_add_u32 s9, s9, 1024
    buffer_store_dwordx4 v[52:55], v9, s[56:59], s9 offen sc1
    s_add_u32 s9, s9, 1024
    buffer_store_dwordx4 v[56:59], v9, s[56:59], s9 offen sc1
    s_add_u32 s9, s9, 1024
    buffer_store_dwordx4 v[60:63], v9, s[56:59], s9 offen sc1
    s_add_u32 s9, s9, 1024
    s_branch k0_end
k0_w2:
    s_mov_b32 s44, s30
    s_mov_b32 s45, s31
    s_and_b32 s45, s45, 0xffff
    s_mov_b32 s46, 0x188000
    s_mov_b32 s47, 0x20000
    s_sub_u32 s4, s2, 118
    s_lshr_b32 s5, s4, 2
    s_and_b32 s6, s4, 3
    s_lshl_b32 s8, s5, 6
    s_mul_i32 s7, s6, 401408
    s_add_u32 s8, s8, s7
    s_mul_i32 s9, s4, 28672
    s_add_u32 s9, s9, 0x2700000
    v_lshrrev_b32 v8, 2, v1
    v_mul_u32_u24 v7, 896, v8
    v_and_b32 v8, 3, v1
    v_lshl_add_u32 v7, v8, 4, v7
    s_mul_i32 s11, s3, 14336
    s_add_u32 s8, s8, s11
    s_lshl_b32 s12, s3, 10
    s_add_u32 s11, s8, 0
    s_add_u32 m0, s12, 0
    s_nop 0
    buffer_load_dwordx4 v7, s[44:47], s11 offen lds
    s_add_u32 s11, s8, 57344
    s_add_u32 m0, s12, 4096
    s_nop 0
    buffer_load_dwordx4 v7, s[44:47], s11 offen lds
    s_add_u32 s11, s8, 114688
    s_add_u32 m0, s12, 8192
    s_nop 0
    buffer_load_dwordx4 v7, s[44:47], s11 offen lds
    s_add_u32 s11, s8, 172032
    s_add_u32 m0, s12, 12288
    s_nop 0
    buffer_load_dwordx4 v7, s[44:47], s11 offen lds
    s_add_u32 s11, s8, 229376
    s_add_u32 m0, s12, 16384
    s_nop 0
    buffer_load_dwordx4 v7, s[44:47], s11 offen lds
    s_add_u32 s11, s8, 286720
    s_add_u32 m0, s12, 20480
    s_nop 0
    buffer_load_dwordx4 v7, s[44:47], s11 offen lds
    s_add_u32 s11, s8, 344064
    s_add_u32 m0, s12, 24576
    s_nop 0
    buffer_load_dwordx4 v7, s[44:47], s11 offen lds
    v_mov_b32 v20, 0
    s_waitcnt vmcnt(0)
    s_barrier
    s_mul_i32 s11, s3, 7168
    v_add_u32 v12, s11, v11
    s_add_u32 s9, s9, s11
    ds_read_b64_tr_b16 v[32:33], v12 offset:0
    ds_read_b64_tr_b16 v[34:35], v12 offset:256
    ds_read_b64_tr_b16 v[36:37], v12 offset:1024
    ds_read_b64_tr_b16 v[38:39], v12 offset:1280
    ds_read_b64_tr_b16 v[40:41], v12 offset:2048
    ds_read_b64_tr_b16 v[42:43], v12 offset:2304
    ds_read_b64_tr_b16 v[44:45], v12 offset:3072
    ds_read_b64_tr_b16 v[46:47], v12 offset:3328
    ds_read_b64_tr_b16 v[48:49], v12 offset:4096
    ds_read_b64_tr_b16 v[50:51], v12 offset:4352
    ds_read_b64_tr_b16 v[52:53], v12 offset:5120
    ds_read_b64_tr_b16 v[54:55], v12 offset:5376
    ds_read_b64_tr_b16 v[56:57], v12 offset:6144
    ds_read_b64_tr_b16 v[58:59], v12 offset:6400
    s_waitcnt lgkmcnt(0)
    buffer_store_dwordx4 v[32:35], v9, s[56:59], s9 offen sc1
    s_add_u32 s9, s9, 1024
    buffer_store_dwordx4 v[36:39], v9, s[56:59], s9 offen sc1
    s_add_u32 s9, s9, 1024
    buffer_store_dwordx4 v[40:43], v9, s[56:59], s9 offen sc1
    s_add_u32 s9, s9, 1024
    buffer_store_dwordx4 v[44:47], v9, s[56:59], s9 offen sc1
    s_add_u32 s9, s9, 1024
    buffer_store_dwordx4 v[48:51], v9, s[56:59], s9 offen sc1
    s_add_u32 s9, s9, 1024
    buffer_store_dwordx4 v[52:55], v9, s[56:59], s9 offen sc1
    s_add_u32 s9, s9, 1024
    buffer_store_dwordx4 v[56:59], v9, s[56:59], s9 offen sc1
    s_add_u32 s9, s9, 1024
    s_branch k0_end
k0_x:
    s_mov_b32 s44, s16
    s_mov_b32 s45, s17
    s_and_b32 s45, s45, 0xffff
    s_mov_b32 s46, 0x1c0000
    s_mov_b32 s47, 0x20000
    s_sub_u32 s4, s2, 174
    s_mul_i32 s8, s4, 28672
    s_lshl_b32 s12, s3, 10
    s_add_u32 s11, s8, s12
    s_add_u32 m0, s12, 0
    s_nop 0
    buffer_load_dwordx4 v9, s[44:47], s11 offen lds
    s_add_u32 s11, s11, 4096
    s_add_u32 m0, s12, 4096
    s_nop 0
    buffer_load_dwordx4 v9, s[44:47], s11 offen lds
    s_add_u32 s11, s11, 4096
    s_add_u32 m0, s12, 8192
    s_nop 0
    buffer_load_dwordx4 v9, s[44:47], s11 offen lds
    s_add_u32 s11, s11, 4096
    s_add_u32 m0, s12, 12288
    s_nop 0
    buffer_load_dwordx4 v9, s[44:47], s11 offen lds
    s_add_u32 s11, s11, 4096
    s_add_u32 m0, s12, 16384
    s_nop 0
    buffer_load_dwordx4 v9, s[44:47], s11 offen lds
    s_add_u32 s11, s11, 4096
    s_add_u32 m0, s12, 20480
    s_nop 0
    buffer_load_dwordx4 v9, s[44:47], s11 offen lds
    s_add_u32 s11, s11, 4096
    s_add_u32 m0, s12, 24576
    s_nop 0
    buffer_load_dwordx4 v9, s[44:47], s11 offen lds
    s_add_u32 s11, s11, 4096
    v_mul_u32_u24 v12, 896, v3
    v_lshl_add_u32 v12, v4, 4, v12
    s_mul_i32 s11, s3, 224
    v_add_u32 v12, s11, v12
    s_mul_i32 s11, s3, 7168
    s_add_u32 s9, s8, s11
    s_waitcnt vmcnt(0)
    s_barrier
    ds_read_b128 v[32:35], v12 offset:0
    ds_read_b128 v[36:39], v12 offset:32
    ds_read_b128 v[40:43], v12 offset:64
    ds_read_b128 v[44:47], v12 offset:96
    ds_read_b128 v[48:51], v12 offset:128
    ds_read_b128 v[52:55], v12 offset:160
    ds_read_b128 v[56:59], v12 offset:192
    s_waitcnt lgkmcnt(0)
    buffer_store_dwordx4 v[32:35], v9, s[56:59], s9 offen sc1
    s_add_u32 s9, s9, 1024
    buffer_store_dwordx4 v[36:39], v9, s[56:59], s9 offen sc1
    s_add_u32 s9, s9, 1024
    buffer_store_dwordx4 v[40:43], v9, s[56:59], s9 offen sc1
    s_add_u32 s9, s9, 1024
    buffer_store_dwordx4 v[44:47], v9, s[56:59], s9 offen sc1
    s_add_u32 s9, s9, 1024
    buffer_store_dwordx4 v[48:51], v9, s[56:59], s9 offen sc1
    s_add_u32 s9, s9, 1024
    buffer_store_dwordx4 v[52:55], v9, s[56:59], s9 offen sc1
    s_add_u32 s9, s9, 1024
    buffer_store_dwordx4 v[56:59], v9, s[56:59], s9 offen sc1
    s_add_u32 s9, s9, 1024
k0_end:
    s_waitcnt vmcnt(0)
    v_mov_b32 v6, 0
L_non_1:
    buffer_load_dword v5, v6, s[76:79], 0 offen sc1
    s_waitcnt vmcnt(0)
    v_readfirstlane_b32 s98, v5
    s_nop 2
    s_cmp_lg_u32 s98, 0
    s_cbranch_scc1 L_non_1_x
    s_sleep 4
    s_branch L_non_1
L_non_1_x:
    s_lshl_b32 s8, s2, 2
    s_waitcnt vmcnt(0) lgkmcnt(0)
    s_barrier
    s_cmp_eq_u32 s3, 0
    s_cbranch_scc0 L_sig_2
    v_mov_b32 v5, s98
    v_mov_b32 v6, 0
    s_mov_b64 exec, 1
    buffer_store_dword v5, v6, s[72:75], s8 offen sc1
    s_mov_b64 exec, -1
L_sig_2:
    s_lshr_b32 s14, s2, 4
    s_mul_i32 s14, s14, 12
    s_cmp_eq_u32 s3, 3
    s_cbranch_scc0 L_pdone_4
    s_mov_b64 exec, 0x7
    v_lshlrev_b32 v6, 2, v1
L_poll_3:
    buffer_load_dword v5, v6, s[72:75], s14 offen sc1
    s_waitcnt vmcnt(0)
    v_cmp_ne_u32 vcc, s98, v5
    s_cbranch_vccz L_pdone_4_x
    s_sleep 2
    s_branch L_poll_3
L_pdone_4_x:
    s_mov_b64 exec, -1
L_pdone_4:
    s_barrier
    s_lshr_b32 s8, s2, 4
    s_add_u32 s44, s38, 0x2200000
    s_addc_u32 s45, s39, 0
    s_and_b32 s45, s45, 0xffff
    s_mov_b32 s46, 0x150000
    s_mov_b32 s47, 0x20000
    s_mul_i32 s8, s8, 86016
    v_lshlrev_b32 v9, 4, v1
    s_cmp_eq_u32 s3, 0
    s_cbranch_scc0 k1p0_dw0
    s_add_u32 s11, s8, 0
    s_mov_b32 m0, 65536
    s_nop 0
    buffer_load_dwordx4 v9, s[44:47], s11 offen lds
    s_add_u32 s11, s8, 29696
    s_mov_b32 m0, 95232
    s_nop 0
    buffer_load_dwordx4 v9, s[44:47], s11 offen lds
    s_add_u32 s11, s8, 59392
    s_mov_b32 m0, 124928
    s_nop 0
    buffer_load_dwordx4 v9, s[44:47], s11 offen lds
    s_add_u32 s11, s8, 4096
    s_mov_b32 m0, 69632
    s_nop 0
    buffer_load_dwordx4 v9, s[44:47], s11 offen lds
    s_add_u32 s11, s8, 33792
    s_mov_b32 m0, 99328
    s_nop 0
    buffer_load_dwordx4 v9, s[44:47], s11 offen lds
    s_add_u32 s11, s8, 63488
    s_mov_b32 m0, 129024
    s_nop 0
    buffer_load_dwordx4 v9, s[44:47], s11 offen lds
    s_add_u32 s11, s8, 8192
    s_mov_b32 m0, 73728
    s_nop 0
    buffer_load_dwordx4 v9, s[44:47], s11 offen lds
    s_add_u32 s11, s8, 37888
    s_mov_b32 m0, 103424
    s_nop 0
    buffer_load_dwordx4 v9, s[44:47], s11 offen lds
    s_add_u32 s11, s8, 67584
    s_mov_b32 m0, 133120
    s_nop 0
    buffer_load_dwordx4 v9, s[44:47], s11 offen lds
    s_add_u32 s11, s8, 12288
    s_mov_b32 m0, 77824
    s_nop 0
    buffer_load_dwordx4 v9, s[44:47], s11 offen lds
    s_add_u32 s11, s8, 41984
    s_mov_b32 m0, 107520
    s_nop 0
    buffer_load_dwordx4 v9, s[44:47], s11 offen lds
    s_add_u32 s11, s8, 71680
    s_mov_b32 m0, 137216
    s_nop 0
    buffer_load_dwordx4 v9, s[44:47], s11 offen lds
    s_add_u32 s11, s8, 16384
    s_mov_b32 m0, 81920
    s_nop 0
    buffer_load_dwordx4 v9, s[44:47], s11 offen lds
    s_add_u32 s11, s8, 46080
    s_mov_b32 m0, 111616
    s_nop 0
    buffer_load_dwordx4 v9, s[44:47], s11 offen lds
    s_add_u32 s11, s8, 75776
    s_mov_b32 m0, 141312
    s_nop 0
    buffer_load_dwordx4 v9, s[44:47], s11 offen lds
    s_add_u32 s11, s8, 20480
    s_mov_b32 m0, 86016
    s_nop 0
    buffer_load_dwordx4 v9, s[44:47], s11 offen lds
    s_add_u32 s11, s8, 50176
    s_mov_b32 m0, 115712
    s_nop 0
    buffer_load_dwordx4 v9, s[44:47], s11 offen lds
    s_add_u32 s11, s8, 79872
    s_mov_b32 m0, 145408
    s_nop 0
    buffer_load_dwordx4 v9, s[44:47], s11 offen lds
    s_add_u32 s11, s8, 24576
    s_mov_b32 m0, 90112
    s_nop 0
    buffer_load_dwordx4 v9, s[44:47], s11 offen lds
    s_add_u32 s11, s8, 54272
    s_mov_b32 m0, 119808
    s_nop 0
    buffer_load_dwordx4 v9, s[44:47], s11 offen lds
    s_add_u32 s11, s8, 83968
    s_mov_b32 m0, 149504
    s_nop 0
    buffer_load_dwordx4 v9, s[44:47], s11 offen lds
k1p0_dw0:
    s_cmp_eq_u32 s3, 1
    s_cbranch_scc0 k1p0_dw1
    s_add_u32 s11, s8, 28672
    s_mov_b32 m0, 94208
    s_nop 0
    buffer_load_dwordx4 v9, s[44:47], s11 offen lds
    s_add_u32 s11, s8, 58368
    s_mov_b32 m0, 123904
    s_nop 0
    buffer_load_dwordx4 v9, s[44:47], s11 offen lds
    s_add_u32 s11, s8, 3072
    s_mov_b32 m0, 68608
    s_nop 0
    buffer_load_dwordx4 v9, s[44:47], s11 offen lds
    s_add_u32 s11, s8, 32768
    s_mov_b32 m0, 98304
    s_nop 0
    buffer_load_dwordx4 v9, s[44:47], s11 offen lds
    s_add_u32 s11, s8, 62464
    s_mov_b32 m0, 128000
    s_nop 0
    buffer_load_dwordx4 v9, s[44:47], s11 offen lds
    s_add_u32 s11, s8, 7168
    s_mov_b32 m0, 72704
    s_nop 0
    buffer_load_dwordx4 v9, s[44:47], s11 offen lds
    s_add_u32 s11, s8, 36864
    s_mov_b32 m0, 102400
    s_nop 0
    buffer_load_dwordx4 v9, s[44:47], s11 offen lds
    s_add_u32 s11, s8, 66560
    s_mov_b32 m0, 132096
    s_nop 0
    buffer_load_dwordx4 v9, s[44:47], s11 offen lds
    s_add_u32 s11, s8, 11264
    s_mov_b32 m0, 76800
    s_nop 0
    buffer_load_dwordx4 v9, s[44:47], s11 offen lds
    s_add_u32 s11, s8, 40960
    s_mov_b32 m0, 106496
    s_nop 0
    buffer_load_dwordx4 v9, s[44:47], s11 offen lds
    s_add_u32 s11, s8, 70656
    s_mov_b32 m0, 136192
    s_nop 0
    buffer_load_dwordx4 v9, s[44:47], s11 offen lds
    s_add_u32 s11, s8, 15360
    s_mov_b32 m0, 80896
    s_nop 0
    buffer_load_dwordx4 v9, s[44:47], s11 offen lds
    s_add_u32 s11, s8, 45056
    s_mov_b32 m0, 110592
    s_nop 0
    buffer_load_dwordx4 v9, s[44:47], s11 offen lds
    s_add_u32 s11, s8, 74752
    s_mov_b32 m0, 140288
    s_nop 0
    buffer_load_dwordx4 v9, s[44:47], s11 offen lds
    s_add_u32 s11, s8, 19456
    s_mov_b32 m0, 84992
    s_nop 0
    buffer_load_dwordx4 v9, s[44:47], s11 offen lds
    s_add_u32 s11, s8, 49152
    s_mov_b32 m0, 114688
    s_nop 0
    buffer_load_dwordx4 v9, s[44:47], s11 offen lds
    s_add_u32 s11, s8, 78848
    s_mov_b32 m0, 144384
    s_nop 0
    buffer_load_dwordx4 v9, s[44:47], s11 offen lds
    s_add_u32 s11, s8, 23552
    s_mov_b32 m0, 89088
    s_nop 0
    buffer_load_dwordx4 v9, s[44:47], s11 offen lds
    s_add_u32 s11, s8, 53248
    s_mov_b32 m0, 118784
    s_nop 0
    buffer_load_dwordx4 v9, s[44:47], s11 offen lds
    s_add_u32 s11, s8, 82944
    s_mov_b32 m0, 148480
    s_nop 0
    buffer_load_dwordx4 v9, s[44:47], s11 offen lds
    s_add_u32 s11, s8, 27648
    s_mov_b32 m0, 93184
    s_nop 0
    buffer_load_dwordx4 v9, s[44:47], s11 offen lds
k1p0_dw1:
    s_cmp_eq_u32 s3, 2
    s_cbranch_scc0 k1p0_dw2
    s_add_u32 s11, s8, 57344
    s_mov_b32 m0, 122880
    s_nop 0
    buffer_load_dwordx4 v9, s[44:47], s11 offen lds
    s_add_u32 s11, s8, 2048
    s_mov_b32 m0, 67584
    s_nop 0
    buffer_load_dwordx4 v9, s[44:47], s11 offen lds
    s_add_u32 s11, s8, 31744
    s_mov_b32 m0, 97280
    s_nop 0
    buffer_load_dwordx4 v9, s[44:47], s11 offen lds
    s_add_u32 s11, s8, 61440
    s_mov_b32 m0, 126976
    s_nop 0
    buffer_load_dwordx4 v9, s[44:47], s11 offen lds
    s_add_u32 s11, s8, 6144
    s_mov_b32 m0, 71680
    s_nop 0
    buffer_load_dwordx4 v9, s[44:47], s11 offen lds
    s_add_u32 s11, s8, 35840
    s_mov_b32 m0, 101376
    s_nop 0
    buffer_load_dwordx4 v9, s[44:47], s11 offen lds
    s_add_u32 s11, s8, 65536
    s_mov_b32 m0, 131072
    s_nop 0
    buffer_load_dwordx4 v9, s[44:47], s11 offen lds
    s_add_u32 s11, s8, 10240
    s_mov_b32 m0, 75776
    s_nop 0
    buffer_load_dwordx4 v9, s[44:47], s11 offen lds
    s_add_u32 s11, s8, 39936
    s_mov_b32 m0, 105472
    s_nop 0
    buffer_load_dwordx4 v9, s[44:47], s11 offen lds
    s_add_u32 s11, s8, 69632
    s_mov_b32 m0, 135168
    s_nop 0
    buffer_load_dwordx4 v9, s[44:47], s11 offen lds
    s_add_u32 s11, s8, 14336
    s_mov_b32 m0, 79872
    s_nop 0
    buffer_load_dwordx4 v9, s[44:47], s11 offen lds
    s_add_u32 s11, s8, 44032
    s_mov_b32 m0, 109568
    s_nop 0
    buffer_load_dwordx4 v9, s[44:47], s11 offen lds
    s_add_u32 s11, s8, 73728
    s_mov_b32 m0, 139264
    s_nop 0
    buffer_load_dwordx4 v9, s[44:47], s11 offen lds
    s_add_u32 s11, s8, 18432
    s_mov_b32 m0, 83968
    s_nop 0
    buffer_load_dwordx4 v9, s[44:47], s11 offen lds
    s_add_u32 s11, s8, 48128
    s_mov_b32 m0, 113664
    s_nop 0
    buffer_load_dwordx4 v9, s[44:47], s11 offen lds
    s_add_u32 s11, s8, 77824
    s_mov_b32 m0, 143360
    s_nop 0
    buffer_load_dwordx4 v9, s[44:47], s11 offen lds
    s_add_u32 s11, s8, 22528
    s_mov_b32 m0, 88064
    s_nop 0
    buffer_load_dwordx4 v9, s[44:47], s11 offen lds
    s_add_u32 s11, s8, 52224
    s_mov_b32 m0, 117760
    s_nop 0
    buffer_load_dwordx4 v9, s[44:47], s11 offen lds
    s_add_u32 s11, s8, 81920
    s_mov_b32 m0, 147456
    s_nop 0
    buffer_load_dwordx4 v9, s[44:47], s11 offen lds
    s_add_u32 s11, s8, 26624
    s_mov_b32 m0, 92160
    s_nop 0
    buffer_load_dwordx4 v9, s[44:47], s11 offen lds
    s_add_u32 s11, s8, 56320
    s_mov_b32 m0, 121856
    s_nop 0
    buffer_load_dwordx4 v9, s[44:47], s11 offen lds
k1p0_dw2:
    s_cmp_eq_u32 s3, 3
    s_cbranch_scc0 k1p0_dw3
    s_add_u32 s11, s8, 1024
    s_mov_b32 m0, 66560
    s_nop 0
    buffer_load_dwordx4 v9, s[44:47], s11 offen lds
    s_add_u32 s11, s8, 30720
    s_mov_b32 m0, 96256
    s_nop 0
    buffer_load_dwordx4 v9, s[44:47], s11 offen lds
    s_add_u32 s11, s8, 60416
    s_mov_b32 m0, 125952
    s_nop 0
    buffer_load_dwordx4 v9, s[44:47], s11 offen lds
    s_add_u32 s11, s8, 5120
    s_mov_b32 m0, 70656
    s_nop 0
    buffer_load_dwordx4 v9, s[44:47], s11 offen lds
    s_add_u32 s11, s8, 34816
    s_mov_b32 m0, 100352
    s_nop 0
    buffer_load_dwordx4 v9, s[44:47], s11 offen lds
    s_add_u32 s11, s8, 64512
    s_mov_b32 m0, 130048
    s_nop 0
    buffer_load_dwordx4 v9, s[44:47], s11 offen lds
    s_add_u32 s11, s8, 9216
    s_mov_b32 m0, 74752
    s_nop 0
    buffer_load_dwordx4 v9, s[44:47], s11 offen lds
    s_add_u32 s11, s8, 38912
    s_mov_b32 m0, 104448
    s_nop 0
    buffer_load_dwordx4 v9, s[44:47], s11 offen lds
    s_add_u32 s11, s8, 68608
    s_mov_b32 m0, 134144
    s_nop 0
    buffer_load_dwordx4 v9, s[44:47], s11 offen lds
    s_add_u32 s11, s8, 13312
    s_mov_b32 m0, 78848
    s_nop 0
    buffer_load_dwordx4 v9, s[44:47], s11 offen lds
    s_add_u32 s11, s8, 43008
    s_mov_b32 m0, 108544
    s_nop 0
    buffer_load_dwordx4 v9, s[44:47], s11 offen lds
    s_add_u32 s11, s8, 72704
    s_mov_b32 m0, 138240
    s_nop 0
    buffer_load_dwordx4 v9, s[44:47], s11 offen lds
    s_add_u32 s11, s8, 17408
    s_mov_b32 m0, 82944
    s_nop 0
    buffer_load_dwordx4 v9, s[44:47], s11 offen lds
    s_add_u32 s11, s8, 47104
    s_mov_b32 m0, 112640
    s_nop 0
    buffer_load_dwordx4 v9, s[44:47], s11 offen lds
    s_add_u32 s11, s8, 76800
    s_mov_b32 m0, 142336
    s_nop 0
    buffer_load_dwordx4 v9, s[44:47], s11 offen lds
    s_add_u32 s11, s8, 21504
    s_mov_b32 m0, 87040
    s_nop 0
    buffer_load_dwordx4 v9, s[44:47], s11 offen lds
    s_add_u32 s11, s8, 51200
    s_mov_b32 m0, 116736
    s_nop 0
    buffer_load_dwordx4 v9, s[44:47], s11 offen lds
    s_add_u32 s11, s8, 80896
    s_mov_b32 m0, 146432
    s_nop 0
    buffer_load_dwordx4 v9, s[44:47], s11 offen lds
    s_add_u32 s11, s8, 25600
    s_mov_b32 m0, 91136
    s_nop 0
    buffer_load_dwordx4 v9, s[44:47], s11 offen lds
    s_add_u32 s11, s8, 55296
    s_mov_b32 m0, 120832
    s_nop 0
    buffer_load_dwordx4 v9, s[44:47], s11 offen lds
    s_add_u32 s11, s8, 84992
    s_mov_b32 m0, 150528
    s_nop 0
    buffer_load_dwordx4 v9, s[44:47], s11 offen lds
k1p0_dw3:
    s_and_b32 s4, s2, 7
    s_lshr_b32 s5, s2, 3
    s_lshl_b32 s4, s4, 1
    s_and_b32 s6, s5, 1
    s_add_u32 s4, s4, s6
    s_lshr_b32 s5, s5, 1
    s_mov_b32 s40, s38
    s_mov_b32 s41, s39
    s_and_b32 s41, s41, 0xffff
    s_mov_b32 s42, 0x1c0000
    s_mov_b32 s43, 0x20000
    s_add_u32 s44, s38, 0x2200000
    s_addc_u32 s45, s39, 0
    s_and_b32 s45, s45, 0xffff
    s_mov_b32 s46, 0x150000
    s_mov_b32 s47, 0x20000
    s_mov_b32 s48, s20
    s_mov_b32 s49, s21
    s_and_b32 s49, s49, 0xffff
    s_mov_b32 s50, 0x6200
    s_mov_b32 s51, 0x20000
    s_add_u32 s52, s38, 0x800000
    s_addc_u32 s53, s39, 0
    s_and_b32 s53, s53, 0xffff
    s_mov_b32 s54, 0x400000
    s_mov_b32 s55, 0x20000
    s_add_u32 s56, s38, 0x1000000
    s_addc_u32 s57, s39, 0
    s_and_b32 s57, s57, 0xffff
    s_mov_b32 s58, 0x20000
    s_mov_b32 s59, 0x20000
    s_add_u32 s64, s38, 0x2900000
    s_addc_u32 s65, s39, 0
    s_and_b32 s65, s65, 0xffff
    s_mov_b32 s66, 0x4000
    s_mov_b32 s67, 0x20000
    v_lshlrev_b32 v9, 4, v1
    s_lshl_b32 s6, s4, 2
    s_add_u32 s6, s6, s3
    v_lshlrev_b32 v8, 1, v3
    v_mul_u32_u24 v7, 224, v4
    v_add_u32 v8, v8, v7
    s_mul_i32 s12, s5, 1568
    v_add_u32 v8, s12, v8
    v_mov_b32 v10, 0x40000000
    v_cmp_gt_u32 vcc, 28, v3
    s_nop 1
    v_cndmask_b32 v8, v10, v8, vcc
    v_cmp_eq_u32 vcc, 0, v4
    s_nop 1
    v_cndmask_b32 v7, v10, v8, vcc
    buffer_load_ushort v32, v8, s[48:51], 0 offen offset:0
    buffer_load_ushort v33, v8, s[48:51], 0 offen offset:56
    buffer_load_ushort v34, v8, s[48:51], 0 offen offset:112
    buffer_load_ushort v35, v8, s[48:51], 0 offen offset:168
    buffer_load_ushort v36, v8, s[48:51], 0 offen offset:448
    buffer_load_ushort v37, v8, s[48:51], 0 offen offset:504
    buffer_load_ushort v38, v8, s[48:51], 0 offen offset:560
    buffer_load_ushort v39, v8, s[48:51], 0 offen offset:616
    buffer_load_ushort v40, v8, s[48:51], 0 offen offset:896
    buffer_load_ushort v41, v8, s[48:51], 0 offen offset:952
    buffer_load_ushort v42, v8, s[48:51], 0 offen offset:1008
    buffer_load_ushort v43, v8, s[48:51], 0 offen offset:1064
    buffer_load_ushort v44, v7, s[48:51], 0 offen offset:1344
    buffer_load_ushort v45, v7, s[48:51], 0 offen offset:1400
    buffer_load_ushort v46, v7, s[48:51], 0 offen offset:1456
    buffer_load_ushort v47, v7, s[48:51], 0 offen offset:1512
    s_mul_i32 s12, s5, 384
    v_lshlrev_b32 v7, 4, v4
    buffer_load_dwordx4 v[240:243], v7, s[64:67], s12 offen offset:0
    buffer_load_dwordx4 v[244:247], v7, s[64:67], s12 offen offset:32
    buffer_load_dwordx4 v[248:251], v7, s[64:67], s12 offen offset:64
    buffer_load_dwordx4 v[252:255], v7, s[64:67], s12 offen offset:96
    buffer_load_dwordx4 v[16:19], v7, s[64:67], s12 offen offset:128
    buffer_load_dwordx4 v[20:23], v7, s[64:67], s12 offen offset:160
    buffer_load_dwordx4 v[24:27], v7, s[64:67], s12 offen offset:192
    buffer_load_dwordx4 v[28:31], v7, s[64:67], s12 offen offset:224
    v_lshlrev_b32 v7, 2, v3
    buffer_load_dword v56, v7, s[64:67], s12 offen offset:256
    s_mov_b32 s60, 0
    s_mov_b32 s61, -1
    v_add_u32 v10, 122880, v9
    v_add_u32 v11, 65536, v9
    s_lshl_b32 s14, s4, 4
    s_add_u32 s14, s14, 696
    s_cmp_eq_u32 s3, 3
    s_cbranch_scc0 L_pdone_6
    s_mov_b64 exec, 0xf
    v_lshlrev_b32 v6, 2, v1
L_poll_5:
    buffer_load_dword v5, v6, s[72:75], s14 offen sc1
    s_waitcnt vmcnt(0)
    v_cmp_ne_u32 vcc, s98, v5
    s_cbranch_vccz L_pdone_6_x
    s_sleep 2
    s_branch L_poll_5
L_pdone_6_x:
    s_mov_b64 exec, -1
L_pdone_6:
    s_barrier
    s_mul_i32 s7, s6, 28672
    buffer_load_dwordx4 v[64:67], v9, s[40:43], s7 offen offset:0
    buffer_load_dwordx4 v[68:71], v9, s[40:43], s7 offen offset:1024
    buffer_load_dwordx4 v[72:75], v9, s[40:43], s7 offen offset:2048
    buffer_load_dwordx4 v[76:79], v9, s[40:43], s7 offen offset:3072
    s_add_u32 s7, s7, 4096
    buffer_load_dwordx4 v[80:83], v9, s[40:43], s7 offen offset:0
    buffer_load_dwordx4 v[84:87], v9, s[40:43], s7 offen offset:1024
    buffer_load_dwordx4 v[88:91], v9, s[40:43], s7 offen offset:2048
    buffer_load_dwordx4 v[92:95], v9, s[40:43], s7 offen offset:3072
    s_add_u32 s7, s7, 4096
    buffer_load_dwordx4 v[96:99], v9, s[40:43], s7 offen offset:0
    buffer_load_dwordx4 v[100:103], v9, s[40:43], s7 offen offset:1024
    buffer_load_dwordx4 v[104:107], v9, s[40:43], s7 offen offset:2048
    buffer_load_dwordx4 v[108:111], v9, s[40:43], s7 offen offset:3072
    s_add_u32 s7, s7, 4096
    buffer_load_dwordx4 v[112:115], v9, s[40:43], s7 offen offset:0
    buffer_load_dwordx4 v[116:119], v9, s[40:43], s7 offen offset:1024
    buffer_load_dwordx4 v[120:123], v9, s[40:43], s7 offen offset:2048
    buffer_load_dwordx4 v[124:127], v9, s[40:43], s7 offen offset:3072
    s_add_u32 s7, s7, 4096
    buffer_load_dwordx4 v[128:131], v9, s[40:43], s7 offen offset:0
    buffer_load_dwordx4 v[132:135], v9, s[40:43], s7 offen offset:1024
    buffer_load_dwordx4 v[136:139], v9, s[40:43], s7 offen offset:2048
    buffer_load_dwordx4 v[140:143], v9, s[40:43], s7 offen offset:3072
    s_add_u32 s7, s7, 4096
    buffer_load_dwordx4 v[144:147], v9, s[40:43], s7 offen offset:0
    buffer_load_dwordx4 v[148:151], v9, s[40:43], s7 offen offset:1024
    buffer_load_dwordx4 v[152:155], v9, s[40:43], s7 offen offset:2048
    buffer_load_dwordx4 v[156:159], v9, s[40:43], s7 offen offset:3072
    s_add_u32 s7, s7, 4096
    buffer_load_dwordx4 v[160:163], v9, s[40:43], s7 offen offset:0
    buffer_load_dwordx4 v[164:167], v9, s[40:43], s7 offen offset:1024
    buffer_load_dwordx4 v[168:171], v9, s[40:43], s7 offen offset:2048
    buffer_load_dwordx4 v[172:175], v9, s[40:43], s7 offen offset:3072
    s_mul_i32 s13, s3, 5120
    s_add_u32 s13, s13, 32768
    s_waitcnt vmcnt(28)
    v_lshl_or_b32 v48, v33, 16, v32
    v_lshl_or_b32 v49, v35, 16, v34
    v_lshl_or_b32 v50, v37, 16, v36
    v_lshl_or_b32 v51, v39, 16, v38
    v_lshl_or_b32 v52, v41, 16, v40
    v_lshl_or_b32 v53, v43, 16, v42
    v_lshl_or_b32 v54, v45, 16, v44
    v_lshl_or_b32 v55, v47, 16, v46
    v_mov_b32 v14, 0
    v_mov_b32 v15, 0
    s_barrier
    ds_read_b128 v[224:227], v11 offset:0
    ds_read_b128 v[228:231], v11 offset:28672
    ds_read_b128 v[232:235], v10 offset:0
    ds_read_b128 v[32:35], v11 offset:1024
    ds_read_b128 v[36:39], v11 offset:29696
    ds_read_b128 v[40:43], v10 offset:1024
    s_waitcnt vmcnt(27) lgkmcnt(3)
    v_mfma_f32_32x32x16_bf16 v[176:191], v[224:227], v[64:67], 0
    v_lshlrev_b32 v57, 16, v64
    v_and_b32 v58, 0xffff0000, v64
    v_add_f32 v14, v14, v57
    v_fmac_f32 v15, v57, v57
    v_add_f32 v14, v14, v58
    v_fmac_f32 v15, v58, v58
    v_lshlrev_b32 v57, 16, v65
    v_and_b32 v58, 0xffff0000, v65
    v_mfma_f32_32x32x16_bf16 v[192:207], v[228:231], v[64:67], 0
    v_add_f32 v14, v14, v57
    v_fmac_f32 v15, v57, v57
    v_add_f32 v14, v14, v58
    v_fmac_f32 v15, v58, v58
    v_lshlrev_b32 v57, 16, v66
    v_and_b32 v58, 0xffff0000, v66
    v_add_f32 v14, v14, v57
    v_fmac_f32 v15, v57, v57
    v_mfma_f32_32x32x16_bf16 v[208:223], v[64:67], v[232:235], 0
    v_add_f32 v14, v14, v58
    v_fmac_f32 v15, v58, v58
    v_lshlrev_b32 v57, 16, v67
    v_and_b32 v58, 0xffff0000, v67
    v_add_f32 v14, v14, v57
    v_fmac_f32 v15, v57, v57
    v_add_f32 v14, v14, v58
    v_fmac_f32 v15, v58, v58
    ds_read_b128 v[224:227], v11 offset:2048
    ds_read_b128 v[228:231], v11 offset:30720
    ds_read_b128 v[232:235], v10 offset:2048
    s_waitcnt vmcnt(26) lgkmcnt(3)
    v_mfma_f32_32x32x16_bf16 v[176:191], v[32:35], v[68:71], v[176:191]
    v_lshlrev_b32 v57, 16, v68
    v_and_b32 v58, 0xffff0000, v68
    v_add_f32 v14, v14, v57
    v_fmac_f32 v15, v57, v57
    v_add_f32 v14, v14, v58
    v_fmac_f32 v15, v58, v58
    v_lshlrev_b32 v57, 16, v69
    v_and_b32 v58, 0xffff0000, v69
    v_mfma_f32_32x32x16_bf16 v[192:207], v[36:39], v[68:71], v[192:207]
    v_add_f32 v14, v14, v57
    v_fmac_f32 v15, v57, v57
    v_add_f32 v14, v14, v58
    v_fmac_f32 v15, v58, v58
    v_lshlrev_b32 v57, 16, v70
    v_and_b32 v58, 0xffff0000, v70
    v_add_f32 v14, v14, v57
    v_fmac_f32 v15, v57, v57
    v_mfma_f32_32x32x16_bf16 v[208:223], v[68:71], v[40:43], v[208:223]
    v_add_f32 v14, v14, v58
    v_fmac_f32 v15, v58, v58
    v_lshlrev_b32 v57, 16, v71
    v_and_b32 v58, 0xffff0000, v71
    v_add_f32 v14, v14, v57
    v_fmac_f32 v15, v57, v57
    v_add_f32 v14, v14, v58
    v_fmac_f32 v15, v58, v58
    ds_read_b128 v[32:35], v11 offset:3072
    ds_read_b128 v[36:39], v11 offset:31744
    ds_read_b128 v[40:43], v10 offset:3072
    s_waitcnt vmcnt(25) lgkmcnt(3)
    v_mfma_f32_32x32x16_bf16 v[176:191], v[224:227], v[72:75], v[176:191]
    v_lshlrev_b32 v57, 16, v72
    v_and_b32 v58, 0xffff0000, v72
    v_add_f32 v14, v14, v57
    v_fmac_f32 v15, v57, v57
    v_add_f32 v14, v14, v58
    v_fmac_f32 v15, v58, v58
    v_lshlrev_b32 v57, 16, v73
    v_and_b32 v58, 0xffff0000, v73
    v_mfma_f32_32x32x16_bf16 v[192:207], v[228:231], v[72:75], v[192:207]
    v_add_f32 v14, v14, v57
    v_fmac_f32 v15, v57, v57
    v_add_f32 v14, v14, v58
    v_fmac_f32 v15, v58, v58
    v_lshlrev_b32 v57, 16, v74
    v_and_b32 v58, 0xffff0000, v74
    v_add_f32 v14, v14, v57
    v_fmac_f32 v15, v57, v57
    v_mfma_f32_32x32x16_bf16 v[208:223], v[72:75], v[232:235], v[208:223]
    v_add_f32 v14, v14, v58
    v_fmac_f32 v15, v58, v58
    v_lshlrev_b32 v57, 16, v75
    v_and_b32 v58, 0xffff0000, v75
    v_add_f32 v14, v14, v57
    v_fmac_f32 v15, v57, v57
    v_add_f32 v14, v14, v58
    v_fmac_f32 v15, v58, v58
    ds_read_b128 v[224:227], v11 offset:4096
    ds_read_b128 v[228:231], v11 offset:32768
    ds_read_b128 v[232:235], v10 offset:4096
    s_waitcnt vmcnt(24) lgkmcnt(3)
    v_mfma_f32_32x32x16_bf16 v[176:191], v[32:35], v[76:79], v[176:191]
    v_lshlrev_b32 v57, 16, v76
    v_and_b32 v58, 0xffff0000, v76
    v_add_f32 v14, v14, v57
    v_fmac_f32 v15, v57, v57
    v_add_f32 v14, v14, v58
    v_fmac_f32 v15, v58, v58
    v_lshlrev_b32 v57, 16, v77
    v_and_b32 v58, 0xffff0000, v77
    v_mfma_f32_32x32x16_bf16 v[192:207], v[36:39], v[76:79], v[192:207]
    v_add_f32 v14, v14, v57
    v_fmac_f32 v15, v57, v57
    v_add_f32 v14, v14, v58
    v_fmac_f32 v15, v58, v58
    v_lshlrev_b32 v57, 16, v78
    v_and_b32 v58, 0xffff0000, v78
    v_add_f32 v14, v14, v57
    v_fmac_f32 v15, v57, v57
    v_mfma_f32_32x32x16_bf16 v[208:223], v[76:79], v[40:43], v[208:223]
    v_add_f32 v14, v14, v58
    v_fmac_f32 v15, v58, v58
    v_lshlrev_b32 v57, 16, v79
    v_and_b32 v58, 0xffff0000, v79
    v_add_f32 v14, v14, v57
    v_fmac_f32 v15, v57, v57
    v_add_f32 v14, v14, v58
    v_fmac_f32 v15, v58, v58
    ds_read_b128 v[32:35], v11 offset:5120
    ds_read_b128 v[36:39], v11 offset:33792
    ds_read_b128 v[40:43], v10 offset:5120
    s_waitcnt vmcnt(23) lgkmcnt(3)
    v_mfma_f32_32x32x16_bf16 v[176:191], v[224:227], v[80:83], v[176:191]
    v_lshlrev_b32 v57, 16, v80
    v_and_b32 v58, 0xffff0000, v80
    v_add_f32 v14, v14, v57
    v_fmac_f32 v15, v57, v57
    v_add_f32 v14, v14, v58
    v_fmac_f32 v15, v58, v58
    v_lshlrev_b32 v57, 16, v81
    v_and_b32 v58, 0xffff0000, v81
    v_mfma_f32_32x32x16_bf16 v[192:207], v[228:231], v[80:83], v[192:207]
    v_add_f32 v14, v14, v57
    v_fmac_f32 v15, v57, v57
    v_add_f32 v14, v14, v58
    v_fmac_f32 v15, v58, v58
    v_lshlrev_b32 v57, 16, v82
    v_and_b32 v58, 0xffff0000, v82
    v_add_f32 v14, v14, v57
    v_fmac_f32 v15, v57, v57
    v_mfma_f32_32x32x16_bf16 v[208:223], v[80:83], v[232:235], v[208:223]
    v_add_f32 v14, v14, v58
    v_fmac_f32 v15, v58, v58
    v_lshlrev_b32 v57, 16, v83
    v_and_b32 v58, 0xffff0000, v83
    v_add_f32 v14, v14, v57
    v_fmac_f32 v15, v57, v57
    v_add_f32 v14, v14, v58
    v_fmac_f32 v15, v58, v58
    ds_read_b128 v[224:227], v11 offset:6144
    ds_read_b128 v[228:231], v11 offset:34816
    ds_read_b128 v[232:235], v10 offset:6144
    s_waitcnt vmcnt(22) lgkmcnt(3)
    v_mfma_f32_32x32x16_bf16 v[176:191], v[32:35], v[84:87], v[176:191]
    v_lshlrev_b32 v57, 16, v84
    v_and_b32 v58, 0xffff0000, v84
    v_add_f32 v14, v14, v57
    v_fmac_f32 v15, v57, v57
    v_add_f32 v14, v14, v58
    v_fmac_f32 v15, v58, v58
    v_lshlrev_b32 v57, 16, v85
    v_and_b32 v58, 0xffff0000, v85
    v_mfma_f32_32x32x16_bf16 v[192:207], v[36:39], v[84:87], v[192:207]
    v_add_f32 v14, v14, v57
    v_fmac_f32 v15, v57, v57
    v_add_f32 v14, v14, v58
    v_fmac_f32 v15, v58, v58
    v_lshlrev_b32 v57, 16, v86
    v_and_b32 v58, 0xffff0000, v86
    v_add_f32 v14, v14, v57
    v_fmac_f32 v15, v57, v57
    v_mfma_f32_32x32x16_bf16 v[208:223], v[84:87], v[40:43], v[208:223]
    v_add_f32 v14, v14, v58
    v_fmac_f32 v15, v58, v58
    v_lshlrev_b32 v57, 16, v87
    v_and_b32 v58, 0xffff0000, v87
    v_add_f32 v14, v14, v57
    v_fmac_f32 v15, v57, v57
    v_add_f32 v14, v14, v58
    v_fmac_f32 v15, v58, v58
    ds_read_b128 v[32:35], v11 offset:7168
    ds_read_b128 v[36:39], v11 offset:35840
    ds_read_b128 v[40:43], v10 offset:7168
    s_waitcnt vmcnt(21) lgkmcnt(3)
    v_mfma_f32_32x32x16_bf16 v[176:191], v[224:227], v[88:91], v[176:191]
    v_lshlrev_b32 v57, 16, v88
    v_and_b32 v58, 0xffff0000, v88
    v_add_f32 v14, v14, v57
    v_fmac_f32 v15, v57, v57
    v_add_f32 v14, v14, v58
    v_fmac_f32 v15, v58, v58
    v_lshlrev_b32 v57, 16, v89
    v_and_b32 v58, 0xffff0000, v89
    v_mfma_f32_32x32x16_bf16 v[192:207], v[228:231], v[88:91], v[192:207]
    v_add_f32 v14, v14, v57
    v_fmac_f32 v15, v57, v57
    v_add_f32 v14, v14, v58
    v_fmac_f32 v15, v58, v58
    v_lshlrev_b32 v57, 16, v90
    v_and_b32 v58, 0xffff0000, v90
    v_add_f32 v14, v14, v57
    v_fmac_f32 v15, v57, v57
    v_mfma_f32_32x32x16_bf16 v[208:223], v[88:91], v[232:235], v[208:223]
    v_add_f32 v14, v14, v58
    v_fmac_f32 v15, v58, v58
    v_lshlrev_b32 v57, 16, v91
    v_and_b32 v58, 0xffff0000, v91
    v_add_f32 v14, v14, v57
    v_fmac_f32 v15, v57, v57
    v_add_f32 v14, v14, v58
    v_fmac_f32 v15, v58, v58
    ds_read_b128 v[224:227], v11 offset:8192
    ds_read_b128 v[228:231], v11 offset:36864
    ds_read_b128 v[232:235], v10 offset:8192
    s_waitcnt vmcnt(20) lgkmcnt(3)
    v_mfma_f32_32x32x16_bf16 v[176:191], v[32:35], v[92:95], v[176:191]
    v_lshlrev_b32 v57, 16, v92
    v_and_b32 v58, 0xffff0000, v92
    v_add_f32 v14, v14, v57
    v_fmac_f32 v15, v57, v57
    v_add_f32 v14, v14, v58
    v_fmac_f32 v15, v58, v58
    v_lshlrev_b32 v57, 16, v93
    v_and_b32 v58, 0xffff0000, v93
    v_mfma_f32_32x32x16_bf16 v[192:207], v[36:39], v[92:95], v[192:207]
    v_add_f32 v14, v14, v57
    v_fmac_f32 v15, v57, v57
    v_add_f32 v14, v14, v58
    v_fmac_f32 v15, v58, v58
    v_lshlrev_b32 v57, 16, v94
    v_and_b32 v58, 0xffff0000, v94
    v_add_f32 v14, v14, v57
    v_fmac_f32 v15, v57, v57
    v_mfma_f32_32x32x16_bf16 v[208:223], v[92:95], v[40:43], v[208:223]
    v_add_f32 v14, v14, v58
    v_fmac_f32 v15, v58, v58
    v_lshlrev_b32 v57, 16, v95
    v_and_b32 v58, 0xffff0000, v95
    v_add_f32 v14, v14, v57
    v_fmac_f32 v15, v57, v57
    v_add_f32 v14, v14, v58
    v_fmac_f32 v15, v58, v58
    ds_read_b128 v[32:35], v11 offset:9216
    ds_read_b128 v[36:39], v11 offset:37888
    ds_read_b128 v[40:43], v10 offset:9216
    s_waitcnt vmcnt(19) lgkmcnt(3)
    v_mfma_f32_32x32x16_bf16 v[176:191], v[224:227], v[96:99], v[176:191]
    v_lshlrev_b32 v57, 16, v96
    v_and_b32 v58, 0xffff0000, v96
    v_add_f32 v14, v14, v57
    v_fmac_f32 v15, v57, v57
    v_add_f32 v14, v14, v58
    v_fmac_f32 v15, v58, v58
    v_lshlrev_b32 v57, 16, v97
    v_and_b32 v58, 0xffff0000, v97
    v_mfma_f32_32x32x16_bf16 v[192:207], v[228:231], v[96:99], v[192:207]
    v_add_f32 v14, v14, v57
    v_fmac_f32 v15, v57, v57
    v_add_f32 v14, v14, v58
    v_fmac_f32 v15, v58, v58
    v_lshlrev_b32 v57, 16, v98
    v_and_b32 v58, 0xffff0000, v98
    v_add_f32 v14, v14, v57
    v_fmac_f32 v15, v57, v57
    v_mfma_f32_32x32x16_bf16 v[208:223], v[96:99], v[232:235], v[208:223]
    v_add_f32 v14, v14, v58
    v_fmac_f32 v15, v58, v58
    v_lshlrev_b32 v57, 16, v99
    v_and_b32 v58, 0xffff0000, v99
    v_add_f32 v14, v14, v57
    v_fmac_f32 v15, v57, v57
    v_add_f32 v14, v14, v58
    v_fmac_f32 v15, v58, v58
    ds_read_b128 v[224:227], v11 offset:10240
    ds_read_b128 v[228:231], v11 offset:38912
    ds_read_b128 v[232:235], v10 offset:10240
    s_waitcnt vmcnt(18) lgkmcnt(3)
    v_mfma_f32_32x32x16_bf16 v[176:191], v[32:35], v[100:103], v[176:191]
    v_lshlrev_b32 v57, 16, v100
    v_and_b32 v58, 0xffff0000, v100
    v_add_f32 v14, v14, v57
    v_fmac_f32 v15, v57, v57
    v_add_f32 v14, v14, v58
    v_fmac_f32 v15, v58, v58
    v_lshlrev_b32 v57, 16, v101
    v_and_b32 v58, 0xffff0000, v101
    v_mfma_f32_32x32x16_bf16 v[192:207], v[36:39], v[100:103], v[192:207]
    v_add_f32 v14, v14, v57
    v_fmac_f32 v15, v57, v57
    v_add_f32 v14, v14, v58
    v_fmac_f32 v15, v58, v58
    v_lshlrev_b32 v57, 16, v102
    v_and_b32 v58, 0xffff0000, v102
    v_add_f32 v14, v14, v57
    v_fmac_f32 v15, v57, v57
    v_mfma_f32_32x32x16_bf16 v[208:223], v[100:103], v[40:43], v[208:223]
    v_add_f32 v14, v14, v58
    v_fmac_f32 v15, v58, v58
    v_lshlrev_b32 v57, 16, v103
    v_and_b32 v58, 0xffff0000, v103
    v_add_f32 v14, v14, v57
    v_fmac_f32 v15, v57, v57
    v_add_f32 v14, v14, v58
    v_fmac_f32 v15, v58, v58
    ds_read_b128 v[32:35], v11 offset:11264
    ds_read_b128 v[36:39], v11 offset:39936
    ds_read_b128 v[40:43], v10 offset:11264
    s_waitcnt vmcnt(17) lgkmcnt(3)
    v_mfma_f32_32x32x16_bf16 v[176:191], v[224:227], v[104:107], v[176:191]
    v_lshlrev_b32 v57, 16, v104
    v_and_b32 v58, 0xffff0000, v104
    v_add_f32 v14, v14, v57
    v_fmac_f32 v15, v57, v57
    v_add_f32 v14, v14, v58
    v_fmac_f32 v15, v58, v58
    v_lshlrev_b32 v57, 16, v105
    v_and_b32 v58, 0xffff0000, v105
    v_mfma_f32_32x32x16_bf16 v[192:207], v[228:231], v[104:107], v[192:207]
    v_add_f32 v14, v14, v57
    v_fmac_f32 v15, v57, v57
    v_add_f32 v14, v14, v58
    v_fmac_f32 v15, v58, v58
    v_lshlrev_b32 v57, 16, v106
    v_and_b32 v58, 0xffff0000, v106
    v_add_f32 v14, v14, v57
    v_fmac_f32 v15, v57, v57
    v_mfma_f32_32x32x16_bf16 v[208:223], v[104:107], v[232:235], v[208:223]
    v_add_f32 v14, v14, v58
    v_fmac_f32 v15, v58, v58
    v_lshlrev_b32 v57, 16, v107
    v_and_b32 v58, 0xffff0000, v107
    v_add_f32 v14, v14, v57
    v_fmac_f32 v15, v57, v57
    v_add_f32 v14, v14, v58
    v_fmac_f32 v15, v58, v58
    ds_read_b128 v[224:227], v11 offset:12288
    ds_read_b128 v[228:231], v11 offset:40960
    ds_read_b128 v[232:235], v10 offset:12288
    s_waitcnt vmcnt(16) lgkmcnt(3)
    v_mfma_f32_32x32x16_bf16 v[176:191], v[32:35], v[108:111], v[176:191]
    v_lshlrev_b32 v57, 16, v108
    v_and_b32 v58, 0xffff0000, v108
    v_add_f32 v14, v14, v57
    v_fmac_f32 v15, v57, v57
    v_add_f32 v14, v14, v58
    v_fmac_f32 v15, v58, v58
    v_lshlrev_b32 v57, 16, v109
    v_and_b32 v58, 0xffff0000, v109
    v_mfma_f32_32x32x16_bf16 v[192:207], v[36:39], v[108:111], v[192:207]
    v_add_f32 v14, v14, v57
    v_fmac_f32 v15, v57, v57
    v_add_f32 v14, v14, v58
    v_fmac_f32 v15, v58, v58
    v_lshlrev_b32 v57, 16, v110
    v_and_b32 v58, 0xffff0000, v110
    v_add_f32 v14, v14, v57
    v_fmac_f32 v15, v57, v57
    v_mfma_f32_32x32x16_bf16 v[208:223], v[108:111], v[40:43], v[208:223]
    v_add_f32 v14, v14, v58
    v_fmac_f32 v15, v58, v58
    v_lshlrev_b32 v57, 16, v111
    v_and_b32 v58, 0xffff0000, v111
    v_add_f32 v14, v14, v57
    v_fmac_f32 v15, v57, v57
    v_add_f32 v14, v14, v58
    v_fmac_f32 v15, v58, v58
    ds_read_b128 v[32:35], v11 offset:13312
    ds_read_b128 v[36:39], v11 offset:41984
    ds_read_b128 v[40:43], v10 offset:13312
    s_waitcnt vmcnt(15) lgkmcnt(3)
    v_mfma_f32_32x32x16_bf16 v[176:191], v[224:227], v[112:115], v[176:191]
    v_lshlrev_b32 v57, 16, v112
    v_and_b32 v58, 0xffff0000, v112
    v_add_f32 v14, v14, v57
    v_fmac_f32 v15, v57, v57
    v_add_f32 v14, v14, v58
    v_fmac_f32 v15, v58, v58
    v_lshlrev_b32 v57, 16, v113
    v_and_b32 v58, 0xffff0000, v113
    v_mfma_f32_32x32x16_bf16 v[192:207], v[228:231], v[112:115], v[192:207]
    v_add_f32 v14, v14, v57
    v_fmac_f32 v15, v57, v57
    v_add_f32 v14, v14, v58
    v_fmac_f32 v15, v58, v58
    v_lshlrev_b32 v57, 16, v114
    v_and_b32 v58, 0xffff0000, v114
    v_add_f32 v14, v14, v57
    v_fmac_f32 v15, v57, v57
    v_mfma_f32_32x32x16_bf16 v[208:223], v[112:115], v[232:235], v[208:223]
    v_add_f32 v14, v14, v58
    v_fmac_f32 v15, v58, v58
    v_lshlrev_b32 v57, 16, v115
    v_and_b32 v58, 0xffff0000, v115
    v_add_f32 v14, v14, v57
    v_fmac_f32 v15, v57, v57
    v_add_f32 v14, v14, v58
    v_fmac_f32 v15, v58, v58
    ds_read_b128 v[224:227], v11 offset:14336
    ds_read_b128 v[228:231], v11 offset:43008
    ds_read_b128 v[232:235], v10 offset:14336
    s_waitcnt vmcnt(14) lgkmcnt(3)
    v_mfma_f32_32x32x16_bf16 v[176:191], v[32:35], v[116:119], v[176:191]
    v_lshlrev_b32 v57, 16, v116
    v_and_b32 v58, 0xffff0000, v116
    v_add_f32 v14, v14, v57
    v_fmac_f32 v15, v57, v57
    v_add_f32 v14, v14, v58
    v_fmac_f32 v15, v58, v58
    v_lshlrev_b32 v57, 16, v117
    v_and_b32 v58, 0xffff0000, v117
    v_mfma_f32_32x32x16_bf16 v[192:207], v[36:39], v[116:119], v[192:207]
    v_add_f32 v14, v14, v57
    v_fmac_f32 v15, v57, v57
    v_add_f32 v14, v14, v58
    v_fmac_f32 v15, v58, v58
    v_lshlrev_b32 v57, 16, v118
    v_and_b32 v58, 0xffff0000, v118
    v_add_f32 v14, v14, v57
    v_fmac_f32 v15, v57, v57
    v_mfma_f32_32x32x16_bf16 v[208:223], v[116:119], v[40:43], v[208:223]
    v_add_f32 v14, v14, v58
    v_fmac_f32 v15, v58, v58
    v_lshlrev_b32 v57, 16, v119
    v_and_b32 v58, 0xffff0000, v119
    v_add_f32 v14, v14, v57
    v_fmac_f32 v15, v57, v57
    v_add_f32 v14, v14, v58
    v_fmac_f32 v15, v58, v58
    ds_read_b128 v[32:35], v11 offset:15360
    ds_read_b128 v[36:39], v11 offset:44032
    ds_read_b128 v[40:43], v10 offset:15360
    s_waitcnt vmcnt(13) lgkmcnt(3)
    v_mfma_f32_32x32x16_bf16 v[176:191], v[224:227], v[120:123], v[176:191]
    v_lshlrev_b32 v57, 16, v120
    v_and_b32 v58, 0xffff0000, v120
    v_add_f32 v14, v14, v57
    v_fmac_f32 v15, v57, v57
    v_add_f32 v14, v14, v58
    v_fmac_f32 v15, v58, v58
    v_lshlrev_b32 v57, 16, v121
    v_and_b32 v58, 0xffff0000, v121
    v_mfma_f32_32x32x16_bf16 v[192:207], v[228:231], v[120:123], v[192:207]
    v_add_f32 v14, v14, v57
    v_fmac_f32 v15, v57, v57
    v_add_f32 v14, v14, v58
    v_fmac_f32 v15, v58, v58
    v_lshlrev_b32 v57, 16, v122
    v_and_b32 v58, 0xffff0000, v122
    v_add_f32 v14, v14, v57
    v_fmac_f32 v15, v57, v57
    v_mfma_f32_32x32x16_bf16 v[208:223], v[120:123], v[232:235], v[208:223]
    v_add_f32 v14, v14, v58
    v_fmac_f32 v15, v58, v58
    v_lshlrev_b32 v57, 16, v123
    v_and_b32 v58, 0xffff0000, v123
    v_add_f32 v14, v14, v57
    v_fmac_f32 v15, v57, v57
    v_add_f32 v14, v14, v58
    v_fmac_f32 v15, v58, v58
    ds_read_b128 v[224:227], v11 offset:16384
    ds_read_b128 v[228:231], v11 offset:45056
    ds_read_b128 v[232:235], v10 offset:16384
    s_waitcnt vmcnt(12) lgkmcnt(3)
    v_mfma_f32_32x32x16_bf16 v[176:191], v[32:35], v[124:127], v[176:191]
    v_lshlrev_b32 v57, 16, v124
    v_and_b32 v58, 0xffff0000, v124
    v_add_f32 v14, v14, v57
    v_fmac_f32 v15, v57, v57
    v_add_f32 v14, v14, v58
    v_fmac_f32 v15, v58, v58
    v_lshlrev_b32 v57, 16, v125
    v_and_b32 v58, 0xffff0000, v125
    v_mfma_f32_32x32x16_bf16 v[192:207], v[36:39], v[124:127], v[192:207]
    v_add_f32 v14, v14, v57
    v_fmac_f32 v15, v57, v57
    v_add_f32 v14, v14, v58
    v_fmac_f32 v15, v58, v58
    v_lshlrev_b32 v57, 16, v126
    v_and_b32 v58, 0xffff0000, v126
    v_add_f32 v14, v14, v57
    v_fmac_f32 v15, v57, v57
    v_mfma_f32_32x32x16_bf16 v[208:223], v[124:127], v[40:43], v[208:223]
    v_add_f32 v14, v14, v58
    v_fmac_f32 v15, v58, v58
    v_lshlrev_b32 v57, 16, v127
    v_and_b32 v58, 0xffff0000, v127
    v_add_f32 v14, v14, v57
    v_fmac_f32 v15, v57, v57
    v_add_f32 v14, v14, v58
    v_fmac_f32 v15, v58, v58
    ds_read_b128 v[32:35], v11 offset:17408
    ds_read_b128 v[36:39], v11 offset:46080
    ds_read_b128 v[40:43], v10 offset:17408
    s_waitcnt vmcnt(11) lgkmcnt(3)
    v_mfma_f32_32x32x16_bf16 v[176:191], v[224:227], v[128:131], v[176:191]
    v_lshlrev_b32 v57, 16, v128
    v_and_b32 v58, 0xffff0000, v128
    v_add_f32 v14, v14, v57
    v_fmac_f32 v15, v57, v57
    v_add_f32 v14, v14, v58
    v_fmac_f32 v15, v58, v58
    v_lshlrev_b32 v57, 16, v129
    v_and_b32 v58, 0xffff0000, v129
    v_mfma_f32_32x32x16_bf16 v[192:207], v[228:231], v[128:131], v[192:207]
    v_add_f32 v14, v14, v57
    v_fmac_f32 v15, v57, v57
    v_add_f32 v14, v14, v58
    v_fmac_f32 v15, v58, v58
    v_lshlrev_b32 v57, 16, v130
    v_and_b32 v58, 0xffff0000, v130
    v_add_f32 v14, v14, v57
    v_fmac_f32 v15, v57, v57
    v_mfma_f32_32x32x16_bf16 v[208:223], v[128:131], v[232:235], v[208:223]
    v_add_f32 v14, v14, v58
    v_fmac_f32 v15, v58, v58
    v_lshlrev_b32 v57, 16, v131
    v_and_b32 v58, 0xffff0000, v131
    v_add_f32 v14, v14, v57
    v_fmac_f32 v15, v57, v57
    v_add_f32 v14, v14, v58
    v_fmac_f32 v15, v58, v58
    ds_read_b128 v[224:227], v11 offset:18432
    ds_read_b128 v[228:231], v11 offset:47104
    ds_read_b128 v[232:235], v10 offset:18432
    s_waitcnt vmcnt(10) lgkmcnt(3)
    v_mfma_f32_32x32x16_bf16 v[176:191], v[32:35], v[132:135], v[176:191]
    v_lshlrev_b32 v57, 16, v132
    v_and_b32 v58, 0xffff0000, v132
    v_add_f32 v14, v14, v57
    v_fmac_f32 v15, v57, v57
    v_add_f32 v14, v14, v58
    v_fmac_f32 v15, v58, v58
    v_lshlrev_b32 v57, 16, v133
    v_and_b32 v58, 0xffff0000, v133
    v_mfma_f32_32x32x16_bf16 v[192:207], v[36:39], v[132:135], v[192:207]
    v_add_f32 v14, v14, v57
    v_fmac_f32 v15, v57, v57
    v_add_f32 v14, v14, v58
    v_fmac_f32 v15, v58, v58
    v_lshlrev_b32 v57, 16, v134
    v_and_b32 v58, 0xffff0000, v134
    v_add_f32 v14, v14, v57
    v_fmac_f32 v15, v57, v57
    v_mfma_f32_32x32x16_bf16 v[208:223], v[132:135], v[40:43], v[208:223]
    v_add_f32 v14, v14, v58
    v_fmac_f32 v15, v58, v58
    v_lshlrev_b32 v57, 16, v135
    v_and_b32 v58, 0xffff0000, v135
    v_add_f32 v14, v14, v57
    v_fmac_f32 v15, v57, v57
    v_add_f32 v14, v14, v58
    v_fmac_f32 v15, v58, v58
    ds_read_b128 v[32:35], v11 offset:19456
    ds_read_b128 v[36:39], v11 offset:48128
    ds_read_b128 v[40:43], v10 offset:19456
    s_waitcnt vmcnt(9) lgkmcnt(3)
    v_mfma_f32_32x32x16_bf16 v[176:191], v[224:227], v[136:139], v[176:191]
    v_lshlrev_b32 v57, 16, v136
    v_and_b32 v58, 0xffff0000, v136
    v_add_f32 v14, v14, v57
    v_fmac_f32 v15, v57, v57
    v_add_f32 v14, v14, v58
    v_fmac_f32 v15, v58, v58
    v_lshlrev_b32 v57, 16, v137
    v_and_b32 v58, 0xffff0000, v137
    v_mfma_f32_32x32x16_bf16 v[192:207], v[228:231], v[136:139], v[192:207]
    v_add_f32 v14, v14, v57
    v_fmac_f32 v15, v57, v57
    v_add_f32 v14, v14, v58
    v_fmac_f32 v15, v58, v58
    v_lshlrev_b32 v57, 16, v138
    v_and_b32 v58, 0xffff0000, v138
    v_add_f32 v14, v14, v57
    v_fmac_f32 v15, v57, v57
    v_mfma_f32_32x32x16_bf16 v[208:223], v[136:139], v[232:235], v[208:223]
    v_add_f32 v14, v14, v58
    v_fmac_f32 v15, v58, v58
    v_lshlrev_b32 v57, 16, v139
    v_and_b32 v58, 0xffff0000, v139
    v_add_f32 v14, v14, v57
    v_fmac_f32 v15, v57, v57
    v_add_f32 v14, v14, v58
    v_fmac_f32 v15, v58, v58
    ds_read_b128 v[224:227], v11 offset:20480
    ds_read_b128 v[228:231], v11 offset:49152
    ds_read_b128 v[232:235], v10 offset:20480
    s_waitcnt vmcnt(8) lgkmcnt(3)
    v_mfma_f32_32x32x16_bf16 v[176:191], v[32:35], v[140:143], v[176:191]
    v_lshlrev_b32 v57, 16, v140
    v_and_b32 v58, 0xffff0000, v140
    v_add_f32 v14, v14, v57
    v_fmac_f32 v15, v57, v57
    v_add_f32 v14, v14, v58
    v_fmac_f32 v15, v58, v58
    v_lshlrev_b32 v57, 16, v141
    v_and_b32 v58, 0xffff0000, v141
    v_mfma_f32_32x32x16_bf16 v[192:207], v[36:39], v[140:143], v[192:207]
    v_add_f32 v14, v14, v57
    v_fmac_f32 v15, v57, v57
    v_add_f32 v14, v14, v58
    v_fmac_f32 v15, v58, v58
    v_lshlrev_b32 v57, 16, v142
    v_and_b32 v58, 0xffff0000, v142
    v_add_f32 v14, v14, v57
    v_fmac_f32 v15, v57, v57
    v_mfma_f32_32x32x16_bf16 v[208:223], v[140:143], v[40:43], v[208:223]
    v_add_f32 v14, v14, v58
    v_fmac_f32 v15, v58, v58
    v_lshlrev_b32 v57, 16, v143
    v_and_b32 v58, 0xffff0000, v143
    v_add_f32 v14, v14, v57
    v_fmac_f32 v15, v57, v57
    v_add_f32 v14, v14, v58
    v_fmac_f32 v15, v58, v58
    ds_read_b128 v[32:35], v11 offset:21504
    ds_read_b128 v[36:39], v11 offset:50176
    ds_read_b128 v[40:43], v10 offset:21504
    s_waitcnt vmcnt(7) lgkmcnt(3)
    v_mfma_f32_32x32x16_bf16 v[176:191], v[224:227], v[144:147], v[176:191]
    v_lshlrev_b32 v57, 16, v144
    v_and_b32 v58, 0xffff0000, v144
    v_add_f32 v14, v14, v57
    v_fmac_f32 v15, v57, v57
    v_add_f32 v14, v14, v58
    v_fmac_f32 v15, v58, v58
    v_lshlrev_b32 v57, 16, v145
    v_and_b32 v58, 0xffff0000, v145
    v_mfma_f32_32x32x16_bf16 v[192:207], v[228:231], v[144:147], v[192:207]
    v_add_f32 v14, v14, v57
    v_fmac_f32 v15, v57, v57
    v_add_f32 v14, v14, v58
    v_fmac_f32 v15, v58, v58
    v_lshlrev_b32 v57, 16, v146
    v_and_b32 v58, 0xffff0000, v146
    v_add_f32 v14, v14, v57
    v_fmac_f32 v15, v57, v57
    v_mfma_f32_32x32x16_bf16 v[208:223], v[144:147], v[232:235], v[208:223]
    v_add_f32 v14, v14, v58
    v_fmac_f32 v15, v58, v58
    v_lshlrev_b32 v57, 16, v147
    v_and_b32 v58, 0xffff0000, v147
    v_add_f32 v14, v14, v57
    v_fmac_f32 v15, v57, v57
    v_add_f32 v14, v14, v58
    v_fmac_f32 v15, v58, v58
    ds_read_b128 v[224:227], v11 offset:22528
    ds_read_b128 v[228:231], v11 offset:51200
    ds_read_b128 v[232:235], v10 offset:22528
    s_waitcnt vmcnt(6) lgkmcnt(3)
    v_mfma_f32_32x32x16_bf16 v[176:191], v[32:35], v[148:151], v[176:191]
    v_lshlrev_b32 v57, 16, v148
    v_and_b32 v58, 0xffff0000, v148
    v_add_f32 v14, v14, v57
    v_fmac_f32 v15, v57, v57
    v_add_f32 v14, v14, v58
    v_fmac_f32 v15, v58, v58
    v_lshlrev_b32 v57, 16, v149
    v_and_b32 v58, 0xffff0000, v149
    v_mfma_f32_32x32x16_bf16 v[192:207], v[36:39], v[148:151], v[192:207]
    v_add_f32 v14, v14, v57
    v_fmac_f32 v15, v57, v57
    v_add_f32 v14, v14, v58
    v_fmac_f32 v15, v58, v58
    v_lshlrev_b32 v57, 16, v150
    v_and_b32 v58, 0xffff0000, v150
    v_add_f32 v14, v14, v57
    v_fmac_f32 v15, v57, v57
    v_mfma_f32_32x32x16_bf16 v[208:223], v[148:151], v[40:43], v[208:223]
    v_add_f32 v14, v14, v58
    v_fmac_f32 v15, v58, v58
    v_lshlrev_b32 v57, 16, v151
    v_and_b32 v58, 0xffff0000, v151
    v_add_f32 v14, v14, v57
    v_fmac_f32 v15, v57, v57
    v_add_f32 v14, v14, v58
    v_fmac_f32 v15, v58, v58
    ds_read_b128 v[32:35], v11 offset:23552
    ds_read_b128 v[36:39], v11 offset:52224
    ds_read_b128 v[40:43], v10 offset:23552
    s_waitcnt vmcnt(5) lgkmcnt(3)
    v_mfma_f32_32x32x16_bf16 v[176:191], v[224:227], v[152:155], v[176:191]
    v_lshlrev_b32 v57, 16, v152
    v_and_b32 v58, 0xffff0000, v152
    v_add_f32 v14, v14, v57
    v_fmac_f32 v15, v57, v57
    v_add_f32 v14, v14, v58
    v_fmac_f32 v15, v58, v58
    v_lshlrev_b32 v57, 16, v153
    v_and_b32 v58, 0xffff0000, v153
    v_mfma_f32_32x32x16_bf16 v[192:207], v[228:231], v[152:155], v[192:207]
    v_add_f32 v14, v14, v57
    v_fmac_f32 v15, v57, v57
    v_add_f32 v14, v14, v58
    v_fmac_f32 v15, v58, v58
    v_lshlrev_b32 v57, 16, v154
    v_and_b32 v58, 0xffff0000, v154
    v_add_f32 v14, v14, v57
    v_fmac_f32 v15, v57, v57
    v_mfma_f32_32x32x16_bf16 v[208:223], v[152:155], v[232:235], v[208:223]
    v_add_f32 v14, v14, v58
    v_fmac_f32 v15, v58, v58
    v_lshlrev_b32 v57, 16, v155
    v_and_b32 v58, 0xffff0000, v155
    v_add_f32 v14, v14, v57
    v_fmac_f32 v15, v57, v57
    v_add_f32 v14, v14, v58
    v_fmac_f32 v15, v58, v58
    ds_read_b128 v[224:227], v11 offset:24576
    ds_read_b128 v[228:231], v11 offset:53248
    ds_read_b128 v[232:235], v10 offset:24576
    s_waitcnt vmcnt(4) lgkmcnt(3)
    v_mfma_f32_32x32x16_bf16 v[176:191], v[32:35], v[156:159], v[176:191]
    v_lshlrev_b32 v57, 16, v156
    v_and_b32 v58, 0xffff0000, v156
    v_add_f32 v14, v14, v57
    v_fmac_f32 v15, v57, v57
    v_add_f32 v14, v14, v58
    v_fmac_f32 v15, v58, v58
    v_lshlrev_b32 v57, 16, v157
    v_and_b32 v58, 0xffff0000, v157
    v_mfma_f32_32x32x16_bf16 v[192:207], v[36:39], v[156:159], v[192:207]
    v_add_f32 v14, v14, v57
    v_fmac_f32 v15, v57, v57
    v_add_f32 v14, v14, v58
    v_fmac_f32 v15, v58, v58
    v_lshlrev_b32 v57, 16, v158
    v_and_b32 v58, 0xffff0000, v158
    v_add_f32 v14, v14, v57
    v_fmac_f32 v15, v57, v57
    v_mfma_f32_32x32x16_bf16 v[208:223], v[156:159], v[40:43], v[208:223]
    v_add_f32 v14, v14, v58
    v_fmac_f32 v15, v58, v58
    v_lshlrev_b32 v57, 16, v159
    v_and_b32 v58, 0xffff0000, v159
    v_add_f32 v14, v14, v57
    v_fmac_f32 v15, v57, v57
    v_add_f32 v14, v14, v58
    v_fmac_f32 v15, v58, v58
    ds_read_b128 v[32:35], v11 offset:25600
    ds_read_b128 v[36:39], v11 offset:54272
    ds_read_b128 v[40:43], v10 offset:25600
    s_waitcnt vmcnt(3) lgkmcnt(3)
    v_mfma_f32_32x32x16_bf16 v[176:191], v[224:227], v[160:163], v[176:191]
    v_lshlrev_b32 v57, 16, v160
    v_and_b32 v58, 0xffff0000, v160
    v_add_f32 v14, v14, v57
    v_fmac_f32 v15, v57, v57
    v_add_f32 v14, v14, v58
    v_fmac_f32 v15, v58, v58
    v_lshlrev_b32 v57, 16, v161
    v_and_b32 v58, 0xffff0000, v161
    v_mfma_f32_32x32x16_bf16 v[192:207], v[228:231], v[160:163], v[192:207]
    v_add_f32 v14, v14, v57
    v_fmac_f32 v15, v57, v57
    v_add_f32 v14, v14, v58
    v_fmac_f32 v15, v58, v58
    v_lshlrev_b32 v57, 16, v162
    v_and_b32 v58, 0xffff0000, v162
    v_add_f32 v14, v14, v57
    v_fmac_f32 v15, v57, v57
    v_mfma_f32_32x32x16_bf16 v[208:223], v[160:163], v[232:235], v[208:223]
    v_add_f32 v14, v14, v58
    v_fmac_f32 v15, v58, v58
    v_lshlrev_b32 v57, 16, v163
    v_and_b32 v58, 0xffff0000, v163
    v_add_f32 v14, v14, v57
    v_fmac_f32 v15, v57, v57
    v_add_f32 v14, v14, v58
    v_fmac_f32 v15, v58, v58
    ds_read_b128 v[224:227], v11 offset:26624
    ds_read_b128 v[228:231], v11 offset:55296
    ds_read_b128 v[232:235], v10 offset:26624
    s_waitcnt vmcnt(2) lgkmcnt(3)
    v_mfma_f32_32x32x16_bf16 v[176:191], v[32:35], v[164:167], v[176:191]
    v_lshlrev_b32 v57, 16, v164
    v_and_b32 v58, 0xffff0000, v164
    v_add_f32 v14, v14, v57
    v_fmac_f32 v15, v57, v57
    v_add_f32 v14, v14, v58
    v_fmac_f32 v15, v58, v58
    v_lshlrev_b32 v57, 16, v165
    v_and_b32 v58, 0xffff0000, v165
    v_mfma_f32_32x32x16_bf16 v[192:207], v[36:39], v[164:167], v[192:207]
    v_add_f32 v14, v14, v57
    v_fmac_f32 v15, v57, v57
    v_add_f32 v14, v14, v58
    v_fmac_f32 v15, v58, v58
    v_lshlrev_b32 v57, 16, v166
    v_and_b32 v58, 0xffff0000, v166
    v_add_f32 v14, v14, v57
    v_fmac_f32 v15, v57, v57
    v_mfma_f32_32x32x16_bf16 v[208:223], v[164:167], v[40:43], v[208:223]
    v_add_f32 v14, v14, v58
    v_fmac_f32 v15, v58, v58
    v_lshlrev_b32 v57, 16, v167
    v_and_b32 v58, 0xffff0000, v167
    v_add_f32 v14, v14, v57
    v_fmac_f32 v15, v57, v57
    v_add_f32 v14, v14, v58
    v_fmac_f32 v15, v58, v58
    ds_read_b128 v[32:35], v11 offset:27648
    ds_read_b128 v[36:39], v11 offset:56320
    ds_read_b128 v[40:43], v10 offset:27648
    s_waitcnt vmcnt(1) lgkmcnt(3)
    v_mfma_f32_32x32x16_bf16 v[176:191], v[224:227], v[168:171], v[176:191]
    v_lshlrev_b32 v57, 16, v168
    v_and_b32 v58, 0xffff0000, v168
    v_add_f32 v14, v14, v57
    v_fmac_f32 v15, v57, v57
    v_add_f32 v14, v14, v58
    v_fmac_f32 v15, v58, v58
    v_lshlrev_b32 v57, 16, v169
    v_and_b32 v58, 0xffff0000, v169
    v_mfma_f32_32x32x16_bf16 v[192:207], v[228:231], v[168:171], v[192:207]
    v_add_f32 v14, v14, v57
    v_fmac_f32 v15, v57, v57
    v_add_f32 v14, v14, v58
    v_fmac_f32 v15, v58, v58
    v_lshlrev_b32 v57, 16, v170
    v_and_b32 v58, 0xffff0000, v170
    v_add_f32 v14, v14, v57
    v_fmac_f32 v15, v57, v57
    v_mfma_f32_32x32x16_bf16 v[208:223], v[168:171], v[232:235], v[208:223]
    v_add_f32 v14, v14, v58
    v_fmac_f32 v15, v58, v58
    v_lshlrev_b32 v57, 16, v171
    v_and_b32 v58, 0xffff0000, v171
    v_add_f32 v14, v14, v57
    v_fmac_f32 v15, v57, v57
    v_add_f32 v14, v14, v58
    v_fmac_f32 v15, v58, v58
    s_waitcnt vmcnt(0) lgkmcnt(0)
    v_mfma_f32_32x32x16_bf16 v[176:191], v[32:35], v[172:175], v[176:191]
    v_lshlrev_b32 v57, 16, v172
    v_and_b32 v58, 0xffff0000, v172
    v_add_f32 v14, v14, v57
    v_fmac_f32 v15, v57, v57
    v_add_f32 v14, v14, v58
    v_fmac_f32 v15, v58, v58
    v_lshlrev_b32 v57, 16, v173
    v_and_b32 v58, 0xffff0000, v173
    v_mfma_f32_32x32x16_bf16 v[192:207], v[36:39], v[172:175], v[192:207]
    v_add_f32 v14, v14, v57
    v_fmac_f32 v15, v57, v57
    v_add_f32 v14, v14, v58
    v_fmac_f32 v15, v58, v58
    v_lshlrev_b32 v57, 16, v174
    v_and_b32 v58, 0xffff0000, v174
    v_add_f32 v14, v14, v57
    v_fmac_f32 v15, v57, v57
    v_mfma_f32_32x32x16_bf16 v[208:223], v[172:175], v[40:43], v[208:223]
    v_add_f32 v14, v14, v58
    v_fmac_f32 v15, v58, v58
    v_lshlrev_b32 v57, 16, v175
    v_and_b32 v58, 0xffff0000, v175
    v_add_f32 v14, v14, v57
    v_fmac_f32 v15, v57, v57
    v_add_f32 v14, v14, v58
    v_fmac_f32 v15, v58, v58
    v_mov_b32 v57, v14
    s_nop 1
    v_permlane32_swap_b32 v14, v57
    s_nop 0
    v_add_f32 v14, v14, v57
    v_mov_b32 v57, v15
    s_nop 1
    v_permlane32_swap_b32 v15, v57
    s_nop 0
    v_add_f32 v15, v15, v57
    v_mul_f32 v14, 0x3b124925, v14
    v_mul_f32 v15, 0x3b124925, v15
    v_fma_f32 v15, -v14, v14, v15
    v_max_f32 v15, 0, v15
    v_add_f32 v15, 0x3727c5ac, v15
    v_rsq_f32 v59, v15
    s_nop 0
    v_mul_f32 v58, v14, v59
    v_sub_f32 v58, 0, v58
    v_lshlrev_b32 v12, 2, v3
    v_add_u32 v12, s13, v12
    ds_write_b32 v12, v59 offset:4096
    ds_write_b32 v12, v58 offset:4224
    v_lshlrev_b32 v13, 4, v4
    v_add_u32 v13, s13, v13
    s_nop 7
    v_mul_f32 v64, v58, v16
    v_fma_f32 v64, v192, v59, v64
    v_mul_f32 v65, v58, v17
    v_fma_f32 v65, v193, v59, v65
    v_mul_f32 v66, v58, v18
    v_fma_f32 v66, v194, v59, v66
    v_mul_f32 v67, v58, v19
    v_fma_f32 v67, v195, v59, v67
    v_mul_f32 v68, v58, v20
    v_fma_f32 v68, v196, v59, v68
    v_mul_f32 v69, v58, v21
    v_fma_f32 v69, v197, v59, v69
    v_mul_f32 v70, v58, v22
    v_fma_f32 v70, v198, v59, v70
    v_mul_f32 v71, v58, v23
    v_fma_f32 v71, v199, v59, v71
    v_mul_f32 v72, v58, v24
    v_fma_f32 v72, v200, v59, v72
    v_mul_f32 v73, v58, v25
    v_fma_f32 v73, v201, v59, v73
    v_mul_f32 v74, v58, v26
    v_fma_f32 v74, v202, v59, v74
    v_mul_f32 v75, v58, v27
    v_fma_f32 v75, v203, v59, v75
    v_mul_f32 v76, v58, v28
    v_fma_f32 v76, v204, v59, v76
    v_mul_f32 v77, v58, v29
    v_fma_f32 v77, v205, v59, v77
    v_mul_f32 v78, v58, v30
    v_fma_f32 v78, v206, v59, v78
    v_mul_f32 v79, v58, v31
    v_fma_f32 v79, v207, v59, v79
    v_cvt_pk_bf16_f32 v80, v64, v65
    v_cvt_pk_bf16_f32 v81, v66, v67
    v_cvt_pk_bf16_f32 v82, v68, v69
    v_cvt_pk_bf16_f32 v83, v70, v71
    v_cvt_pk_bf16_f32 v84, v72, v73
    v_cvt_pk_bf16_f32 v85, v74, v75
    v_cvt_pk_bf16_f32 v86, v76, v77
    v_cvt_pk_bf16_f32 v87, v78, v79
    s_nop 1
    v_mfma_f32_32x32x16_bf16 v[96:111], v[48:51], v[80:83], 0
    v_mfma_f32_32x32x16_bf16 v[96:111], v[52:55], v[84:87], v[96:111]
    v_mov_b32 v24, 0xff7fffff
    v_mov_b32 v25, 0x7f7fffff
    s_nop 13
    v_cndmask_b32 v26, v108, v24, s[60:61]
    v_cndmask_b32 v144, v108, v25, s[60:61]
    v_cndmask_b32 v27, v109, v24, s[60:61]
    v_cndmask_b32 v145, v109, v25, s[60:61]
    v_cndmask_b32 v28, v110, v24, s[60:61]
    v_cndmask_b32 v146, v110, v25, s[60:61]
    v_cndmask_b32 v29, v111, v24, s[60:61]
    v_cndmask_b32 v147, v111, v25, s[60:61]
    v_max3_f32 v30, v96, v97, v98
    v_min3_f32 v31, v96, v97, v98
    v_max3_f32 v30, v99, v100, v30
    v_min3_f32 v31, v99, v100, v31
    v_max3_f32 v30, v101, v102, v30
    v_min3_f32 v31, v101, v102, v31
    v_max3_f32 v30, v103, v104, v30
    v_min3_f32 v31, v103, v104, v31
    v_max3_f32 v30, v105, v106, v30
    v_min3_f32 v31, v105, v106, v31
    v_max_f32 v30, v107, v30
    v_min_f32 v31, v107, v31
    v_max3_f32 v30, v26, v27, v30
    v_min3_f32 v31, v144, v145, v31
    v_max3_f32 v30, v28, v29, v30
    v_min3_f32 v31, v146, v147, v31
    v_mov_b32 v12, v30
    s_nop 1
    v_permlane32_swap_b32 v30, v12
    s_nop 0
    v_max_f32 v30, v30, v12
    v_mov_b32 v12, v31
    s_nop 1
    v_permlane32_swap_b32 v31, v12
    s_nop 0
    v_min_f32 v31, v31, v12
    v_mov_b32 v24, 0x3fb8aa3b
    v_mul_f32 v30, 0xbfb8aa3b, v30
    v_mul_f32 v31, 0x3fb8aa3b, v31
    v_fma_f32 v112, v96, v24, v30
    v_fma_f32 v128, -v96, v24, v31
    v_fma_f32 v113, v97, v24, v30
    v_fma_f32 v129, -v97, v24, v31
    v_fma_f32 v114, v98, v24, v30
    v_fma_f32 v130, -v98, v24, v31
    v_fma_f32 v115, v99, v24, v30
    v_fma_f32 v131, -v99, v24, v31
    v_fma_f32 v116, v100, v24, v30
    v_fma_f32 v132, -v100, v24, v31
    v_fma_f32 v117, v101, v24, v30
    v_fma_f32 v133, -v101, v24, v31
    v_fma_f32 v118, v102, v24, v30
    v_fma_f32 v134, -v102, v24, v31
    v_fma_f32 v119, v103, v24, v30
    v_fma_f32 v135, -v103, v24, v31
    v_fma_f32 v120, v104, v24, v30
    v_fma_f32 v136, -v104, v24, v31
    v_fma_f32 v121, v105, v24, v30
    v_fma_f32 v137, -v105, v24, v31
    v_fma_f32 v122, v106, v24, v30
    v_fma_f32 v138, -v106, v24, v31
    v_fma_f32 v123, v107, v24, v30
    v_fma_f32 v139, -v107, v24, v31
    v_fma_f32 v124, v108, v24, v30
    v_fma_f32 v140, -v108, v24, v31
    v_fma_f32 v125, v109, v24, v30
    v_fma_f32 v141, -v109, v24, v31
    v_fma_f32 v126, v110, v24, v30
    v_fma_f32 v142, -v110, v24, v31
    v_fma_f32 v127, v111, v24, v30
    v_fma_f32 v143, -v111, v24, v31
    v_exp_f32 v112, v112
    v_exp_f32 v128, v128
    v_exp_f32 v113, v113
    v_exp_f32 v129, v129
    v_exp_f32 v114, v114
    v_exp_f32 v130, v130
    v_exp_f32 v115, v115
    v_exp_f32 v131, v131
    v_exp_f32 v116, v116
    v_exp_f32 v132, v132
    v_exp_f32 v117, v117
    v_exp_f32 v133, v133
    v_exp_f32 v118, v118
    v_exp_f32 v134, v134
    v_exp_f32 v119, v119
    v_exp_f32 v135, v135
    v_exp_f32 v120, v120
    v_exp_f32 v136, v136
    v_exp_f32 v121, v121
    v_exp_f32 v137, v137
    v_exp_f32 v122, v122
    v_exp_f32 v138, v138
    v_exp_f32 v123, v123
    v_exp_f32 v139, v139
    v_exp_f32 v124, v124
    v_exp_f32 v140, v140
    v_exp_f32 v125, v125
    v_exp_f32 v141, v141
    v_exp_f32 v126, v126
    v_exp_f32 v142, v142
    v_exp_f32 v127, v127
    v_exp_f32 v143, v143
    s_nop 0
    v_cndmask_b32 v124, v124, 0, s[60:61]
    v_cndmask_b32 v140, v140, 0, s[60:61]
    v_cndmask_b32 v125, v125, 0, s[60:61]
    v_cndmask_b32 v141, v141, 0, s[60:61]
    v_cndmask_b32 v126, v126, 0, s[60:61]
    v_cndmask_b32 v142, v142, 0, s[60:61]
    v_cndmask_b32 v127, v127, 0, s[60:61]
    v_cndmask_b32 v143, v143, 0, s[60:61]
    v_add_f32 v30, v112, v113
    v_add_f32 v31, v128, v129
    v_add_f32 v30, v114, v30
    v_add_f32 v31, v130, v31
    v_add_f32 v30, v115, v30
    v_add_f32 v31, v131, v31
    v_add_f32 v30, v116, v30
    v_add_f32 v31, v132, v31
    v_add_f32 v30, v117, v30
    v_add_f32 v31, v133, v31
    v_add_f32 v30, v118, v30
    v_add_f32 v31, v134, v31
    v_add_f32 v30, v119, v30
    v_add_f32 v31, v135, v31
    v_add_f32 v30, v120, v30
    v_add_f32 v31, v136, v31
    v_add_f32 v30, v121, v30
    v_add_f32 v31, v137, v31
    v_add_f32 v30, v122, v30
    v_add_f32 v31, v138, v31
    v_add_f32 v30, v123, v30
    v_add_f32 v31, v139, v31
    v_add_f32 v30, v124, v30
    v_add_f32 v31, v140, v31
    v_add_f32 v30, v125, v30
    v_add_f32 v31, v141, v31
    v_add_f32 v30, v126, v30
    v_add_f32 v31, v142, v31
    v_add_f32 v30, v127, v30
    v_add_f32 v31, v143, v31
    v_mov_b32 v12, v30
    s_nop 1
    v_permlane32_swap_b32 v30, v12
    s_nop 0
    v_add_f32 v30, v30, v12
    v_mov_b32 v12, v31
    s_nop 1
    v_permlane32_swap_b32 v31, v12
    s_nop 0
    v_add_f32 v31, v31, v12
    v_rcp_f32 v30, v30
    v_rcp_f32 v31, v31
    s_nop 0
    v_mul_f32 v112, v30, v112
    v_mul_f32 v128, v31, v128
    v_mul_f32 v113, v30, v113
    v_mul_f32 v129, v31, v129
    v_mul_f32 v114, v30, v114
    v_mul_f32 v130, v31, v130
    v_mul_f32 v115, v30, v115
    v_mul_f32 v131, v31, v131
    v_mul_f32 v116, v30, v116
    v_mul_f32 v132, v31, v132
    v_mul_f32 v117, v30, v117
    v_mul_f32 v133, v31, v133
    v_mul_f32 v118, v30, v118
    v_mul_f32 v134, v31, v134
    v_mul_f32 v119, v30, v119
    v_mul_f32 v135, v31, v135
    v_mul_f32 v120, v30, v120
    v_mul_f32 v136, v31, v136
    v_mul_f32 v121, v30, v121
    v_mul_f32 v137, v31, v137
    v_mul_f32 v122, v30, v122
    v_mul_f32 v138, v31, v138
    v_mul_f32 v123, v30, v123
    v_mul_f32 v139, v31, v139
    v_mul_f32 v124, v30, v124
    v_mul_f32 v140, v31, v140
    v_mul_f32 v125, v30, v125
    v_mul_f32 v141, v31, v141
    v_mul_f32 v126, v30, v126
    v_mul_f32 v142, v31, v142
    v_mul_f32 v127, v30, v127
    v_mul_f32 v143, v31, v143
    v_cvt_pk_bf16_f32 v112, v112, v113
    v_cvt_pk_bf16_f32 v128, v128, v129
    v_cvt_pk_bf16_f32 v113, v114, v115
    v_cvt_pk_bf16_f32 v129, v130, v131
    v_cvt_pk_bf16_f32 v114, v116, v117
    v_cvt_pk_bf16_f32 v130, v132, v133
    v_cvt_pk_bf16_f32 v115, v118, v119
    v_cvt_pk_bf16_f32 v131, v134, v135
    v_cvt_pk_bf16_f32 v116, v120, v121
    v_cvt_pk_bf16_f32 v132, v136, v137
    v_cvt_pk_bf16_f32 v117, v122, v123
    v_cvt_pk_bf16_f32 v133, v138, v139
    v_cvt_pk_bf16_f32 v118, v124, v125
    v_cvt_pk_bf16_f32 v134, v140, v141
    v_cvt_pk_bf16_f32 v119, v126, v127
    v_cvt_pk_bf16_f32 v135, v142, v143
    v_lshlrev_b32 v12, 6, v3
    v_lshl_add_u32 v12, v4, 3, v12
    v_add_u32 v12, s13, v12
    ds_write_b64 v12, v[112:113] offset:0
    ds_write_b64 v12, v[128:129] offset:2048
    ds_write_b64 v12, v[114:115] offset:16
    ds_write_b64 v12, v[130:131] offset:2064
    ds_write_b64 v12, v[116:117] offset:32
    ds_write_b64 v12, v[132:133] offset:2080
    ds_write_b64 v12, v[118:119] offset:48
    ds_write_b64 v12, v[134:135] offset:2096
    ds_read_b128 v[64:67], v13 offset:4096
    ds_read_b128 v[80:83], v13 offset:4224
    ds_read_b128 v[68:71], v13 offset:4128
    ds_read_b128 v[84:87], v13 offset:4256
    ds_read_b128 v[72:75], v13 offset:4160
    ds_read_b128 v[88:91], v13 offset:4288
    ds_read_b128 v[76:79], v13 offset:4192
    ds_read_b128 v[92:95], v13 offset:4320
    v_cmp_gt_u32 vcc, 28, v3
    v_mov_b32 v24, 0
    v_mov_b32 v25, 1.0
    v_cmp_eq_u32 s[62:63], 28, v3
    s_nop 1
    v_cndmask_b32 v24, v24, v25, s[62:63]
    s_waitcnt lgkmcnt(0)
    v_mul_f32 v80, v56, v80
    v_fma_f32 v80, v208, v64, v80
    v_cndmask_b32 v80, v24, v80, vcc
    v_mul_f32 v81, v56, v81
    v_fma_f32 v81, v209, v65, v81
    v_cndmask_b32 v81, v24, v81, vcc
    v_mul_f32 v82, v56, v82
    v_fma_f32 v82, v210, v66, v82
    v_cndmask_b32 v82, v24, v82, vcc
    v_mul_f32 v83, v56, v83
    v_fma_f32 v83, v211, v67, v83
    v_cndmask_b32 v83, v24, v83, vcc
    v_mul_f32 v84, v56, v84
    v_fma_f32 v84, v212, v68, v84
    v_cndmask_b32 v84, v24, v84, vcc
    v_mul_f32 v85, v56, v85
    v_fma_f32 v85, v213, v69, v85
    v_cndmask_b32 v85, v24, v85, vcc
    v_mul_f32 v86, v56, v86
    v_fma_f32 v86, v214, v70, v86
    v_cndmask_b32 v86, v24, v86, vcc
    v_mul_f32 v87, v56, v87
    v_fma_f32 v87, v215, v71, v87
    v_cndmask_b32 v87, v24, v87, vcc
    v_mul_f32 v88, v56, v88
    v_fma_f32 v88, v216, v72, v88
    v_cndmask_b32 v88, v24, v88, vcc
    v_mul_f32 v89, v56, v89
    v_fma_f32 v89, v217, v73, v89
    v_cndmask_b32 v89, v24, v89, vcc
    v_mul_f32 v90, v56, v90
    v_fma_f32 v90, v218, v74, v90
    v_cndmask_b32 v90, v24, v90, vcc
    v_mul_f32 v91, v56, v91
    v_fma_f32 v91, v219, v75, v91
    v_cndmask_b32 v91, v24, v91, vcc
    v_mul_f32 v92, v56, v92
    v_fma_f32 v92, v220, v76, v92
    v_cndmask_b32 v92, v24, v92, vcc
    v_mul_f32 v93, v56, v93
    v_fma_f32 v93, v221, v77, v93
    v_cndmask_b32 v93, v24, v93, vcc
    v_mul_f32 v94, v56, v94
    v_fma_f32 v94, v222, v78, v94
    v_cndmask_b32 v94, v24, v94, vcc
    v_mul_f32 v95, v56, v95
    v_fma_f32 v95, v223, v79, v95
    v_cndmask_b32 v95, v24, v95, vcc
    v_cvt_pk_bf16_f32 v96, v80, v81
    v_cvt_pk_bf16_f32 v97, v82, v83
    v_cvt_pk_bf16_f32 v98, v84, v85
    v_cvt_pk_bf16_f32 v99, v86, v87
    v_cvt_pk_bf16_f32 v100, v88, v89
    v_cvt_pk_bf16_f32 v101, v90, v91
    v_cvt_pk_bf16_f32 v102, v92, v93
    v_cvt_pk_bf16_f32 v103, v94, v95
    v_and_b32 v26, 15, v1
    v_lshrrev_b32 v27, 2, v26
    v_and_b32 v26, 3, v26
    v_lshlrev_b32 v26, 3, v26
    v_lshl_add_u32 v27, v4, 2, v27
    v_lshl_add_u32 v26, v27, 6, v26
    v_bfe_u32 v27, v1, 4, 1
    v_lshl_add_u32 v26, v27, 5, v26
    v_add_u32 v26, s13, v26
    ds_read_b64_tr_b16 v[144:145], v26 offset:0
    ds_read_b64_tr_b16 v[146:147], v26 offset:512
    ds_read_b64_tr_b16 v[148:149], v26 offset:1024
    ds_read_b64_tr_b16 v[150:151], v26 offset:1536
    ds_read_b64_tr_b16 v[152:153], v26 offset:2048
    ds_read_b64_tr_b16 v[154:155], v26 offset:2560
    ds_read_b64_tr_b16 v[156:157], v26 offset:3072
    ds_read_b64_tr_b16 v[158:159], v26 offset:3584
    s_waitcnt lgkmcnt(0)
    v_mfma_f32_32x32x16_bf16 v[192:207], v[144:147], v[96:99], 0
    v_mfma_f32_32x32x16_bf16 v[192:207], v[148:151], v[100:103], v[192:207]
    v_mfma_f32_32x32x16_bf16 v[208:223], v[152:155], v[96:99], 0
    v_mfma_f32_32x32x16_bf16 v[208:223], v[156:159], v[100:103], v[208:223]
    s_barrier
    s_nop 11
    s_lshl_b32 s12, s3, 13
    v_lshlrev_b32 v12, 5, v1
    v_add_u32 v12, s12, v12
    ds_write_b128 v12, v[192:195] offset:0
    ds_write_b128 v12, v[196:199] offset:16
    ds_write_b128 v12, v[200:203] offset:2048
    ds_write_b128 v12, v[204:207] offset:2064
    ds_write_b128 v12, v[208:211] offset:4096
    ds_write_b128 v12, v[212:215] offset:4112
    ds_write_b128 v12, v[216:219] offset:6144
    ds_write_b128 v12, v[220:223] offset:6160
    s_waitcnt lgkmcnt(0)
    s_barrier
    v_lshlrev_b32 v12, 2, v0
    ds_read_b32 v64, v12 offset:0
    ds_read_b32 v65, v12 offset:8192
    ds_read_b32 v66, v12 offset:16384
    ds_read_b32 v67, v12 offset:24576
    ds_read_b32 v68, v12 offset:1024
    ds_read_b32 v69, v12 offset:9216
    ds_read_b32 v70, v12 offset:17408
    ds_read_b32 v71, v12 offset:25600
    ds_read_b32 v72, v12 offset:2048
    ds_read_b32 v73, v12 offset:10240
    ds_read_b32 v74, v12 offset:18432
    ds_read_b32 v75, v12 offset:26624
    ds_read_b32 v76, v12 offset:3072
    ds_read_b32 v77, v12 offset:11264
    ds_read_b32 v78, v12 offset:19456
    ds_read_b32 v79, v12 offset:27648
    ds_read_b32 v80, v12 offset:4096
    ds_read_b32 v81, v12 offset:12288
    ds_read_b32 v82, v12 offset:20480
    ds_read_b32 v83, v12 offset:28672
    ds_read_b32 v84, v12 offset:5120
    ds_read_b32 v85, v12 offset:13312
    ds_read_b32 v86, v12 offset:21504
    ds_read_b32 v87, v12 offset:29696
    ds_read_b32 v88, v12 offset:6144
    ds_read_b32 v89, v12 offset:14336
    ds_read_b32 v90, v12 offset:22528
    ds_read_b32 v91, v12 offset:30720
    ds_read_b32 v92, v12 offset:7168
    ds_read_b32 v93, v12 offset:15360
    ds_read_b32 v94, v12 offset:23552
    ds_read_b32 v95, v12 offset:31744
    s_lshl_b32 s12, s5, 13
    s_waitcnt lgkmcnt(15)
    v_add_f32 v64, v64, v65
    v_add_f32 v66, v66, v67
    v_add_f32 v64, v64, v66
    buffer_atomic_add_f32 v64, v12, s[56:59], s12 offen offset:0 sc1
    s_waitcnt lgkmcnt(15)
    v_add_f32 v68, v68, v69
    v_add_f32 v70, v70, v71
    v_add_f32 v68, v68, v70
    buffer_atomic_add_f32 v68, v12, s[56:59], s12 offen offset:1024 sc1
    s_waitcnt lgkmcnt(15)
    v_add_f32 v72, v72, v73
    v_add_f32 v74, v74, v75
    v_add_f32 v72, v72, v74
    buffer_atomic_add_f32 v72, v12, s[56:59], s12 offen offset:2048 sc1
    s_waitcnt lgkmcnt(15)
    v_add_f32 v76, v76, v77
    v_add_f32 v78, v78, v79
    v_add_f32 v76, v76, v78
    buffer_atomic_add_f32 v76, v12, s[56:59], s12 offen offset:3072 sc1
    s_add_u32 s12, s12, 4096
    s_waitcnt lgkmcnt(12)
    v_add_f32 v80, v80, v81
    v_add_f32 v82, v82, v83
    v_add_f32 v80, v80, v82
    buffer_atomic_add_f32 v80, v12, s[56:59], s12 offen offset:0 sc1
    s_waitcnt lgkmcnt(8)
    v_add_f32 v84, v84, v85
    v_add_f32 v86, v86, v87
    v_add_f32 v84, v84, v86
    buffer_atomic_add_f32 v84, v12, s[56:59], s12 offen offset:1024 sc1
    s_waitcnt lgkmcnt(4)
    v_add_f32 v88, v88, v89
    v_add_f32 v90, v90, v91
    v_add_f32 v88, v88, v90
    buffer_atomic_add_f32 v88, v12, s[56:59], s12 offen offset:2048 sc1
    s_waitcnt lgkmcnt(0)
    v_add_f32 v92, v92, v93
    v_add_f32 v94, v94, v95
    v_add_f32 v92, v92, v94
    buffer_atomic_add_f32 v92, v12, s[56:59], s12 offen offset:3072 sc1
    s_lshl_b32 s12, s2, 2
    s_add_u32 s12, s12, 1024
    s_waitcnt vmcnt(0) lgkmcnt(0)
    s_barrier
    s_cmp_eq_u32 s3, 0
    s_cbranch_scc0 L_sig_7
    v_mov_b32 v5, s98
    v_mov_b32 v6, 0
    s_mov_b64 exec, 1
    buffer_store_dword v5, v6, s[72:75], s12 offen sc1
    s_mov_b64 exec, -1
L_sig_7:
    s_cmp_eq_u32 s2, 255
    s_cbranch_scc0 L_agg_8
    s_cmp_eq_u32 s3, 3
    s_cbranch_scc0 L_agg_8
    s_mov_b32 s13, 0
    v_lshlrev_b32 v6, 4, v1
    v_lshlrev_b32 v7, 2, v1
L_pb_9:
    buffer_load_dwordx4 v[12:15], v6, s[72:75], s13 offen sc1
    s_waitcnt vmcnt(0)
    s_mov_b64 s[60:61], 0
    v_add_u32 v16, 0, v7
    s_movk_i32 s14, 238
    v_cmp_gt_u32 s[62:63], s14, v16
    v_cmp_ne_u32 vcc, s98, v12
    s_and_b64 s[62:63], s[62:63], vcc
    s_or_b64 s[60:61], s[60:61], s[62:63]
    v_add_u32 v16, 1, v7
    s_movk_i32 s14, 238
    v_cmp_gt_u32 s[62:63], s14, v16
    v_cmp_ne_u32 vcc, s98, v13
    s_and_b64 s[62:63], s[62:63], vcc
    s_or_b64 s[60:61], s[60:61], s[62:63]
    v_add_u32 v16, 2, v7
    s_movk_i32 s14, 238
    v_cmp_gt_u32 s[62:63], s14, v16
    v_cmp_ne_u32 vcc, s98, v14
    s_and_b64 s[62:63], s[62:63], vcc
    s_or_b64 s[60:61], s[60:61], s[62:63]
    v_add_u32 v16, 3, v7
    s_movk_i32 s14, 238
    v_cmp_gt_u32 s[62:63], s14, v16
    v_cmp_ne_u32 vcc, s98, v15
    s_and_b64 s[62:63], s[62:63], vcc
    s_or_b64 s[60:61], s[60:61], s[62:63]
    s_cmp_eq_u64 s[60:61], 0
    s_cbranch_scc1 L_pb_9_x
    s_sleep 2
    s_branch L_pb_9
L_pb_9_x:
    s_mov_b32 s13, 1024
    v_lshlrev_b32 v6, 4, v1
    v_lshlrev_b32 v7, 2, v1
L_pb_10:
    buffer_load_dwordx4 v[12:15], v6, s[72:75], s13 offen sc1
    s_waitcnt vmcnt(0)
    s_mov_b64 s[60:61], 0
    v_add_u32 v16, 0, v7
    s_movk_i32 s14, 256
    v_cmp_gt_u32 s[62:63], s14, v16
    v_cmp_ne_u32 vcc, s98, v12
    s_and_b64 s[62:63], s[62:63], vcc
    s_or_b64 s[60:61], s[60:61], s[62:63]
    v_add_u32 v16, 1, v7
    s_movk_i32 s14, 256
    v_cmp_gt_u32 s[62:63], s14, v16
    v_cmp_ne_u32 vcc, s98, v13
    s_and_b64 s[62:63], s[62:63], vcc
    s_or_b64 s[60:61], s[60:61], s[62:63]
    v_add_u32 v16, 2, v7
    s_movk_i32 s14, 256
    v_cmp_gt_u32 s[62:63], s14, v16
    v_cmp_ne_u32 vcc, s98, v14
    s_and_b64 s[62:63], s[62:63], vcc
    s_or_b64 s[60:61], s[60:61], s[62:63]
    v_add_u32 v16, 3, v7
    s_movk_i32 s14, 256
    v_cmp_gt_u32 s[62:63], s14, v16
    v_cmp_ne_u32 vcc, s98, v15
    s_and_b64 s[62:63], s[62:63], vcc
    s_or_b64 s[60:61], s[60:61], s[62:63]
    s_cmp_eq_u64 s[60:61], 0
    s_cbranch_scc1 L_pb_10_x
    s_sleep 2
    s_branch L_pb_10
L_pb_10_x:
    v_lshlrev_b32 v6, 7, v1
    v_mov_b32 v5, s98
    s_mov_b64 exec, 0xffff
    s_mov_b32 s13, 4096
    buffer_store_dword v5, v6, s[72:75], s13 offen sc1
    s_mov_b64 exec, -1
L_agg_8:
    s_lshr_b32 s13, s2, 3
    s_mul_hi_u32 s14, s13, 0x24924925
    s_mul_i32 s14, s14, 7
    s_sub_u32 s13, s13, s14
    s_add_u32 s44, s38, 0x2600000
    s_addc_u32 s45, s39, 0
    s_and_b32 s45, s45, 0xffff
    s_mov_b32 s46, 0x70000
    s_mov_b32 s47, 0x20000
    s_lshl_b32 s13, s13, 16
    s_lshl_b32 s14, s3, 14
    s_add_u32 s13, s13, s14
    s_add_u32 s14, s14, 65536
    s_add_u32 s11, s13, 0
    s_add_u32 m0, s14, 0
    s_nop 0
    buffer_load_dwordx4 v9, s[44:47], s11 offen lds
    s_add_u32 s11, s13, 1024
    s_add_u32 m0, s14, 1024
    s_nop 0
    buffer_load_dwordx4 v9, s[44:47], s11 offen lds
    s_add_u32 s11, s13, 2048
    s_add_u32 m0, s14, 2048
    s_nop 0
    buffer_load_dwordx4 v9, s[44:47], s11 offen lds
    s_add_u32 s11, s13, 3072
    s_add_u32 m0, s14, 3072
    s_nop 0
    buffer_load_dwordx4 v9, s[44:47], s11 offen lds
    s_add_u32 s11, s13, 4096
    s_add_u32 m0, s14, 4096
    s_nop 0
    buffer_load_dwordx4 v9, s[44:47], s11 offen lds
    s_add_u32 s11, s13, 5120
    s_add_u32 m0, s14, 5120
    s_nop 0
    buffer_load_dwordx4 v9, s[44:47], s11 offen lds
    s_add_u32 s11, s13, 6144
    s_add_u32 m0, s14, 6144
    s_nop 0
    buffer_load_dwordx4 v9, s[44:47], s11 offen lds
    s_add_u32 s11, s13, 7168
    s_add_u32 m0, s14, 7168
    s_nop 0
    buffer_load_dwordx4 v9, s[44:47], s11 offen lds
    s_add_u32 s11, s13, 8192
    s_add_u32 m0, s14, 8192
    s_nop 0
    buffer_load_dwordx4 v9, s[44:47], s11 offen lds
    s_add_u32 s11, s13, 9216
    s_add_u32 m0, s14, 9216
    s_nop 0
    buffer_load_dwordx4 v9, s[44:47], s11 offen lds
    s_add_u32 s11, s13, 10240
    s_add_u32 m0, s14, 10240
    s_nop 0
    buffer_load_dwordx4 v9, s[44:47], s11 offen lds
    s_add_u32 s11, s13, 11264
    s_add_u32 m0, s14, 11264
    s_nop 0
    buffer_load_dwordx4 v9, s[44:47], s11 offen lds
    s_add_u32 s11, s13, 12288
    s_add_u32 m0, s14, 12288
    s_nop 0
    buffer_load_dwordx4 v9, s[44:47], s11 offen lds
    s_add_u32 s11, s13, 13312
    s_add_u32 m0, s14, 13312
    s_nop 0
    buffer_load_dwordx4 v9, s[44:47], s11 offen lds
    s_add_u32 s11, s13, 14336
    s_add_u32 m0, s14, 14336
    s_nop 0
    buffer_load_dwordx4 v9, s[44:47], s11 offen lds
    s_add_u32 s11, s13, 15360
    s_add_u32 m0, s14, 15360
    s_nop 0
    buffer_load_dwordx4 v9, s[44:47], s11 offen lds
    s_mov_b32 s60, 0
    s_mov_b32 s61, -1
    v_mul_f32 v64, v58, v240
    v_fma_f32 v64, v176, v59, v64
    v_mul_f32 v65, v58, v241
    v_fma_f32 v65, v177, v59, v65
    v_mul_f32 v66, v58, v242
    v_fma_f32 v66, v178, v59, v66
    v_mul_f32 v67, v58, v243
    v_fma_f32 v67, v179, v59, v67
    v_mul_f32 v68, v58, v244
    v_fma_f32 v68, v180, v59, v68
    v_mul_f32 v69, v58, v245
    v_fma_f32 v69, v181, v59, v69
    v_mul_f32 v70, v58, v246
    v_fma_f32 v70, v182, v59, v70
    v_mul_f32 v71, v58, v247
    v_fma_f32 v71, v183, v59, v71
    v_mul_f32 v72, v58, v248
    v_fma_f32 v72, v184, v59, v72
    v_mul_f32 v73, v58, v249
    v_fma_f32 v73, v185, v59, v73
    v_mul_f32 v74, v58, v250
    v_fma_f32 v74, v186, v59, v74
    v_mul_f32 v75, v58, v251
    v_fma_f32 v75, v187, v59, v75
    v_mul_f32 v76, v58, v252
    v_fma_f32 v76, v188, v59, v76
    v_mul_f32 v77, v58, v253
    v_fma_f32 v77, v189, v59, v77
    v_mul_f32 v78, v58, v254
    v_fma_f32 v78, v190, v59, v78
    v_mul_f32 v79, v58, v255
    v_fma_f32 v79, v191, v59, v79
    v_cvt_pk_bf16_f32 v80, v64, v65
    v_cvt_pk_bf16_f32 v81, v66, v67
    v_cvt_pk_bf16_f32 v82, v68, v69
    v_cvt_pk_bf16_f32 v83, v70, v71
    v_cvt_pk_bf16_f32 v84, v72, v73
    v_cvt_pk_bf16_f32 v85, v74, v75
    v_cvt_pk_bf16_f32 v86, v76, v77
    v_cvt_pk_bf16_f32 v87, v78, v79
    s_nop 1
    v_mfma_f32_32x32x16_bf16 v[96:111], v[48:51], v[80:83], 0
    v_mfma_f32_32x32x16_bf16 v[96:111], v[52:55], v[84:87], v[96:111]
    v_mov_b32 v24, 0xff7fffff
    v_mov_b32 v25, 0x7f7fffff
    s_nop 13
    v_cndmask_b32 v26, v108, v24, s[60:61]
    v_cndmask_b32 v144, v108, v25, s[60:61]
    v_cndmask_b32 v27, v109, v24, s[60:61]
    v_cndmask_b32 v145, v109, v25, s[60:61]
    v_cndmask_b32 v28, v110, v24, s[60:61]
    v_cndmask_b32 v146, v110, v25, s[60:61]
    v_cndmask_b32 v29, v111, v24, s[60:61]
    v_cndmask_b32 v147, v111, v25, s[60:61]
    v_max3_f32 v30, v96, v97, v98
    v_min3_f32 v31, v96, v97, v98
    v_max3_f32 v30, v99, v100, v30
    v_min3_f32 v31, v99, v100, v31
    v_max3_f32 v30, v101, v102, v30
    v_min3_f32 v31, v101, v102, v31
    v_max3_f32 v30, v103, v104, v30
    v_min3_f32 v31, v103, v104, v31
    v_max3_f32 v30, v105, v106, v30
    v_min3_f32 v31, v105, v106, v31
    v_max_f32 v30, v107, v30
    v_min_f32 v31, v107, v31
    v_max3_f32 v30, v26, v27, v30
    v_min3_f32 v31, v144, v145, v31
    v_max3_f32 v30, v28, v29, v30
    v_min3_f32 v31, v146, v147, v31
    v_mov_b32 v12, v30
    s_nop 1
    v_permlane32_swap_b32 v30, v12
    s_nop 0
    v_max_f32 v30, v30, v12
    v_mov_b32 v12, v31
    s_nop 1
    v_permlane32_swap_b32 v31, v12
    s_nop 0
    v_min_f32 v31, v31, v12
    v_mov_b32 v24, 0x3fb8aa3b
    v_mul_f32 v30, 0xbfb8aa3b, v30
    v_mul_f32 v31, 0x3fb8aa3b, v31
    v_fma_f32 v112, v96, v24, v30
    v_fma_f32 v128, -v96, v24, v31
    v_fma_f32 v113, v97, v24, v30
    v_fma_f32 v129, -v97, v24, v31
    v_fma_f32 v114, v98, v24, v30
    v_fma_f32 v130, -v98, v24, v31
    v_fma_f32 v115, v99, v24, v30
    v_fma_f32 v131, -v99, v24, v31
    v_fma_f32 v116, v100, v24, v30
    v_fma_f32 v132, -v100, v24, v31
    v_fma_f32 v117, v101, v24, v30
    v_fma_f32 v133, -v101, v24, v31
    v_fma_f32 v118, v102, v24, v30
    v_fma_f32 v134, -v102, v24, v31
    v_fma_f32 v119, v103, v24, v30
    v_fma_f32 v135, -v103, v24, v31
    v_fma_f32 v120, v104, v24, v30
    v_fma_f32 v136, -v104, v24, v31
    v_fma_f32 v121, v105, v24, v30
    v_fma_f32 v137, -v105, v24, v31
    v_fma_f32 v122, v106, v24, v30
    v_fma_f32 v138, -v106, v24, v31
    v_fma_f32 v123, v107, v24, v30
    v_fma_f32 v139, -v107, v24, v31
    v_fma_f32 v124, v108, v24, v30
    v_fma_f32 v140, -v108, v24, v31
    v_fma_f32 v125, v109, v24, v30
    v_fma_f32 v141, -v109, v24, v31
    v_fma_f32 v126, v110, v24, v30
    v_fma_f32 v142, -v110, v24, v31
    v_fma_f32 v127, v111, v24, v30
    v_fma_f32 v143, -v111, v24, v31
    v_exp_f32 v112, v112
    v_exp_f32 v128, v128
    v_exp_f32 v113, v113
    v_exp_f32 v129, v129
    v_exp_f32 v114, v114
    v_exp_f32 v130, v130
    v_exp_f32 v115, v115
    v_exp_f32 v131, v131
    v_exp_f32 v116, v116
    v_exp_f32 v132, v132
    v_exp_f32 v117, v117
    v_exp_f32 v133, v133
    v_exp_f32 v118, v118
    v_exp_f32 v134, v134
    v_exp_f32 v119, v119
    v_exp_f32 v135, v135
    v_exp_f32 v120, v120
    v_exp_f32 v136, v136
    v_exp_f32 v121, v121
    v_exp_f32 v137, v137
    v_exp_f32 v122, v122
    v_exp_f32 v138, v138
    v_exp_f32 v123, v123
    v_exp_f32 v139, v139
    v_exp_f32 v124, v124
    v_exp_f32 v140, v140
    v_exp_f32 v125, v125
    v_exp_f32 v141, v141
    v_exp_f32 v126, v126
    v_exp_f32 v142, v142
    v_exp_f32 v127, v127
    v_exp_f32 v143, v143
    s_nop 0
    v_cndmask_b32 v124, v124, 0, s[60:61]
    v_cndmask_b32 v140, v140, 0, s[60:61]
    v_cndmask_b32 v125, v125, 0, s[60:61]
    v_cndmask_b32 v141, v141, 0, s[60:61]
    v_cndmask_b32 v126, v126, 0, s[60:61]
    v_cndmask_b32 v142, v142, 0, s[60:61]
    v_cndmask_b32 v127, v127, 0, s[60:61]
    v_cndmask_b32 v143, v143, 0, s[60:61]
    v_add_f32 v30, v112, v113
    v_add_f32 v31, v128, v129
    v_add_f32 v30, v114, v30
    v_add_f32 v31, v130, v31
    v_add_f32 v30, v115, v30
    v_add_f32 v31, v131, v31
    v_add_f32 v30, v116, v30
    v_add_f32 v31, v132, v31
    v_add_f32 v30, v117, v30
    v_add_f32 v31, v133, v31
    v_add_f32 v30, v118, v30
    v_add_f32 v31, v134, v31
    v_add_f32 v30, v119, v30
    v_add_f32 v31, v135, v31
    v_add_f32 v30, v120, v30
    v_add_f32 v31, v136, v31
    v_add_f32 v30, v121, v30
    v_add_f32 v31, v137, v31
    v_add_f32 v30, v122, v30
    v_add_f32 v31, v138, v31
    v_add_f32 v30, v123, v30
    v_add_f32 v31, v139, v31
    v_add_f32 v30, v124, v30
    v_add_f32 v31, v140, v31
    v_add_f32 v30, v125, v30
    v_add_f32 v31, v141, v31
    v_add_f32 v30, v126, v30
    v_add_f32 v31, v142, v31
    v_add_f32 v30, v127, v30
    v_add_f32 v31, v143, v31
    v_mov_b32 v12, v30
    s_nop 1
    v_permlane32_swap_b32 v30, v12
    s_nop 0
    v_add_f32 v30, v30, v12
    v_mov_b32 v12, v31
    s_nop 1
    v_permlane32_swap_b32 v31, v12
    s_nop 0
    v_add_f32 v31, v31, v12
    v_rcp_f32 v30, v30
    v_rcp_f32 v31, v31
    s_nop 0
    v_mul_f32 v112, v30, v112
    v_mul_f32 v128, v31, v128
    v_mul_f32 v113, v30, v113
    v_mul_f32 v129, v31, v129
    v_mul_f32 v114, v30, v114
    v_mul_f32 v130, v31, v130
    v_mul_f32 v115, v30, v115
    v_mul_f32 v131, v31, v131
    v_mul_f32 v116, v30, v116
    v_mul_f32 v132, v31, v132
    v_mul_f32 v117, v30, v117
    v_mul_f32 v133, v31, v133
    v_mul_f32 v118, v30, v118
    v_mul_f32 v134, v31, v134
    v_mul_f32 v119, v30, v119
    v_mul_f32 v135, v31, v135
    v_mul_f32 v120, v30, v120
    v_mul_f32 v136, v31, v136
    v_mul_f32 v121, v30, v121
    v_mul_f32 v137, v31, v137
    v_mul_f32 v122, v30, v122
    v_mul_f32 v138, v31, v138
    v_mul_f32 v123, v30, v123
    v_mul_f32 v139, v31, v139
    v_mul_f32 v124, v30, v124
    v_mul_f32 v140, v31, v140
    v_mul_f32 v125, v30, v125
    v_mul_f32 v141, v31, v141
    v_mul_f32 v126, v30, v126
    v_mul_f32 v142, v31, v142
    v_mul_f32 v127, v30, v127
    v_mul_f32 v143, v31, v143
    v_cvt_pk_bf16_f32 v112, v112, v113
    v_cvt_pk_bf16_f32 v128, v128, v129
    v_cvt_pk_bf16_f32 v113, v114, v115
    v_cvt_pk_bf16_f32 v129, v130, v131
    v_cvt_pk_bf16_f32 v114, v116, v117
    v_cvt_pk_bf16_f32 v130, v132, v133
    v_cvt_pk_bf16_f32 v115, v118, v119
    v_cvt_pk_bf16_f32 v131, v134, v135
    v_cvt_pk_bf16_f32 v116, v120, v121
    v_cvt_pk_bf16_f32 v132, v136, v137
    v_cvt_pk_bf16_f32 v117, v122, v123
    v_cvt_pk_bf16_f32 v133, v138, v139
    v_cvt_pk_bf16_f32 v118, v124, v125
    v_cvt_pk_bf16_f32 v134, v140, v141
    v_cvt_pk_bf16_f32 v119, v126, v127
    v_cvt_pk_bf16_f32 v135, v142, v143
    v_mov_b32 v224, v112
    v_mov_b32 v232, v128
    v_mov_b32 v225, v113
    v_mov_b32 v233, v129
    v_mov_b32 v226, v114
    v_mov_b32 v234, v130
    v_mov_b32 v227, v115
    v_mov_b32 v235, v131
    v_mov_b32 v228, v116
    v_mov_b32 v236, v132
    v_mov_b32 v229, v117
    v_mov_b32 v237, v133
    v_mov_b32 v230, v118
    v_mov_b32 v238, v134
    v_mov_b32 v231, v119
    v_mov_b32 v239, v135
    s_add_u32 s52, s38, 0x800000
    s_addc_u32 s53, s39, 0
    s_and_b32 s53, s53, 0xffff
    s_mov_b32 s54, 0x200000
    s_mov_b32 s55, 0x20000
    s_and_b32 s13, s2, 15
    s_lshl_b32 s13, s13, 7
    s_add_u32 s13, s13, 4096
    v_lshlrev_b32 v8, 5, v1
    s_lshl_b32 s10, s5, 13
    s_cmp_eq_u32 s3, 3
    s_cbranch_scc0 L_pdone_12
    s_mov_b64 exec, 0x1
    v_lshlrev_b32 v6, 2, v1
L_poll_11:
    buffer_load_dword v5, v6, s[72:75], s13 offen sc1
    s_waitcnt vmcnt(0)
    v_cmp_ne_u32 vcc, s98, v5
    s_cbranch_vccz L_pdone_12_x
    s_sleep 3
    s_branch L_poll_11
L_pdone_12_x:
    s_mov_b64 exec, -1
L_pdone_12:
    s_barrier
    buffer_load_dwordx4 v[64:67], v8, s[56:59], s10 offen offset:0
    buffer_load_dwordx4 v[68:71], v8, s[56:59], s10 offen offset:16
    buffer_load_dwordx4 v[72:75], v8, s[56:59], s10 offen offset:2048
    buffer_load_dwordx4 v[76:79], v8, s[56:59], s10 offen offset:2064
    s_add_u32 s10, s10, 4096
    buffer_load_dwordx4 v[80:83], v8, s[56:59], s10 offen offset:0
    buffer_load_dwordx4 v[84:87], v8, s[56:59], s10 offen offset:16
    buffer_load_dwordx4 v[88:91], v8, s[56:59], s10 offen offset:2048
    buffer_load_dwordx4 v[92:95], v8, s[56:59], s10 offen offset:2064
    s_waitcnt vmcnt(0)
    v_cvt_pk_bf16_f32 v96, v64, v65
    v_cvt_pk_bf16_f32 v97, v66, v67
    v_cvt_pk_bf16_f32 v98, v68, v69
    v_cvt_pk_bf16_f32 v99, v70, v71
    v_cvt_pk_bf16_f32 v100, v72, v73
    v_cvt_pk_bf16_f32 v101, v74, v75
    v_cvt_pk_bf16_f32 v102, v76, v77
    v_cvt_pk_bf16_f32 v103, v78, v79
    v_cvt_pk_bf16_f32 v104, v80, v81
    v_cvt_pk_bf16_f32 v105, v82, v83
    v_cvt_pk_bf16_f32 v106, v84, v85
    v_cvt_pk_bf16_f32 v107, v86, v87
    v_cvt_pk_bf16_f32 v108, v88, v89
    v_cvt_pk_bf16_f32 v109, v90, v91
    v_cvt_pk_bf16_f32 v110, v92, v93
    v_cvt_pk_bf16_f32 v111, v94, v95
    s_nop 1
    v_mfma_f32_32x32x16_bf16 v[176:191], v[96:99], v[224:227], 0
    v_mfma_f32_32x32x16_bf16 v[176:191], v[100:103], v[228:231], v[176:191]
    v_mfma_f32_32x32x16_bf16 v[176:191], v[104:107], v[232:235], v[176:191]
    v_mfma_f32_32x32x16_bf16 v[176:191], v[108:111], v[236:239], v[176:191]
    s_nop 15
    v_mov_b32 v13, v188
    v_mov_b32 v12, v188
    s_nop 1
    v_permlane32_swap_b32 v13, v12
    s_nop 0
    v_add_f32 v12, 0x358637bd, v12
    v_rcp_f32 v12, v12
    s_nop 0
    v_mul_f32 v176, v12, v176
    v_mul_f32 v177, v12, v177
    v_mul_f32 v178, v12, v178
    v_mul_f32 v179, v12, v179
    v_mul_f32 v180, v12, v180
    v_mul_f32 v181, v12, v181
    v_mul_f32 v182, v12, v182
    v_mul_f32 v183, v12, v183
    v_mul_f32 v184, v12, v184
    v_mul_f32 v185, v12, v185
    v_mul_f32 v186, v12, v186
    v_mul_f32 v187, v12, v187
    v_mul_f32 v188, v12, v188
    v_mul_f32 v189, v12, v189
    v_mul_f32 v190, v12, v190
    v_mul_f32 v191, v12, v191
    v_cvt_pk_bf16_f32 v64, v176, v177
    v_cvt_pk_bf16_f32 v65, v178, v179
    v_cvt_pk_bf16_f32 v66, v180, v181
    v_cvt_pk_bf16_f32 v67, v182, v183
    v_cvt_pk_bf16_f32 v68, v184, v185
    v_cvt_pk_bf16_f32 v69, v186, v187
    v_cvt_pk_bf16_f32 v70, v188, v189
    v_cvt_pk_bf16_f32 v71, v190, v191
    s_lshl_b32 s12, s6, 15
    s_lshl_b32 s13, s5, 11
    s_add_u32 s12, s12, s13
    buffer_store_dwordx4 v[64:67], v9, s[52:55], s12 offen sc1
    buffer_store_dwordx4 v[68:71], v9, s[52:55], s12 offen offset:1024 sc1
    s_lshl_b32 s12, s4, 7
    s_lshl_b32 s13, s5, 2
    s_add_u32 s12, s12, s13
    s_add_u32 s12, s12, 20480
    s_waitcnt vmcnt(0) lgkmcnt(0)
    s_barrier
    s_cmp_eq_u32 s3, 0
    s_cbranch_scc0 L_sig_13
    v_mov_b32 v5, s98
    v_mov_b32 v6, 0
    s_mov_b64 exec, 1
    buffer_store_dword v5, v6, s[72:75], s12 offen sc1
    s_mov_b64 exec, -1
L_sig_13:
    s_cmp_ge_u32 s2, 224
    s_cbranch_scc1 k2l0_end
    s_and_b32 s4, s2, 7
    s_lshr_b32 s5, s2, 3
    s_mul_hi_u32 s6, s5, 0x24924925
    s_mul_i32 s7, s6, 7
    s_sub_u32 s5, s5, s7
    s_lshl_b32 s4, s4, 2
    s_add_u32 s4, s4, s6
    s_mov_b32 s40, s38
    s_mov_b32 s41, s39
    s_and_b32 s41, s41, 0xffff
    s_mov_b32 s42, 0x1c0000
    s_mov_b32 s43, 0x20000
    s_add_u32 s48, s38, 0x800000
    s_addc_u32 s49, s39, 0
    s_and_b32 s49, s49, 0xffff
    s_mov_b32 s50, 0x200000
    s_mov_b32 s51, 0x20000
    s_add_u32 s52, s38, 0x200000
    s_addc_u32 s53, s39, 0
    s_and_b32 s53, s53, 0xffff
    s_mov_b32 s54, 0x1c0000
    s_mov_b32 s55, 0x20000
    v_lshlrev_b32 v9, 4, v1
    s_and_b32 s6, s3, 1
    s_lshr_b32 s7, s3, 1
    s_lshl_b32 s8, s4, 1
    s_add_u32 s8, s8, s6
    s_lshl_b32 s15, s5, 1
    s_add_u32 s15, s15, s7
    s_mul_i32 s12, s8, 28672
    s_lshl_b32 s14, s15, 11
    s_add_u32 s12, s12, s14
    s_lshl_b32 s9, s4, 16
    s_lshl_b32 s10, s3, 14
    s_add_u32 s9, s9, s10
    s_lshr_b32 s13, s4, 1
    s_lshl_b32 s13, s13, 7
    s_add_u32 s13, s13, 20480
    s_cmp_eq_u32 s3, 3
    s_cbranch_scc0 L_pdone_15
    s_mov_b64 exec, 0xffff
    v_lshlrev_b32 v6, 2, v1
L_poll_14:
    buffer_load_dword v5, v6, s[72:75], s13 offen sc1
    s_waitcnt vmcnt(0)
    v_cmp_ne_u32 vcc, s98, v5
    s_cbranch_vccz L_pdone_15_x
    s_sleep 2
    s_branch L_poll_14
L_pdone_15_x:
    s_mov_b64 exec, -1
L_pdone_15:
    s_barrier
    s_add_u32 s11, s9, 0
    s_add_u32 m0, s10, 0
    s_nop 0
    buffer_load_dwordx4 v9, s[48:51], s11 offen lds
    s_add_u32 s11, s9, 1024
    s_add_u32 m0, s10, 1024
    s_nop 0
    buffer_load_dwordx4 v9, s[48:51], s11 offen lds
    s_add_u32 s11, s9, 2048
    s_add_u32 m0, s10, 2048
    s_nop 0
    buffer_load_dwordx4 v9, s[48:51], s11 offen lds
    s_add_u32 s11, s9, 3072
    s_add_u32 m0, s10, 3072
    s_nop 0
    buffer_load_dwordx4 v9, s[48:51], s11 offen lds
    s_add_u32 s11, s9, 4096
    s_add_u32 m0, s10, 4096
    s_nop 0
    buffer_load_dwordx4 v9, s[48:51], s11 offen lds
    s_add_u32 s11, s9, 5120
    s_add_u32 m0, s10, 5120
    s_nop 0
    buffer_load_dwordx4 v9, s[48:51], s11 offen lds
    s_add_u32 s11, s9, 6144
    s_add_u32 m0, s10, 6144
    s_nop 0
    buffer_load_dwordx4 v9, s[48:51], s11 offen lds
    s_add_u32 s11, s9, 7168
    s_add_u32 m0, s10, 7168
    s_nop 0
    buffer_load_dwordx4 v9, s[48:51], s11 offen lds
    s_add_u32 s11, s9, 8192
    s_add_u32 m0, s10, 8192
    s_nop 0
    buffer_load_dwordx4 v9, s[48:51], s11 offen lds
    s_add_u32 s11, s9, 9216
    s_add_u32 m0, s10, 9216
    s_nop 0
    buffer_load_dwordx4 v9, s[48:51], s11 offen lds
    s_add_u32 s11, s9, 10240
    s_add_u32 m0, s10, 10240
    s_nop 0
    buffer_load_dwordx4 v9, s[48:51], s11 offen lds
    s_add_u32 s11, s9, 11264
    s_add_u32 m0, s10, 11264
    s_nop 0
    buffer_load_dwordx4 v9, s[48:51], s11 offen lds
    s_add_u32 s11, s9, 12288
    s_add_u32 m0, s10, 12288
    s_nop 0
    buffer_load_dwordx4 v9, s[48:51], s11 offen lds
    s_add_u32 s11, s9, 13312
    s_add_u32 m0, s10, 13312
    s_nop 0
    buffer_load_dwordx4 v9, s[48:51], s11 offen lds
    s_add_u32 s11, s9, 14336
    s_add_u32 m0, s10, 14336
    s_nop 0
    buffer_load_dwordx4 v9, s[48:51], s11 offen lds
    s_add_u32 s11, s9, 15360
    s_add_u32 m0, s10, 15360
    s_nop 0
    buffer_load_dwordx4 v9, s[48:51], s11 offen lds
    buffer_load_dwordx4 v[40:43], v9, s[40:43], s12 offen
    buffer_load_dwordx4 v[44:47], v9, s[40:43], s12 offen offset:1024
    s_lshl_b32 s11, s6, 15
    v_add_u32 v10, s11, v9
    s_lshl_b32 s11, s7, 15
    s_add_u32 s11, s11, 65536
    v_add_u32 v11, s11, v9
    s_waitcnt vmcnt(2)
    s_barrier
    ds_read_b128 v[64:67], v10 offset:0
    ds_read_b128 v[68:71], v11 offset:0
    ds_read_b128 v[72:75], v10 offset:1024
    ds_read_b128 v[76:79], v11 offset:1024
    ds_read_b128 v[80:83], v10 offset:2048
    ds_read_b128 v[84:87], v11 offset:2048
    ds_read_b128 v[88:91], v10 offset:3072
    ds_read_b128 v[92:95], v11 offset:3072
    ds_read_b128 v[96:99], v10 offset:4096
    ds_read_b128 v[100:103], v11 offset:4096
    ds_read_b128 v[104:107], v10 offset:5120
    ds_read_b128 v[108:111], v11 offset:5120
    s_waitcnt lgkmcnt(10)
    v_mfma_f32_32x32x16_bf16 v[16:31], v[68:71], v[64:67], 0
    ds_read_b128 v[64:67], v10 offset:6144
    ds_read_b128 v[68:71], v11 offset:6144
    s_waitcnt lgkmcnt(10)
    v_mfma_f32_32x32x16_bf16 v[16:31], v[76:79], v[72:75], v[16:31]
    ds_read_b128 v[72:75], v10 offset:7168
    ds_read_b128 v[76:79], v11 offset:7168
    s_waitcnt lgkmcnt(10)
    v_mfma_f32_32x32x16_bf16 v[16:31], v[84:87], v[80:83], v[16:31]
    ds_read_b128 v[80:83], v10 offset:8192
    ds_read_b128 v[84:87], v11 offset:8192
    s_waitcnt lgkmcnt(10)
    v_mfma_f32_32x32x16_bf16 v[16:31], v[92:95], v[88:91], v[16:31]
    ds_read_b128 v[88:91], v10 offset:9216
    ds_read_b128 v[92:95], v11 offset:9216
    s_waitcnt lgkmcnt(10)
    v_mfma_f32_32x32x16_bf16 v[16:31], v[100:103], v[96:99], v[16:31]
    ds_read_b128 v[96:99], v10 offset:10240
    ds_read_b128 v[100:103], v11 offset:10240
    s_waitcnt lgkmcnt(10)
    v_mfma_f32_32x32x16_bf16 v[16:31], v[108:111], v[104:107], v[16:31]
    ds_read_b128 v[104:107], v10 offset:11264
    ds_read_b128 v[108:111], v11 offset:11264
    s_waitcnt lgkmcnt(10)
    v_mfma_f32_32x32x16_bf16 v[16:31], v[68:71], v[64:67], v[16:31]
    ds_read_b128 v[64:67], v10 offset:12288
    ds_read_b128 v[68:71], v11 offset:12288
    s_waitcnt lgkmcnt(10)
    v_mfma_f32_32x32x16_bf16 v[16:31], v[76:79], v[72:75], v[16:31]
    ds_read_b128 v[72:75], v10 offset:13312
    ds_read_b128 v[76:79], v11 offset:13312
    s_waitcnt lgkmcnt(10)
    v_mfma_f32_32x32x16_bf16 v[16:31], v[84:87], v[80:83], v[16:31]
    ds_read_b128 v[80:83], v10 offset:14336
    ds_read_b128 v[84:87], v11 offset:14336
    s_waitcnt lgkmcnt(10)
    v_mfma_f32_32x32x16_bf16 v[16:31], v[92:95], v[88:91], v[16:31]
    ds_read_b128 v[88:91], v10 offset:15360
    ds_read_b128 v[92:95], v11 offset:15360
    s_waitcnt lgkmcnt(10)
    v_mfma_f32_32x32x16_bf16 v[16:31], v[100:103], v[96:99], v[16:31]
    ds_read_b128 v[96:99], v10 offset:16384
    ds_read_b128 v[100:103], v11 offset:16384
    s_waitcnt lgkmcnt(10)
    v_mfma_f32_32x32x16_bf16 v[16:31], v[108:111], v[104:107], v[16:31]
    ds_read_b128 v[104:107], v10 offset:17408
    ds_read_b128 v[108:111], v11 offset:17408
    s_waitcnt lgkmcnt(10)
    v_mfma_f32_32x32x16_bf16 v[16:31], v[68:71], v[64:67], v[16:31]
    ds_read_b128 v[64:67], v10 offset:18432
    ds_read_b128 v[68:71], v11 offset:18432
    s_waitcnt lgkmcnt(10)
    v_mfma_f32_32x32x16_bf16 v[16:31], v[76:79], v[72:75], v[16:31]
    ds_read_b128 v[72:75], v10 offset:19456
    ds_read_b128 v[76:79], v11 offset:19456
    s_waitcnt lgkmcnt(10)
    v_mfma_f32_32x32x16_bf16 v[16:31], v[84:87], v[80:83], v[16:31]
    ds_read_b128 v[80:83], v10 offset:20480
    ds_read_b128 v[84:87], v11 offset:20480
    s_waitcnt lgkmcnt(10)
    v_mfma_f32_32x32x16_bf16 v[16:31], v[92:95], v[88:91], v[16:31]
    ds_read_b128 v[88:91], v10 offset:21504
    ds_read_b128 v[92:95], v11 offset:21504
    s_waitcnt lgkmcnt(10)
    v_mfma_f32_32x32x16_bf16 v[16:31], v[100:103], v[96:99], v[16:31]
    ds_read_b128 v[96:99], v10 offset:22528
    ds_read_b128 v[100:103], v11 offset:22528
    s_waitcnt lgkmcnt(10)
    v_mfma_f32_32x32x16_bf16 v[16:31], v[108:111], v[104:107], v[16:31]
    ds_read_b128 v[104:107], v10 offset:23552
    ds_read_b128 v[108:111], v11 offset:23552
    s_waitcnt lgkmcnt(10)
    v_mfma_f32_32x32x16_bf16 v[16:31], v[68:71], v[64:67], v[16:31]
    ds_read_b128 v[64:67], v10 offset:24576
    ds_read_b128 v[68:71], v11 offset:24576
    s_waitcnt lgkmcnt(10)
    v_mfma_f32_32x32x16_bf16 v[16:31], v[76:79], v[72:75], v[16:31]
    ds_read_b128 v[72:75], v10 offset:25600
    ds_read_b128 v[76:79], v11 offset:25600
    s_waitcnt lgkmcnt(10)
    v_mfma_f32_32x32x16_bf16 v[16:31], v[84:87], v[80:83], v[16:31]
    ds_read_b128 v[80:83], v10 offset:26624
    ds_read_b128 v[84:87], v11 offset:26624
    s_waitcnt lgkmcnt(10)
    v_mfma_f32_32x32x16_bf16 v[16:31], v[92:95], v[88:91], v[16:31]
    ds_read_b128 v[88:91], v10 offset:27648
    ds_read_b128 v[92:95], v11 offset:27648
    s_waitcnt lgkmcnt(10)
    v_mfma_f32_32x32x16_bf16 v[16:31], v[100:103], v[96:99], v[16:31]
    ds_read_b128 v[96:99], v10 offset:28672
    ds_read_b128 v[100:103], v11 offset:28672
    s_waitcnt lgkmcnt(10)
    v_mfma_f32_32x32x16_bf16 v[16:31], v[108:111], v[104:107], v[16:31]
    ds_read_b128 v[104:107], v10 offset:29696
    ds_read_b128 v[108:111], v11 offset:29696
    s_waitcnt lgkmcnt(10)
    v_mfma_f32_32x32x16_bf16 v[16:31], v[68:71], v[64:67], v[16:31]
    ds_read_b128 v[64:67], v10 offset:30720
    ds_read_b128 v[68:71], v11 offset:30720
    s_waitcnt lgkmcnt(10)
    v_mfma_f32_32x32x16_bf16 v[16:31], v[76:79], v[72:75], v[16:31]
    ds_read_b128 v[72:75], v10 offset:31744
    ds_read_b128 v[76:79], v11 offset:31744
    s_waitcnt lgkmcnt(10)
    v_mfma_f32_32x32x16_bf16 v[16:31], v[84:87], v[80:83], v[16:31]
    s_waitcnt lgkmcnt(8)
    v_mfma_f32_32x32x16_bf16 v[16:31], v[92:95], v[88:91], v[16:31]
    s_waitcnt lgkmcnt(6)
    v_mfma_f32_32x32x16_bf16 v[16:31], v[100:103], v[96:99], v[16:31]
    s_waitcnt lgkmcnt(4)
    v_mfma_f32_32x32x16_bf16 v[16:31], v[108:111], v[104:107], v[16:31]
    s_waitcnt lgkmcnt(2)
    v_mfma_f32_32x32x16_bf16 v[16:31], v[68:71], v[64:67], v[16:31]
    s_waitcnt lgkmcnt(0)
    v_mfma_f32_32x32x16_bf16 v[16:31], v[76:79], v[72:75], v[16:31]
    s_barrier
    s_waitcnt vmcnt(0)
    v_permlane32_swap_b32 v40, v42
    v_permlane32_swap_b32 v41, v43
    v_permlane32_swap_b32 v44, v46
    v_permlane32_swap_b32 v45, v47
    s_nop 11
    v_lshlrev_b32 v14, 16, v40
    v_and_b32 v15, 0xffff0000, v40
    v_add_f32 v16, v16, v14
    v_add_f32 v17, v17, v15
    v_cvt_pk_bf16_f32 v40, v16, v17
    v_lshlrev_b32 v14, 16, v41
    v_and_b32 v15, 0xffff0000, v41
    v_add_f32 v18, v18, v14
    v_add_f32 v19, v19, v15
    v_cvt_pk_bf16_f32 v41, v18, v19
    v_lshlrev_b32 v14, 16, v42
    v_and_b32 v15, 0xffff0000, v42
    v_add_f32 v20, v20, v14
    v_add_f32 v21, v21, v15
    v_cvt_pk_bf16_f32 v42, v20, v21
    v_lshlrev_b32 v14, 16, v43
    v_and_b32 v15, 0xffff0000, v43
    v_add_f32 v22, v22, v14
    v_add_f32 v23, v23, v15
    v_cvt_pk_bf16_f32 v43, v22, v23
    v_lshlrev_b32 v14, 16, v44
    v_and_b32 v15, 0xffff0000, v44
    v_add_f32 v24, v24, v14
    v_add_f32 v25, v25, v15
    v_cvt_pk_bf16_f32 v44, v24, v25
    v_lshlrev_b32 v14, 16, v45
    v_and_b32 v15, 0xffff0000, v45
    v_add_f32 v26, v26, v14
    v_add_f32 v27, v27, v15
    v_cvt_pk_bf16_f32 v45, v26, v27
    v_lshlrev_b32 v14, 16, v46
    v_and_b32 v15, 0xffff0000, v46
    v_add_f32 v28, v28, v14
    v_add_f32 v29, v29, v15
    v_cvt_pk_bf16_f32 v46, v28, v29
    v_lshlrev_b32 v14, 16, v47
    v_and_b32 v15, 0xffff0000, v47
    v_add_f32 v30, v30, v14
    v_add_f32 v31, v31, v15
    v_cvt_pk_bf16_f32 v47, v30, v31
    s_nop 0
    v_permlane32_swap_b32 v40, v42
    v_permlane32_swap_b32 v41, v43
    v_permlane32_swap_b32 v44, v46
    v_permlane32_swap_b32 v45, v47
    buffer_store_dwordx4 v[40:43], v9, s[52:55], s12 offen offset:0 sc1
    buffer_store_dwordx4 v[44:47], v9, s[52:55], s12 offen offset:1024 sc1
    s_lshr_b32 s62, s4, 1
    s_lshl_b32 s62, s62, 7
    s_and_b32 s63, s4, 1
    s_mul_i32 s63, s63, 7
    s_add_u32 s63, s63, s5
    s_lshl_b32 s63, s63, 2
    s_add_u32 s62, s62, s63
    s_add_u32 s62, s62, 8192
    s_waitcnt vmcnt(0) lgkmcnt(0)
    s_barrier
    s_cmp_eq_u32 s3, 0
    s_cbranch_scc0 L_sig_16
    v_mov_b32 v5, s98
    v_mov_b32 v6, 0
    s_mov_b64 exec, 1
    buffer_store_dword v5, v6, s[72:75], s62 offen sc1
    s_mov_b64 exec, -1
L_sig_16:
    s_lshr_b32 s8, s2, 4
    s_add_u32 s44, s38, 0x2400000
    s_addc_u32 s45, s39, 0
    s_and_b32 s45, s45, 0xffff
    s_mov_b32 s46, 0x188000
    s_mov_b32 s47, 0x20000
    s_mul_i32 s8, s8, 114688
    s_lshl_b32 s10, s3, 10
    s_add_u32 s8, s8, s10
    s_add_u32 s12, s8, 0
    s_add_u32 m0, s10, 0
    s_nop 0
    buffer_load_dwordx4 v9, s[44:47], s12 offen lds
    s_add_u32 s12, s8, 4096
    s_add_u32 m0, s10, 4096
    s_nop 0
    buffer_load_dwordx4 v9, s[44:47], s12 offen lds
    s_add_u32 s12, s8, 8192
    s_add_u32 m0, s10, 8192
    s_nop 0
    buffer_load_dwordx4 v9, s[44:47], s12 offen lds
    s_add_u32 s12, s8, 12288
    s_add_u32 m0, s10, 12288
    s_nop 0
    buffer_load_dwordx4 v9, s[44:47], s12 offen lds
    s_add_u32 s12, s8, 16384
    s_add_u32 m0, s10, 16384
    s_nop 0
    buffer_load_dwordx4 v9, s[44:47], s12 offen lds
    s_add_u32 s12, s8, 20480
    s_add_u32 m0, s10, 20480
    s_nop 0
    buffer_load_dwordx4 v9, s[44:47], s12 offen lds
    s_add_u32 s12, s8, 24576
    s_add_u32 m0, s10, 24576
    s_nop 0
    buffer_load_dwordx4 v9, s[44:47], s12 offen lds
    s_add_u32 s12, s8, 28672
    s_add_u32 m0, s10, 28672
    s_nop 0
    buffer_load_dwordx4 v9, s[44:47], s12 offen lds
    s_add_u32 s12, s8, 32768
    s_add_u32 m0, s10, 32768
    s_nop 0
    buffer_load_dwordx4 v9, s[44:47], s12 offen lds
    s_add_u32 s12, s8, 36864
    s_add_u32 m0, s10, 36864
    s_nop 0
    buffer_load_dwordx4 v9, s[44:47], s12 offen lds
    s_add_u32 s12, s8, 40960
    s_add_u32 m0, s10, 40960
    s_nop 0
    buffer_load_dwordx4 v9, s[44:47], s12 offen lds
    s_add_u32 s12, s8, 45056
    s_add_u32 m0, s10, 45056
    s_nop 0
    buffer_load_dwordx4 v9, s[44:47], s12 offen lds
    s_add_u32 s12, s8, 49152
    s_add_u32 m0, s10, 49152
    s_nop 0
    buffer_load_dwordx4 v9, s[44:47], s12 offen lds
    s_add_u32 s12, s8, 53248
    s_add_u32 m0, s10, 53248
    s_nop 0
    buffer_load_dwordx4 v9, s[44:47], s12 offen lds
    s_add_u32 s12, s8, 57344
    s_add_u32 m0, s10, 57344
    s_nop 0
    buffer_load_dwordx4 v9, s[44:47], s12 offen lds
    s_add_u32 s12, s8, 61440
    s_add_u32 m0, s10, 61440
    s_nop 0
    buffer_load_dwordx4 v9, s[44:47], s12 offen lds
    s_add_u32 s12, s8, 65536
    s_add_u32 m0, s10, 65536
    s_nop 0
    buffer_load_dwordx4 v9, s[44:47], s12 offen lds
    s_add_u32 s12, s8, 69632
    s_add_u32 m0, s10, 69632
    s_nop 0
    buffer_load_dwordx4 v9, s[44:47], s12 offen lds
    s_add_u32 s12, s8, 73728
    s_add_u32 m0, s10, 73728
    s_nop 0
    buffer_load_dwordx4 v9, s[44:47], s12 offen lds
    s_add_u32 s12, s8, 77824
    s_add_u32 m0, s10, 77824
    s_nop 0
    buffer_load_dwordx4 v9, s[44:47], s12 offen lds
    s_add_u32 s12, s8, 81920
    s_add_u32 m0, s10, 81920
    s_nop 0
    buffer_load_dwordx4 v9, s[44:47], s12 offen lds
    s_add_u32 s12, s8, 86016
    s_add_u32 m0, s10, 86016
    s_nop 0
    buffer_load_dwordx4 v9, s[44:47], s12 offen lds
    s_add_u32 s12, s8, 90112
    s_add_u32 m0, s10, 90112
    s_nop 0
    buffer_load_dwordx4 v9, s[44:47], s12 offen lds
    s_add_u32 s12, s8, 94208
    s_add_u32 m0, s10, 94208
    s_nop 0
    buffer_load_dwordx4 v9, s[44:47], s12 offen lds
    s_add_u32 s12, s8, 98304
    s_add_u32 m0, s10, 98304
    s_nop 0
    buffer_load_dwordx4 v9, s[44:47], s12 offen lds
    s_add_u32 s12, s8, 102400
    s_add_u32 m0, s10, 102400
    s_nop 0
    buffer_load_dwordx4 v9, s[44:47], s12 offen lds
    s_add_u32 s12, s8, 106496
    s_add_u32 m0, s10, 106496
    s_nop 0
    buffer_load_dwordx4 v9, s[44:47], s12 offen lds
    s_add_u32 s12, s8, 110592
    s_add_u32 m0, s10, 110592
    s_nop 0
    buffer_load_dwordx4 v9, s[44:47], s12 offen lds
k2l0_end:
    s_cmp_ge_u32 s2, 224
    s_cbranch_scc1 k3l0_end
    s_and_b32 s4, s2, 7
    s_lshr_b32 s5, s2, 3
    s_lshr_b32 s6, s5, 1
    s_and_b32 s5, s5, 1
    s_lshl_b32 s4, s4, 1
    s_add_u32 s4, s4, s5
    s_mov_b32 s5, s6
    s_add_u32 s40, s38, 0x200000
    s_addc_u32 s41, s39, 0
    s_and_b32 s41, s41, 0xffff
    s_mov_b32 s42, 0x1c0000
    s_mov_b32 s43, 0x20000
    s_add_u32 s44, s38, 0x2400000
    s_addc_u32 s45, s39, 0
    s_and_b32 s45, s45, 0xffff
    s_mov_b32 s46, 0x188000
    s_mov_b32 s47, 0x20000
    s_mov_b32 s48, s28
    s_mov_b32 s49, s29
    s_and_b32 s49, s49, 0xffff
    s_mov_b32 s50, 0xe00
    s_mov_b32 s51, 0x20000
    s_add_u32 s52, s38, 0x1200000
    s_addc_u32 s53, s39, 0
    s_and_b32 s53, s53, 0xffff
    s_mov_b32 s54, 0x700000
    s_mov_b32 s55, 0x20000
    s_add_u32 s56, s38, 0x2902000
    s_addc_u32 s57, s39, 0
    s_and_b32 s57, s57, 0xffff
    s_mov_b32 s58, 0x2000
    s_mov_b32 s59, 0x20000
    v_lshlrev_b32 v9, 4, v1
    s_lshl_b32 s6, s4, 2
    s_add_u32 s6, s6, s3
    v_lshlrev_b32 v8, 3, v4
    s_lshl_b32 s11, s5, 8
    buffer_load_dwordx2 v[32:33], v8, s[48:51], s11 offen offset:0
    buffer_load_dwordx2 v[34:35], v8, s[48:51], s11 offen offset:16
    buffer_load_dwordx2 v[36:37], v8, s[48:51], s11 offen offset:32
    buffer_load_dwordx2 v[38:39], v8, s[48:51], s11 offen offset:48
    buffer_load_dwordx2 v[40:41], v8, s[48:51], s11 offen offset:64
    buffer_load_dwordx2 v[42:43], v8, s[48:51], s11 offen offset:80
    buffer_load_dwordx2 v[44:45], v8, s[48:51], s11 offen offset:96
    buffer_load_dwordx2 v[46:47], v8, s[48:51], s11 offen offset:112
    buffer_load_dwordx2 v[48:49], v8, s[48:51], s11 offen offset:128
    buffer_load_dwordx2 v[50:51], v8, s[48:51], s11 offen offset:144
    buffer_load_dwordx2 v[52:53], v8, s[48:51], s11 offen offset:160
    buffer_load_dwordx2 v[54:55], v8, s[48:51], s11 offen offset:176
    buffer_load_dwordx2 v[56:57], v8, s[48:51], s11 offen offset:192
    buffer_load_dwordx2 v[58:59], v8, s[48:51], s11 offen offset:208
    buffer_load_dwordx2 v[60:61], v8, s[48:51], s11 offen offset:224
    buffer_load_dwordx2 v[62:63], v8, s[48:51], s11 offen offset:240
    v_add_u32 v10, 57344, v9
    v_lshlrev_b32 v7, 4, v4
    s_lshl_b32 s14, s5, 9
    s_lshl_b32 s12, s4, 7
    s_add_u32 s12, s12, 8192
    s_cmp_eq_u32 s3, 3
    s_cbranch_scc0 L_pdone_18
    s_mov_b64 exec, 0x3fff
    v_lshlrev_b32 v6, 2, v1
L_poll_17:
    buffer_load_dword v5, v6, s[72:75], s12 offen sc1
    s_waitcnt vmcnt(0)
    v_cmp_ne_u32 vcc, s98, v5
    s_cbranch_vccz L_pdone_18_x
    s_sleep 2
    s_branch L_poll_17
L_pdone_18_x:
    s_mov_b64 exec, -1
L_pdone_18:
    s_barrier
    s_mul_i32 s7, s6, 28672
    buffer_load_dwordx4 v[64:67], v9, s[40:43], s7 offen offset:0
    buffer_load_dwordx4 v[68:71], v9, s[40:43], s7 offen offset:1024
    buffer_load_dwordx4 v[72:75], v9, s[40:43], s7 offen offset:2048
    buffer_load_dwordx4 v[76:79], v9, s[40:43], s7 offen offset:3072
    s_add_u32 s7, s7, 4096
    buffer_load_dwordx4 v[80:83], v9, s[40:43], s7 offen offset:0
    buffer_load_dwordx4 v[84:87], v9, s[40:43], s7 offen offset:1024
    buffer_load_dwordx4 v[88:91], v9, s[40:43], s7 offen offset:2048
    buffer_load_dwordx4 v[92:95], v9, s[40:43], s7 offen offset:3072
    s_add_u32 s7, s7, 4096
    buffer_load_dwordx4 v[96:99], v9, s[40:43], s7 offen offset:0
    buffer_load_dwordx4 v[100:103], v9, s[40:43], s7 offen offset:1024
    buffer_load_dwordx4 v[104:107], v9, s[40:43], s7 offen offset:2048
    buffer_load_dwordx4 v[108:111], v9, s[40:43], s7 offen offset:3072
    s_add_u32 s7, s7, 4096
    buffer_load_dwordx4 v[112:115], v9, s[40:43], s7 offen offset:0
    buffer_load_dwordx4 v[116:119], v9, s[40:43], s7 offen offset:1024
    buffer_load_dwordx4 v[120:123], v9, s[40:43], s7 offen offset:2048
    buffer_load_dwordx4 v[124:127], v9, s[40:43], s7 offen offset:3072
    s_add_u32 s7, s7, 4096
    buffer_load_dwordx4 v[128:131], v9, s[40:43], s7 offen offset:0
    buffer_load_dwordx4 v[132:135], v9, s[40:43], s7 offen offset:1024
    buffer_load_dwordx4 v[136:139], v9, s[40:43], s7 offen offset:2048
    buffer_load_dwordx4 v[140:143], v9, s[40:43], s7 offen offset:3072
    s_add_u32 s7, s7, 4096
    buffer_load_dwordx4 v[144:147], v9, s[40:43], s7 offen offset:0
    buffer_load_dwordx4 v[148:151], v9, s[40:43], s7 offen offset:1024
    buffer_load_dwordx4 v[152:155], v9, s[40:43], s7 offen offset:2048
    buffer_load_dwordx4 v[156:159], v9, s[40:43], s7 offen offset:3072
    s_add_u32 s7, s7, 4096
    buffer_load_dwordx4 v[160:163], v9, s[40:43], s7 offen offset:0
    buffer_load_dwordx4 v[164:167], v9, s[40:43], s7 offen offset:1024
    buffer_load_dwordx4 v[168:171], v9, s[40:43], s7 offen offset:2048
    buffer_load_dwordx4 v[172:175], v9, s[40:43], s7 offen offset:3072
    v_mov_b32 v21, 0xbdd2d3e8
    s_mul_i32 s15, s6, 114688
    s_lshl_b32 s13, s5, 13
    s_add_u32 s15, s15, s13
    s_add_u32 s63, s15, 4096
    v_mov_b32 v14, 0
    v_mov_b32 v15, 0
    s_waitcnt vmcnt(28)
    s_barrier
    ds_read_b128 v[208:211], v9 offset:0
    ds_read_b128 v[212:215], v9 offset:1024
    ds_read_b128 v[216:219], v9 offset:2048
    buffer_load_dwordx4 v[224:227], v7, s[56:59], s14 offen offset:0
    buffer_load_dwordx4 v[228:231], v7, s[56:59], s14 offen offset:32
    buffer_load_dwordx4 v[232:235], v7, s[56:59], s14 offen offset:64
    buffer_load_dwordx4 v[236:239], v7, s[56:59], s14 offen offset:96
    ds_read_b128 v[220:223], v9 offset:3072
    s_waitcnt vmcnt(31) lgkmcnt(3)
    v_mfma_f32_32x32x16_bf16 v[176:191], v[208:211], v[64:67], 0
    ds_read_b128 v[208:211], v9 offset:4096
    s_waitcnt vmcnt(30) lgkmcnt(3)
    v_mfma_f32_32x32x16_bf16 v[176:191], v[212:215], v[68:71], v[176:191]
    ds_read_b128 v[212:215], v9 offset:5120
    s_waitcnt vmcnt(29) lgkmcnt(3)
    v_mfma_f32_32x32x16_bf16 v[176:191], v[216:219], v[72:75], v[176:191]
    ds_read_b128 v[216:219], v9 offset:6144
    s_waitcnt vmcnt(28) lgkmcnt(3)
    v_mfma_f32_32x32x16_bf16 v[176:191], v[220:223], v[76:79], v[176:191]
    ds_read_b128 v[220:223], v9 offset:7168
    s_waitcnt vmcnt(27) lgkmcnt(3)
    v_mfma_f32_32x32x16_bf16 v[176:191], v[208:211], v[80:83], v[176:191]
    ds_read_b128 v[208:211], v9 offset:8192
    s_waitcnt vmcnt(26) lgkmcnt(3)
    v_mfma_f32_32x32x16_bf16 v[176:191], v[212:215], v[84:87], v[176:191]
    ds_read_b128 v[212:215], v9 offset:9216
    s_waitcnt vmcnt(25) lgkmcnt(3)
    v_mfma_f32_32x32x16_bf16 v[176:191], v[216:219], v[88:91], v[176:191]
    ds_read_b128 v[216:219], v9 offset:10240
    s_waitcnt vmcnt(24) lgkmcnt(3)
    v_mfma_f32_32x32x16_bf16 v[176:191], v[220:223], v[92:95], v[176:191]
    ds_read_b128 v[220:223], v9 offset:11264
    s_waitcnt vmcnt(23) lgkmcnt(3)
    v_mfma_f32_32x32x16_bf16 v[176:191], v[208:211], v[96:99], v[176:191]
    ds_read_b128 v[208:211], v9 offset:12288
    s_waitcnt vmcnt(22) lgkmcnt(3)
    v_mfma_f32_32x32x16_bf16 v[176:191], v[212:215], v[100:103], v[176:191]
    ds_read_b128 v[212:215], v9 offset:13312
    s_waitcnt vmcnt(21) lgkmcnt(3)
    v_mfma_f32_32x32x16_bf16 v[176:191], v[216:219], v[104:107], v[176:191]
    ds_read_b128 v[216:219], v9 offset:14336
    s_waitcnt vmcnt(20) lgkmcnt(3)
    v_mfma_f32_32x32x16_bf16 v[176:191], v[220:223], v[108:111], v[176:191]
    ds_read_b128 v[220:223], v9 offset:15360
    s_waitcnt vmcnt(19) lgkmcnt(3)
    v_mfma_f32_32x32x16_bf16 v[176:191], v[208:211], v[112:115], v[176:191]
    ds_read_b128 v[208:211], v9 offset:16384
    s_waitcnt vmcnt(18) lgkmcnt(3)
    v_mfma_f32_32x32x16_bf16 v[176:191], v[212:215], v[116:119], v[176:191]
    ds_read_b128 v[212:215], v9 offset:17408
    s_waitcnt vmcnt(17) lgkmcnt(3)
    v_mfma_f32_32x32x16_bf16 v[176:191], v[216:219], v[120:123], v[176:191]
    ds_read_b128 v[216:219], v9 offset:18432
    s_waitcnt vmcnt(16) lgkmcnt(3)
    v_mfma_f32_32x32x16_bf16 v[176:191], v[220:223], v[124:127], v[176:191]
    ds_read_b128 v[220:223], v9 offset:19456
    s_waitcnt vmcnt(15) lgkmcnt(3)
    v_mfma_f32_32x32x16_bf16 v[176:191], v[208:211], v[128:131], v[176:191]
    ds_read_b128 v[208:211], v9 offset:20480
    s_waitcnt vmcnt(14) lgkmcnt(3)
    v_mfma_f32_32x32x16_bf16 v[176:191], v[212:215], v[132:135], v[176:191]
    ds_read_b128 v[212:215], v9 offset:21504
    s_waitcnt vmcnt(13) lgkmcnt(3)
    v_mfma_f32_32x32x16_bf16 v[176:191], v[216:219], v[136:139], v[176:191]
    ds_read_b128 v[216:219], v9 offset:22528
    s_waitcnt vmcnt(12) lgkmcnt(3)
    v_mfma_f32_32x32x16_bf16 v[176:191], v[220:223], v[140:143], v[176:191]
    ds_read_b128 v[220:223], v9 offset:23552
    s_waitcnt vmcnt(11) lgkmcnt(3)
    v_mfma_f32_32x32x16_bf16 v[176:191], v[208:211], v[144:147], v[176:191]
    ds_read_b128 v[208:211], v9 offset:24576
    s_waitcnt vmcnt(10) lgkmcnt(3)
    v_mfma_f32_32x32x16_bf16 v[176:191], v[212:215], v[148:151], v[176:191]
    ds_read_b128 v[212:215], v9 offset:25600
    s_waitcnt vmcnt(9) lgkmcnt(3)
    v_mfma_f32_32x32x16_bf16 v[176:191], v[216:219], v[152:155], v[176:191]
    ds_read_b128 v[216:219], v9 offset:26624
    s_waitcnt vmcnt(8) lgkmcnt(3)
    v_mfma_f32_32x32x16_bf16 v[176:191], v[220:223], v[156:159], v[176:191]
    ds_read_b128 v[220:223], v9 offset:27648
    s_waitcnt vmcnt(7) lgkmcnt(3)
    v_mfma_f32_32x32x16_bf16 v[176:191], v[208:211], v[160:163], v[176:191]
    ds_read_b128 v[208:211], v9 offset:28672
    s_waitcnt vmcnt(6) lgkmcnt(3)
    v_mfma_f32_32x32x16_bf16 v[176:191], v[212:215], v[164:167], v[176:191]
    ds_read_b128 v[212:215], v9 offset:29696
    s_waitcnt vmcnt(5) lgkmcnt(3)
    v_mfma_f32_32x32x16_bf16 v[176:191], v[216:219], v[168:171], v[176:191]
    ds_read_b128 v[216:219], v9 offset:30720
    s_waitcnt vmcnt(4) lgkmcnt(3)
    v_mfma_f32_32x32x16_bf16 v[176:191], v[220:223], v[172:175], v[176:191]
    v_mov_b32 v16, 0x3f803f80
    v_mov_b32 v14, 0
    v_mov_b32 v15, 0
    v_dot2_f32_bf16 v14, v64, v16, v14
    v_dot2_f32_bf16 v15, v64, v64, v15
    v_dot2_f32_bf16 v14, v65, v16, v14
    v_dot2_f32_bf16 v15, v65, v65, v15
    v_dot2_f32_bf16 v14, v66, v16, v14
    v_dot2_f32_bf16 v15, v66, v66, v15
    v_dot2_f32_bf16 v14, v67, v16, v14
    v_dot2_f32_bf16 v15, v67, v67, v15
    v_dot2_f32_bf16 v14, v68, v16, v14
    v_dot2_f32_bf16 v15, v68, v68, v15
    v_dot2_f32_bf16 v14, v69, v16, v14
    v_dot2_f32_bf16 v15, v69, v69, v15
    v_dot2_f32_bf16 v14, v70, v16, v14
    v_dot2_f32_bf16 v15, v70, v70, v15
    v_dot2_f32_bf16 v14, v71, v16, v14
    v_dot2_f32_bf16 v15, v71, v71, v15
    v_dot2_f32_bf16 v14, v72, v16, v14
    v_dot2_f32_bf16 v15, v72, v72, v15
    v_dot2_f32_bf16 v14, v73, v16, v14
    v_dot2_f32_bf16 v15, v73, v73, v15
    v_dot2_f32_bf16 v14, v74, v16, v14
    v_dot2_f32_bf16 v15, v74, v74, v15
    v_dot2_f32_bf16 v14, v75, v16, v14
    v_dot2_f32_bf16 v15, v75, v75, v15
    v_dot2_f32_bf16 v14, v76, v16, v14
    v_dot2_f32_bf16 v15, v76, v76, v15
    v_dot2_f32_bf16 v14, v77, v16, v14
    v_dot2_f32_bf16 v15, v77, v77, v15
    v_dot2_f32_bf16 v14, v78, v16, v14
    v_dot2_f32_bf16 v15, v78, v78, v15
    v_dot2_f32_bf16 v14, v79, v16, v14
    v_dot2_f32_bf16 v15, v79, v79, v15
    v_dot2_f32_bf16 v14, v80, v16, v14
    v_dot2_f32_bf16 v15, v80, v80, v15
    v_dot2_f32_bf16 v14, v81, v16, v14
    v_dot2_f32_bf16 v15, v81, v81, v15
    v_dot2_f32_bf16 v14, v82, v16, v14
    v_dot2_f32_bf16 v15, v82, v82, v15
    v_dot2_f32_bf16 v14, v83, v16, v14
    v_dot2_f32_bf16 v15, v83, v83, v15
    v_dot2_f32_bf16 v14, v84, v16, v14
    v_dot2_f32_bf16 v15, v84, v84, v15
    v_dot2_f32_bf16 v14, v85, v16, v14
    v_dot2_f32_bf16 v15, v85, v85, v15
    v_dot2_f32_bf16 v14, v86, v16, v14
    v_dot2_f32_bf16 v15, v86, v86, v15
    v_dot2_f32_bf16 v14, v87, v16, v14
    v_dot2_f32_bf16 v15, v87, v87, v15
    v_dot2_f32_bf16 v14, v88, v16, v14
    v_dot2_f32_bf16 v15, v88, v88, v15
    v_dot2_f32_bf16 v14, v89, v16, v14
    v_dot2_f32_bf16 v15, v89, v89, v15
    v_dot2_f32_bf16 v14, v90, v16, v14
    v_dot2_f32_bf16 v15, v90, v90, v15
    v_dot2_f32_bf16 v14, v91, v16, v14
    v_dot2_f32_bf16 v15, v91, v91, v15
    v_dot2_f32_bf16 v14, v92, v16, v14
    v_dot2_f32_bf16 v15, v92, v92, v15
    v_dot2_f32_bf16 v14, v93, v16, v14
    v_dot2_f32_bf16 v15, v93, v93, v15
    v_dot2_f32_bf16 v14, v94, v16, v14
    v_dot2_f32_bf16 v15, v94, v94, v15
    v_dot2_f32_bf16 v14, v95, v16, v14
    v_dot2_f32_bf16 v15, v95, v95, v15
    v_dot2_f32_bf16 v14, v96, v16, v14
    v_dot2_f32_bf16 v15, v96, v96, v15
    v_dot2_f32_bf16 v14, v97, v16, v14
    v_dot2_f32_bf16 v15, v97, v97, v15
    v_dot2_f32_bf16 v14, v98, v16, v14
    v_dot2_f32_bf16 v15, v98, v98, v15
    v_dot2_f32_bf16 v14, v99, v16, v14
    v_dot2_f32_bf16 v15, v99, v99, v15
    v_dot2_f32_bf16 v14, v100, v16, v14
    v_dot2_f32_bf16 v15, v100, v100, v15
    v_dot2_f32_bf16 v14, v101, v16, v14
    v_dot2_f32_bf16 v15, v101, v101, v15
    v_dot2_f32_bf16 v14, v102, v16, v14
    v_dot2_f32_bf16 v15, v102, v102, v15
    v_dot2_f32_bf16 v14, v103, v16, v14
    v_dot2_f32_bf16 v15, v103, v103, v15
    v_dot2_f32_bf16 v14, v104, v16, v14
    v_dot2_f32_bf16 v15, v104, v104, v15
    v_dot2_f32_bf16 v14, v105, v16, v14
    v_dot2_f32_bf16 v15, v105, v105, v15
    v_dot2_f32_bf16 v14, v106, v16, v14
    v_dot2_f32_bf16 v15, v106, v106, v15
    v_dot2_f32_bf16 v14, v107, v16, v14
    v_dot2_f32_bf16 v15, v107, v107, v15
    v_dot2_f32_bf16 v14, v108, v16, v14
    v_dot2_f32_bf16 v15, v108, v108, v15
    v_dot2_f32_bf16 v14, v109, v16, v14
    v_dot2_f32_bf16 v15, v109, v109, v15
    v_dot2_f32_bf16 v14, v110, v16, v14
    v_dot2_f32_bf16 v15, v110, v110, v15
    v_dot2_f32_bf16 v14, v111, v16, v14
    v_dot2_f32_bf16 v15, v111, v111, v15
    v_dot2_f32_bf16 v14, v112, v16, v14
    v_dot2_f32_bf16 v15, v112, v112, v15
    v_dot2_f32_bf16 v14, v113, v16, v14
    v_dot2_f32_bf16 v15, v113, v113, v15
    v_dot2_f32_bf16 v14, v114, v16, v14
    v_dot2_f32_bf16 v15, v114, v114, v15
    v_dot2_f32_bf16 v14, v115, v16, v14
    v_dot2_f32_bf16 v15, v115, v115, v15
    v_dot2_f32_bf16 v14, v116, v16, v14
    v_dot2_f32_bf16 v15, v116, v116, v15
    v_dot2_f32_bf16 v14, v117, v16, v14
    v_dot2_f32_bf16 v15, v117, v117, v15
    v_dot2_f32_bf16 v14, v118, v16, v14
    v_dot2_f32_bf16 v15, v118, v118, v15
    v_dot2_f32_bf16 v14, v119, v16, v14
    v_dot2_f32_bf16 v15, v119, v119, v15
    v_dot2_f32_bf16 v14, v120, v16, v14
    v_dot2_f32_bf16 v15, v120, v120, v15
    v_dot2_f32_bf16 v14, v121, v16, v14
    v_dot2_f32_bf16 v15, v121, v121, v15
    v_dot2_f32_bf16 v14, v122, v16, v14
    v_dot2_f32_bf16 v15, v122, v122, v15
    v_dot2_f32_bf16 v14, v123, v16, v14
    v_dot2_f32_bf16 v15, v123, v123, v15
    v_dot2_f32_bf16 v14, v124, v16, v14
    v_dot2_f32_bf16 v15, v124, v124, v15
    v_dot2_f32_bf16 v14, v125, v16, v14
    v_dot2_f32_bf16 v15, v125, v125, v15
    v_dot2_f32_bf16 v14, v126, v16, v14
    v_dot2_f32_bf16 v15, v126, v126, v15
    v_dot2_f32_bf16 v14, v127, v16, v14
    v_dot2_f32_bf16 v15, v127, v127, v15
    v_dot2_f32_bf16 v14, v128, v16, v14
    v_dot2_f32_bf16 v15, v128, v128, v15
    v_dot2_f32_bf16 v14, v129, v16, v14
    v_dot2_f32_bf16 v15, v129, v129, v15
    v_dot2_f32_bf16 v14, v130, v16, v14
    v_dot2_f32_bf16 v15, v130, v130, v15
    v_dot2_f32_bf16 v14, v131, v16, v14
    v_dot2_f32_bf16 v15, v131, v131, v15
    v_dot2_f32_bf16 v14, v132, v16, v14
    v_dot2_f32_bf16 v15, v132, v132, v15
    v_dot2_f32_bf16 v14, v133, v16, v14
    v_dot2_f32_bf16 v15, v133, v133, v15
    v_dot2_f32_bf16 v14, v134, v16, v14
    v_dot2_f32_bf16 v15, v134, v134, v15
    v_dot2_f32_bf16 v14, v135, v16, v14
    v_dot2_f32_bf16 v15, v135, v135, v15
    v_dot2_f32_bf16 v14, v136, v16, v14
    v_dot2_f32_bf16 v15, v136, v136, v15
    v_dot2_f32_bf16 v14, v137, v16, v14
    v_dot2_f32_bf16 v15, v137, v137, v15
    v_dot2_f32_bf16 v14, v138, v16, v14
    v_dot2_f32_bf16 v15, v138, v138, v15
    v_dot2_f32_bf16 v14, v139, v16, v14
    v_dot2_f32_bf16 v15, v139, v139, v15
    v_dot2_f32_bf16 v14, v140, v16, v14
    v_dot2_f32_bf16 v15, v140, v140, v15
    v_dot2_f32_bf16 v14, v141, v16, v14
    v_dot2_f32_bf16 v15, v141, v141, v15
    v_dot2_f32_bf16 v14, v142, v16, v14
    v_dot2_f32_bf16 v15, v142, v142, v15
    v_dot2_f32_bf16 v14, v143, v16, v14
    v_dot2_f32_bf16 v15, v143, v143, v15
    v_dot2_f32_bf16 v14, v144, v16, v14
    v_dot2_f32_bf16 v15, v144, v144, v15
    v_dot2_f32_bf16 v14, v145, v16, v14
    v_dot2_f32_bf16 v15, v145, v145, v15
    v_dot2_f32_bf16 v14, v146, v16, v14
    v_dot2_f32_bf16 v15, v146, v146, v15
    v_dot2_f32_bf16 v14, v147, v16, v14
    v_dot2_f32_bf16 v15, v147, v147, v15
    v_dot2_f32_bf16 v14, v148, v16, v14
    v_dot2_f32_bf16 v15, v148, v148, v15
    v_dot2_f32_bf16 v14, v149, v16, v14
    v_dot2_f32_bf16 v15, v149, v149, v15
    v_dot2_f32_bf16 v14, v150, v16, v14
    v_dot2_f32_bf16 v15, v150, v150, v15
    v_dot2_f32_bf16 v14, v151, v16, v14
    v_dot2_f32_bf16 v15, v151, v151, v15
    v_dot2_f32_bf16 v14, v152, v16, v14
    v_dot2_f32_bf16 v15, v152, v152, v15
    v_dot2_f32_bf16 v14, v153, v16, v14
    v_dot2_f32_bf16 v15, v153, v153, v15
    v_dot2_f32_bf16 v14, v154, v16, v14
    v_dot2_f32_bf16 v15, v154, v154, v15
    v_dot2_f32_bf16 v14, v155, v16, v14
    v_dot2_f32_bf16 v15, v155, v155, v15
    v_dot2_f32_bf16 v14, v156, v16, v14
    v_dot2_f32_bf16 v15, v156, v156, v15
    v_dot2_f32_bf16 v14, v157, v16, v14
    v_dot2_f32_bf16 v15, v157, v157, v15
    v_dot2_f32_bf16 v14, v158, v16, v14
    v_dot2_f32_bf16 v15, v158, v158, v15
    v_dot2_f32_bf16 v14, v159, v16, v14
    v_dot2_f32_bf16 v15, v159, v159, v15
    v_dot2_f32_bf16 v14, v160, v16, v14
    v_dot2_f32_bf16 v15, v160, v160, v15
    v_dot2_f32_bf16 v14, v161, v16, v14
    v_dot2_f32_bf16 v15, v161, v161, v15
    v_dot2_f32_bf16 v14, v162, v16, v14
    v_dot2_f32_bf16 v15, v162, v162, v15
    v_dot2_f32_bf16 v14, v163, v16, v14
    v_dot2_f32_bf16 v15, v163, v163, v15
    v_dot2_f32_bf16 v14, v164, v16, v14
    v_dot2_f32_bf16 v15, v164, v164, v15
    v_dot2_f32_bf16 v14, v165, v16, v14
    v_dot2_f32_bf16 v15, v165, v165, v15
    v_dot2_f32_bf16 v14, v166, v16, v14
    v_dot2_f32_bf16 v15, v166, v166, v15
    v_dot2_f32_bf16 v14, v167, v16, v14
    v_dot2_f32_bf16 v15, v167, v167, v15
    v_dot2_f32_bf16 v14, v168, v16, v14
    v_dot2_f32_bf16 v15, v168, v168, v15
    v_dot2_f32_bf16 v14, v169, v16, v14
    v_dot2_f32_bf16 v15, v169, v169, v15
    v_dot2_f32_bf16 v14, v170, v16, v14
    v_dot2_f32_bf16 v15, v170, v170, v15
    v_dot2_f32_bf16 v14, v171, v16, v14
    v_dot2_f32_bf16 v15, v171, v171, v15
    v_dot2_f32_bf16 v14, v172, v16, v14
    v_dot2_f32_bf16 v15, v172, v172, v15
    v_dot2_f32_bf16 v14, v173, v16, v14
    v_dot2_f32_bf16 v15, v173, v173, v15
    v_dot2_f32_bf16 v14, v174, v16, v14
    v_dot2_f32_bf16 v15, v174, v174, v15
    v_dot2_f32_bf16 v14, v175, v16, v14
    v_dot2_f32_bf16 v15, v175, v175, v15
    s_nop 2
    v_mov_b32 v16, v14
    s_nop 1
    v_permlane32_swap_b32 v14, v16
    s_nop 0
    v_add_f32 v14, v14, v16
    v_mov_b32 v16, v15
    s_nop 1
    v_permlane32_swap_b32 v15, v16
    s_nop 0
    v_add_f32 v15, v15, v16
    v_mul_f32 v14, 0x3b124925, v14
    v_mul_f32 v15, 0x3b124925, v15
    v_fma_f32 v15, -v14, v14, v15
    v_max_f32 v15, 0, v15
    v_add_f32 v15, 0x3727c5ac, v15
    v_rsq_f32 v18, v15
    s_nop 0
    v_mul_f32 v17, v14, v18
    v_sub_f32 v17, 0, v17
    s_waitcnt vmcnt(0)
    buffer_load_dwordx4 v[240:243], v7, s[56:59], s14 offen offset:128
    buffer_load_dwordx4 v[244:247], v7, s[56:59], s14 offen offset:160
    buffer_load_dwordx4 v[248:251], v7, s[56:59], s14 offen offset:192
    buffer_load_dwordx4 v[252:255], v7, s[56:59], s14 offen offset:224
    ds_read_b128 v[220:223], v9 offset:31744
    s_waitcnt lgkmcnt(3)
    v_mfma_f32_32x32x16_bf16 v[192:207], v[208:211], v[64:67], 0
    ds_read_b128 v[208:211], v9 offset:32768
    s_waitcnt lgkmcnt(3)
    v_mfma_f32_32x32x16_bf16 v[192:207], v[212:215], v[68:71], v[192:207]
    ds_read_b128 v[212:215], v9 offset:33792
    s_waitcnt lgkmcnt(3)
    v_mfma_f32_32x32x16_bf16 v[192:207], v[216:219], v[72:75], v[192:207]
    v_lshlrev_b32 v22, 16, v32
    v_fma_f32 v22, v224, v17, v22
    v_fma_f32 v176, v176, v18, v22
    v_mul_f32 v22, v176, v176
    v_fmaak_f32 v22, v21, v22, 0xc0135761
    v_mul_f32 v22, v176, v22
    v_exp_f32 v22, v22
    s_nop 0
    ds_read_b128 v[216:219], v9 offset:34816
    s_waitcnt lgkmcnt(3)
    v_mfma_f32_32x32x16_bf16 v[192:207], v[220:223], v[76:79], v[192:207]
    v_add_f32 v22, 1.0, v22
    v_rcp_f32 v22, v22
    s_nop 0
    v_mul_f32 v176, v176, v22
    v_and_b32 v23, 0xffff0000, v32
    v_fma_f32 v23, v225, v17, v23
    v_fma_f32 v177, v177, v18, v23
    v_mul_f32 v23, v177, v177
    ds_read_b128 v[220:223], v9 offset:35840
    s_waitcnt lgkmcnt(3)
    v_mfma_f32_32x32x16_bf16 v[192:207], v[208:211], v[80:83], v[192:207]
    v_fmaak_f32 v23, v21, v23, 0xc0135761
    v_mul_f32 v23, v177, v23
    v_exp_f32 v23, v23
    s_nop 0
    v_add_f32 v23, 1.0, v23
    v_rcp_f32 v23, v23
    s_nop 0
    v_mul_f32 v177, v177, v23
    ds_read_b128 v[208:211], v9 offset:36864
    s_waitcnt lgkmcnt(3)
    v_mfma_f32_32x32x16_bf16 v[192:207], v[212:215], v[84:87], v[192:207]
    v_lshlrev_b32 v22, 16, v33
    v_fma_f32 v22, v226, v17, v22
    v_fma_f32 v178, v178, v18, v22
    v_mul_f32 v22, v178, v178
    v_fmaak_f32 v22, v21, v22, 0xc0135761
    v_mul_f32 v22, v178, v22
    v_exp_f32 v22, v22
    s_nop 0
    ds_read_b128 v[212:215], v9 offset:37888
    s_waitcnt lgkmcnt(3)
    v_mfma_f32_32x32x16_bf16 v[192:207], v[216:219], v[88:91], v[192:207]
    v_add_f32 v22, 1.0, v22
    v_rcp_f32 v22, v22
    s_nop 0
    v_mul_f32 v178, v178, v22
    v_and_b32 v23, 0xffff0000, v33
    v_fma_f32 v23, v227, v17, v23
    v_fma_f32 v179, v179, v18, v23
    v_mul_f32 v23, v179, v179
    ds_read_b128 v[216:219], v9 offset:38912
    s_waitcnt lgkmcnt(3)
    v_mfma_f32_32x32x16_bf16 v[192:207], v[220:223], v[92:95], v[192:207]
    v_fmaak_f32 v23, v21, v23, 0xc0135761
    v_mul_f32 v23, v179, v23
    v_exp_f32 v23, v23
    s_nop 0
    v_add_f32 v23, 1.0, v23
    v_rcp_f32 v23, v23
    s_nop 0
    v_mul_f32 v179, v179, v23
    ds_read_b128 v[220:223], v9 offset:39936
    s_waitcnt lgkmcnt(3)
    v_mfma_f32_32x32x16_bf16 v[192:207], v[208:211], v[96:99], v[192:207]
    v_lshlrev_b32 v22, 16, v34
    v_fma_f32 v22, v228, v17, v22
    v_fma_f32 v180, v180, v18, v22
    v_mul_f32 v22, v180, v180
    v_fmaak_f32 v22, v21, v22, 0xc0135761
    v_mul_f32 v22, v180, v22
    v_exp_f32 v22, v22
    s_nop 0
    ds_read_b128 v[208:211], v9 offset:40960
    s_waitcnt lgkmcnt(3)
    v_mfma_f32_32x32x16_bf16 v[192:207], v[212:215], v[100:103], v[192:207]
    v_add_f32 v22, 1.0, v22
    v_rcp_f32 v22, v22
    s_nop 0
    v_mul_f32 v180, v180, v22
    v_and_b32 v23, 0xffff0000, v34
    v_fma_f32 v23, v229, v17, v23
    v_fma_f32 v181, v181, v18, v23
    v_mul_f32 v23, v181, v181
    ds_read_b128 v[212:215], v9 offset:41984
    s_waitcnt lgkmcnt(3)
    v_mfma_f32_32x32x16_bf16 v[192:207], v[216:219], v[104:107], v[192:207]
    v_fmaak_f32 v23, v21, v23, 0xc0135761
    v_mul_f32 v23, v181, v23
    v_exp_f32 v23, v23
    s_nop 0
    v_add_f32 v23, 1.0, v23
    v_rcp_f32 v23, v23
    s_nop 0
    v_mul_f32 v181, v181, v23
    ds_read_b128 v[216:219], v9 offset:43008
    s_waitcnt lgkmcnt(3)
    v_mfma_f32_32x32x16_bf16 v[192:207], v[220:223], v[108:111], v[192:207]
    v_lshlrev_b32 v22, 16, v35
    v_fma_f32 v22, v230, v17, v22
    v_fma_f32 v182, v182, v18, v22
    v_mul_f32 v22, v182, v182
    v_fmaak_f32 v22, v21, v22, 0xc0135761
    v_mul_f32 v22, v182, v22
    v_exp_f32 v22, v22
    s_nop 0
    ds_read_b128 v[220:223], v9 offset:44032
    s_waitcnt lgkmcnt(3)
    v_mfma_f32_32x32x16_bf16 v[192:207], v[208:211], v[112:115], v[192:207]
    v_add_f32 v22, 1.0, v22
    v_rcp_f32 v22, v22
    s_nop 0
    v_mul_f32 v182, v182, v22
    v_and_b32 v23, 0xffff0000, v35
    v_fma_f32 v23, v231, v17, v23
    v_fma_f32 v183, v183, v18, v23
    v_mul_f32 v23, v183, v183
    ds_read_b128 v[208:211], v9 offset:45056
    s_waitcnt lgkmcnt(3)
    v_mfma_f32_32x32x16_bf16 v[192:207], v[212:215], v[116:119], v[192:207]
    v_fmaak_f32 v23, v21, v23, 0xc0135761
    v_mul_f32 v23, v183, v23
    v_exp_f32 v23, v23
    s_nop 0
    v_add_f32 v23, 1.0, v23
    v_rcp_f32 v23, v23
    s_nop 0
    v_mul_f32 v183, v183, v23
    ds_read_b128 v[212:215], v9 offset:46080
    s_waitcnt lgkmcnt(3)
    v_mfma_f32_32x32x16_bf16 v[192:207], v[216:219], v[120:123], v[192:207]
    v_lshlrev_b32 v22, 16, v36
    v_fma_f32 v22, v232, v17, v22
    v_fma_f32 v184, v184, v18, v22
    v_mul_f32 v22, v184, v184
    v_fmaak_f32 v22, v21, v22, 0xc0135761
    v_mul_f32 v22, v184, v22
    v_exp_f32 v22, v22
    s_nop 0
    ds_read_b128 v[216:219], v9 offset:47104
    s_waitcnt lgkmcnt(3)
    v_mfma_f32_32x32x16_bf16 v[192:207], v[220:223], v[124:127], v[192:207]
    v_add_f32 v22, 1.0, v22
    v_rcp_f32 v22, v22
    s_nop 0
    v_mul_f32 v184, v184, v22
    v_and_b32 v23, 0xffff0000, v36
    v_fma_f32 v23, v233, v17, v23
    v_fma_f32 v185, v185, v18, v23
    v_mul_f32 v23, v185, v185
    ds_read_b128 v[220:223], v9 offset:48128
    s_waitcnt lgkmcnt(3)
    v_mfma_f32_32x32x16_bf16 v[192:207], v[208:211], v[128:131], v[192:207]
    v_fmaak_f32 v23, v21, v23, 0xc0135761
    v_mul_f32 v23, v185, v23
    v_exp_f32 v23, v23
    s_nop 0
    v_add_f32 v23, 1.0, v23
    v_rcp_f32 v23, v23
    s_nop 0
    v_mul_f32 v185, v185, v23
    ds_read_b128 v[208:211], v9 offset:49152
    s_waitcnt lgkmcnt(3)
    v_mfma_f32_32x32x16_bf16 v[192:207], v[212:215], v[132:135], v[192:207]
    v_lshlrev_b32 v22, 16, v37
    v_fma_f32 v22, v234, v17, v22
    v_fma_f32 v186, v186, v18, v22
    v_mul_f32 v22, v186, v186
    v_fmaak_f32 v22, v21, v22, 0xc0135761
    v_mul_f32 v22, v186, v22
    v_exp_f32 v22, v22
    s_nop 0
    ds_read_b128 v[212:215], v9 offset:50176
    s_waitcnt lgkmcnt(3)
    v_mfma_f32_32x32x16_bf16 v[192:207], v[216:219], v[136:139], v[192:207]
    v_add_f32 v22, 1.0, v22
    v_rcp_f32 v22, v22
    s_nop 0
    v_mul_f32 v186, v186, v22
    v_and_b32 v23, 0xffff0000, v37
    v_fma_f32 v23, v235, v17, v23
    v_fma_f32 v187, v187, v18, v23
    v_mul_f32 v23, v187, v187
    ds_read_b128 v[216:219], v9 offset:51200
    s_waitcnt lgkmcnt(3)
    v_mfma_f32_32x32x16_bf16 v[192:207], v[220:223], v[140:143], v[192:207]
    v_fmaak_f32 v23, v21, v23, 0xc0135761
    v_mul_f32 v23, v187, v23
    v_exp_f32 v23, v23
    s_nop 0
    v_add_f32 v23, 1.0, v23
    v_rcp_f32 v23, v23
    s_nop 0
    v_mul_f32 v187, v187, v23
    ds_read_b128 v[220:223], v9 offset:52224
    s_waitcnt lgkmcnt(3)
    v_mfma_f32_32x32x16_bf16 v[192:207], v[208:211], v[144:147], v[192:207]
    v_lshlrev_b32 v22, 16, v38
    v_fma_f32 v22, v236, v17, v22
    v_fma_f32 v188, v188, v18, v22
    v_mul_f32 v22, v188, v188
    v_fmaak_f32 v22, v21, v22, 0xc0135761
    v_mul_f32 v22, v188, v22
    v_exp_f32 v22, v22
    s_nop 0
    ds_read_b128 v[208:211], v9 offset:53248
    s_waitcnt lgkmcnt(3)
    v_mfma_f32_32x32x16_bf16 v[192:207], v[212:215], v[148:151], v[192:207]
    v_add_f32 v22, 1.0, v22
    v_rcp_f32 v22, v22
    s_nop 0
    v_mul_f32 v188, v188, v22
    v_and_b32 v23, 0xffff0000, v38
    v_fma_f32 v23, v237, v17, v23
    v_fma_f32 v189, v189, v18, v23
    v_mul_f32 v23, v189, v189
    ds_read_b128 v[212:215], v9 offset:54272
    s_waitcnt lgkmcnt(3)
    v_mfma_f32_32x32x16_bf16 v[192:207], v[216:219], v[152:155], v[192:207]
    v_fmaak_f32 v23, v21, v23, 0xc0135761
    v_mul_f32 v23, v189, v23
    v_exp_f32 v23, v23
    s_nop 0
    v_add_f32 v23, 1.0, v23
    v_rcp_f32 v23, v23
    s_nop 0
    v_mul_f32 v189, v189, v23
    ds_read_b128 v[216:219], v9 offset:55296
    s_waitcnt lgkmcnt(3)
    v_mfma_f32_32x32x16_bf16 v[192:207], v[220:223], v[156:159], v[192:207]
    v_lshlrev_b32 v22, 16, v39
    v_fma_f32 v22, v238, v17, v22
    v_fma_f32 v190, v190, v18, v22
    v_mul_f32 v22, v190, v190
    v_fmaak_f32 v22, v21, v22, 0xc0135761
    v_mul_f32 v22, v190, v22
    v_exp_f32 v22, v22
    s_nop 0
    ds_read_b128 v[220:223], v9 offset:56320
    s_waitcnt lgkmcnt(3)
    v_mfma_f32_32x32x16_bf16 v[192:207], v[208:211], v[160:163], v[192:207]
    v_add_f32 v22, 1.0, v22
    v_rcp_f32 v22, v22
    s_nop 0
    v_mul_f32 v190, v190, v22
    v_and_b32 v23, 0xffff0000, v39
    v_fma_f32 v23, v239, v17, v23
    v_fma_f32 v191, v191, v18, v23
    v_mul_f32 v23, v191, v191
    ds_read_b128 v[208:211], v10 offset:0
    s_waitcnt lgkmcnt(3)
    v_mfma_f32_32x32x16_bf16 v[192:207], v[212:215], v[164:167], v[192:207]
    v_fmaak_f32 v23, v21, v23, 0xc0135761
    v_mul_f32 v23, v191, v23
    v_exp_f32 v23, v23
    s_nop 0
    v_add_f32 v23, 1.0, v23
    v_rcp_f32 v23, v23
    s_nop 0
    v_mul_f32 v191, v191, v23
    ds_read_b128 v[212:215], v10 offset:1024
    s_waitcnt lgkmcnt(3)
    v_mfma_f32_32x32x16_bf16 v[192:207], v[216:219], v[168:171], v[192:207]
    v_cvt_pk_bf16_f32 v176, v176, v177
    v_cvt_pk_bf16_f32 v177, v178, v179
    v_cvt_pk_bf16_f32 v178, v180, v181
    v_cvt_pk_bf16_f32 v179, v182, v183
    v_cvt_pk_bf16_f32 v180, v184, v185
    v_cvt_pk_bf16_f32 v181, v186, v187
    v_cvt_pk_bf16_f32 v182, v188, v189
    v_cvt_pk_bf16_f32 v183, v190, v191
    s_nop 0
    v_permlane32_swap_b32 v176, v178
    v_permlane32_swap_b32 v177, v179
    v_permlane32_swap_b32 v180, v182
    v_permlane32_swap_b32 v181, v183
    buffer_store_dwordx4 v[176:179], v9, s[52:55], s15 offen offset:0 sc1
    buffer_store_dwordx4 v[180:183], v9, s[52:55], s15 offen offset:1024 sc1
    ds_read_b128 v[216:219], v10 offset:2048
    s_waitcnt lgkmcnt(3)
    v_mfma_f32_32x32x16_bf16 v[192:207], v[220:223], v[172:175], v[192:207]
    s_waitcnt vmcnt(2)
    buffer_load_dwordx4 v[224:227], v7, s[56:59], s14 offen offset:256
    buffer_load_dwordx4 v[228:231], v7, s[56:59], s14 offen offset:288
    buffer_load_dwordx4 v[232:235], v7, s[56:59], s14 offen offset:320
    buffer_load_dwordx4 v[236:239], v7, s[56:59], s14 offen offset:352
    ds_read_b128 v[220:223], v10 offset:3072
    s_waitcnt lgkmcnt(3)
    v_mfma_f32_32x32x16_bf16 v[176:191], v[208:211], v[64:67], 0
    ds_read_b128 v[208:211], v10 offset:4096
    s_waitcnt lgkmcnt(3)
    v_mfma_f32_32x32x16_bf16 v[176:191], v[212:215], v[68:71], v[176:191]
    ds_read_b128 v[212:215], v10 offset:5120
    s_waitcnt lgkmcnt(3)
    v_mfma_f32_32x32x16_bf16 v[176:191], v[216:219], v[72:75], v[176:191]
    v_lshlrev_b32 v22, 16, v40
    v_fma_f32 v22, v240, v17, v22
    v_fma_f32 v192, v192, v18, v22
    v_mul_f32 v22, v192, v192
    v_fmaak_f32 v22, v21, v22, 0xc0135761
    v_mul_f32 v22, v192, v22
    v_exp_f32 v22, v22
    s_nop 0
    ds_read_b128 v[216:219], v10 offset:6144
    s_waitcnt lgkmcnt(3)
    v_mfma_f32_32x32x16_bf16 v[176:191], v[220:223], v[76:79], v[176:191]
    v_add_f32 v22, 1.0, v22
    v_rcp_f32 v22, v22
    s_nop 0
    v_mul_f32 v192, v192, v22
    v_and_b32 v23, 0xffff0000, v40
    v_fma_f32 v23, v241, v17, v23
    v_fma_f32 v193, v193, v18, v23
    v_mul_f32 v23, v193, v193
    ds_read_b128 v[220:223], v10 offset:7168
    s_waitcnt lgkmcnt(3)
    v_mfma_f32_32x32x16_bf16 v[176:191], v[208:211], v[80:83], v[176:191]
    v_fmaak_f32 v23, v21, v23, 0xc0135761
    v_mul_f32 v23, v193, v23
    v_exp_f32 v23, v23
    s_nop 0
    v_add_f32 v23, 1.0, v23
    v_rcp_f32 v23, v23
    s_nop 0
    v_mul_f32 v193, v193, v23
    ds_read_b128 v[208:211], v10 offset:8192
    s_waitcnt lgkmcnt(3)
    v_mfma_f32_32x32x16_bf16 v[176:191], v[212:215], v[84:87], v[176:191]
    v_lshlrev_b32 v22, 16, v41
    v_fma_f32 v22, v242, v17, v22
    v_fma_f32 v194, v194, v18, v22
    v_mul_f32 v22, v194, v194
    v_fmaak_f32 v22, v21, v22, 0xc0135761
    v_mul_f32 v22, v194, v22
    v_exp_f32 v22, v22
    s_nop 0
    ds_read_b128 v[212:215], v10 offset:9216
    s_waitcnt lgkmcnt(3)
    v_mfma_f32_32x32x16_bf16 v[176:191], v[216:219], v[88:91], v[176:191]
    v_add_f32 v22, 1.0, v22
    v_rcp_f32 v22, v22
    s_nop 0
    v_mul_f32 v194, v194, v22
    v_and_b32 v23, 0xffff0000, v41
    v_fma_f32 v23, v243, v17, v23
    v_fma_f32 v195, v195, v18, v23
    v_mul_f32 v23, v195, v195
    ds_read_b128 v[216:219], v10 offset:10240
    s_waitcnt lgkmcnt(3)
    v_mfma_f32_32x32x16_bf16 v[176:191], v[220:223], v[92:95], v[176:191]
    v_fmaak_f32 v23, v21, v23, 0xc0135761
    v_mul_f32 v23, v195, v23
    v_exp_f32 v23, v23
    s_nop 0
    v_add_f32 v23, 1.0, v23
    v_rcp_f32 v23, v23
    s_nop 0
    v_mul_f32 v195, v195, v23
    ds_read_b128 v[220:223], v10 offset:11264
    s_waitcnt lgkmcnt(3)
    v_mfma_f32_32x32x16_bf16 v[176:191], v[208:211], v[96:99], v[176:191]
    v_lshlrev_b32 v22, 16, v42
    v_fma_f32 v22, v244, v17, v22
    v_fma_f32 v196, v196, v18, v22
    v_mul_f32 v22, v196, v196
    v_fmaak_f32 v22, v21, v22, 0xc0135761
    v_mul_f32 v22, v196, v22
    v_exp_f32 v22, v22
    s_nop 0
    ds_read_b128 v[208:211], v10 offset:12288
    s_waitcnt lgkmcnt(3)
    v_mfma_f32_32x32x16_bf16 v[176:191], v[212:215], v[100:103], v[176:191]
    v_add_f32 v22, 1.0, v22
    v_rcp_f32 v22, v22
    s_nop 0
    v_mul_f32 v196, v196, v22
    v_and_b32 v23, 0xffff0000, v42
    v_fma_f32 v23, v245, v17, v23
    v_fma_f32 v197, v197, v18, v23
    v_mul_f32 v23, v197, v197
    ds_read_b128 v[212:215], v10 offset:13312
    s_waitcnt lgkmcnt(3)
    v_mfma_f32_32x32x16_bf16 v[176:191], v[216:219], v[104:107], v[176:191]
    v_fmaak_f32 v23, v21, v23, 0xc0135761
    v_mul_f32 v23, v197, v23
    v_exp_f32 v23, v23
    s_nop 0
    v_add_f32 v23, 1.0, v23
    v_rcp_f32 v23, v23
    s_nop 0
    v_mul_f32 v197, v197, v23
    ds_read_b128 v[216:219], v10 offset:14336
    s_waitcnt lgkmcnt(3)
    v_mfma_f32_32x32x16_bf16 v[176:191], v[220:223], v[108:111], v[176:191]
    v_lshlrev_b32 v22, 16, v43
    v_fma_f32 v22, v246, v17, v22
    v_fma_f32 v198, v198, v18, v22
    v_mul_f32 v22, v198, v198
    v_fmaak_f32 v22, v21, v22, 0xc0135761
    v_mul_f32 v22, v198, v22
    v_exp_f32 v22, v22
    s_nop 0
    ds_read_b128 v[220:223], v10 offset:15360
    s_waitcnt lgkmcnt(3)
    v_mfma_f32_32x32x16_bf16 v[176:191], v[208:211], v[112:115], v[176:191]
    v_add_f32 v22, 1.0, v22
    v_rcp_f32 v22, v22
    s_nop 0
    v_mul_f32 v198, v198, v22
    v_and_b32 v23, 0xffff0000, v43
    v_fma_f32 v23, v247, v17, v23
    v_fma_f32 v199, v199, v18, v23
    v_mul_f32 v23, v199, v199
    ds_read_b128 v[208:211], v10 offset:16384
    s_waitcnt lgkmcnt(3)
    v_mfma_f32_32x32x16_bf16 v[176:191], v[212:215], v[116:119], v[176:191]
    v_fmaak_f32 v23, v21, v23, 0xc0135761
    v_mul_f32 v23, v199, v23
    v_exp_f32 v23, v23
    s_nop 0
    v_add_f32 v23, 1.0, v23
    v_rcp_f32 v23, v23
    s_nop 0
    v_mul_f32 v199, v199, v23
    ds_read_b128 v[212:215], v10 offset:17408
    s_waitcnt lgkmcnt(3)
    v_mfma_f32_32x32x16_bf16 v[176:191], v[216:219], v[120:123], v[176:191]
    v_lshlrev_b32 v22, 16, v44
    v_fma_f32 v22, v248, v17, v22
    v_fma_f32 v200, v200, v18, v22
    v_mul_f32 v22, v200, v200
    v_fmaak_f32 v22, v21, v22, 0xc0135761
    v_mul_f32 v22, v200, v22
    v_exp_f32 v22, v22
    s_nop 0
    ds_read_b128 v[216:219], v10 offset:18432
    s_waitcnt lgkmcnt(3)
    v_mfma_f32_32x32x16_bf16 v[176:191], v[220:223], v[124:127], v[176:191]
    v_add_f32 v22, 1.0, v22
    v_rcp_f32 v22, v22
    s_nop 0
    v_mul_f32 v200, v200, v22
    v_and_b32 v23, 0xffff0000, v44
    v_fma_f32 v23, v249, v17, v23
    v_fma_f32 v201, v201, v18, v23
    v_mul_f32 v23, v201, v201
    ds_read_b128 v[220:223], v10 offset:19456
    s_waitcnt lgkmcnt(3)
    v_mfma_f32_32x32x16_bf16 v[176:191], v[208:211], v[128:131], v[176:191]
    v_fmaak_f32 v23, v21, v23, 0xc0135761
    v_mul_f32 v23, v201, v23
    v_exp_f32 v23, v23
    s_nop 0
    v_add_f32 v23, 1.0, v23
    v_rcp_f32 v23, v23
    s_nop 0
    v_mul_f32 v201, v201, v23
    ds_read_b128 v[208:211], v10 offset:20480
    s_waitcnt lgkmcnt(3)
    v_mfma_f32_32x32x16_bf16 v[176:191], v[212:215], v[132:135], v[176:191]
    v_lshlrev_b32 v22, 16, v45
    v_fma_f32 v22, v250, v17, v22
    v_fma_f32 v202, v202, v18, v22
    v_mul_f32 v22, v202, v202
    v_fmaak_f32 v22, v21, v22, 0xc0135761
    v_mul_f32 v22, v202, v22
    v_exp_f32 v22, v22
    s_nop 0
    ds_read_b128 v[212:215], v10 offset:21504
    s_waitcnt lgkmcnt(3)
    v_mfma_f32_32x32x16_bf16 v[176:191], v[216:219], v[136:139], v[176:191]
    v_add_f32 v22, 1.0, v22
    v_rcp_f32 v22, v22
    s_nop 0
    v_mul_f32 v202, v202, v22
    v_and_b32 v23, 0xffff0000, v45
    v_fma_f32 v23, v251, v17, v23
    v_fma_f32 v203, v203, v18, v23
    v_mul_f32 v23, v203, v203
    ds_read_b128 v[216:219], v10 offset:22528
    s_waitcnt lgkmcnt(3)
    v_mfma_f32_32x32x16_bf16 v[176:191], v[220:223], v[140:143], v[176:191]
    v_fmaak_f32 v23, v21, v23, 0xc0135761
    v_mul_f32 v23, v203, v23
    v_exp_f32 v23, v23
    s_nop 0
    v_add_f32 v23, 1.0, v23
    v_rcp_f32 v23, v23
    s_nop 0
    v_mul_f32 v203, v203, v23
    ds_read_b128 v[220:223], v10 offset:23552
    s_waitcnt lgkmcnt(3)
    v_mfma_f32_32x32x16_bf16 v[176:191], v[208:211], v[144:147], v[176:191]
    v_lshlrev_b32 v22, 16, v46
    v_fma_f32 v22, v252, v17, v22
    v_fma_f32 v204, v204, v18, v22
    v_mul_f32 v22, v204, v204
    v_fmaak_f32 v22, v21, v22, 0xc0135761
    v_mul_f32 v22, v204, v22
    v_exp_f32 v22, v22
    s_nop 0
    ds_read_b128 v[208:211], v10 offset:24576
    s_waitcnt lgkmcnt(3)
    v_mfma_f32_32x32x16_bf16 v[176:191], v[212:215], v[148:151], v[176:191]
    v_add_f32 v22, 1.0, v22
    v_rcp_f32 v22, v22
    s_nop 0
    v_mul_f32 v204, v204, v22
    v_and_b32 v23, 0xffff0000, v46
    v_fma_f32 v23, v253, v17, v23
    v_fma_f32 v205, v205, v18, v23
    v_mul_f32 v23, v205, v205
    ds_read_b128 v[212:215], v10 offset:25600
    s_waitcnt lgkmcnt(3)
    v_mfma_f32_32x32x16_bf16 v[176:191], v[216:219], v[152:155], v[176:191]
    v_fmaak_f32 v23, v21, v23, 0xc0135761
    v_mul_f32 v23, v205, v23
    v_exp_f32 v23, v23
    s_nop 0
    v_add_f32 v23, 1.0, v23
    v_rcp_f32 v23, v23
    s_nop 0
    v_mul_f32 v205, v205, v23
    ds_read_b128 v[216:219], v10 offset:26624
    s_waitcnt lgkmcnt(3)
    v_mfma_f32_32x32x16_bf16 v[176:191], v[220:223], v[156:159], v[176:191]
    v_lshlrev_b32 v22, 16, v47
    v_fma_f32 v22, v254, v17, v22
    v_fma_f32 v206, v206, v18, v22
    v_mul_f32 v22, v206, v206
    v_fmaak_f32 v22, v21, v22, 0xc0135761
    v_mul_f32 v22, v206, v22
    v_exp_f32 v22, v22
    s_nop 0
    ds_read_b128 v[220:223], v10 offset:27648
    s_waitcnt lgkmcnt(3)
    v_mfma_f32_32x32x16_bf16 v[176:191], v[208:211], v[160:163], v[176:191]
    v_add_f32 v22, 1.0, v22
    v_rcp_f32 v22, v22
    s_nop 0
    v_mul_f32 v206, v206, v22
    v_and_b32 v23, 0xffff0000, v47
    v_fma_f32 v23, v255, v17, v23
    v_fma_f32 v207, v207, v18, v23
    v_mul_f32 v23, v207, v207
    ds_read_b128 v[208:211], v10 offset:28672
    s_waitcnt lgkmcnt(3)
    v_mfma_f32_32x32x16_bf16 v[176:191], v[212:215], v[164:167], v[176:191]
    v_fmaak_f32 v23, v21, v23, 0xc0135761
    v_mul_f32 v23, v207, v23
    v_exp_f32 v23, v23
    s_nop 0
    v_add_f32 v23, 1.0, v23
    v_rcp_f32 v23, v23
    s_nop 0
    v_mul_f32 v207, v207, v23
    ds_read_b128 v[212:215], v10 offset:29696
    s_waitcnt lgkmcnt(3)
    v_mfma_f32_32x32x16_bf16 v[176:191], v[216:219], v[168:171], v[176:191]
    v_cvt_pk_bf16_f32 v192, v192, v193
    v_cvt_pk_bf16_f32 v193, v194, v195
    v_cvt_pk_bf16_f32 v194, v196, v197
    v_cvt_pk_bf16_f32 v195, v198, v199
    v_cvt_pk_bf16_f32 v196, v200, v201
    v_cvt_pk_bf16_f32 v197, v202, v203
    v_cvt_pk_bf16_f32 v198, v204, v205
    v_cvt_pk_bf16_f32 v199, v206, v207
    s_nop 0
    v_permlane32_swap_b32 v192, v194
    v_permlane32_swap_b32 v193, v195
    v_permlane32_swap_b32 v196, v198
    v_permlane32_swap_b32 v197, v199
    buffer_store_dwordx4 v[192:195], v9, s[52:55], s15 offen offset:2048 sc1
    buffer_store_dwordx4 v[196:199], v9, s[52:55], s15 offen offset:3072 sc1
    ds_read_b128 v[216:219], v10 offset:30720
    s_waitcnt lgkmcnt(3)
    v_mfma_f32_32x32x16_bf16 v[176:191], v[220:223], v[172:175], v[176:191]
    s_waitcnt vmcnt(2)
    buffer_load_dwordx4 v[240:243], v7, s[56:59], s14 offen offset:384
    buffer_load_dwordx4 v[244:247], v7, s[56:59], s14 offen offset:416
    buffer_load_dwordx4 v[248:251], v7, s[56:59], s14 offen offset:448
    buffer_load_dwordx4 v[252:255], v7, s[56:59], s14 offen offset:480
    ds_read_b128 v[220:223], v10 offset:31744
    s_waitcnt lgkmcnt(3)
    v_mfma_f32_32x32x16_bf16 v[192:207], v[208:211], v[64:67], 0
    ds_read_b128 v[208:211], v10 offset:32768
    s_waitcnt lgkmcnt(3)
    v_mfma_f32_32x32x16_bf16 v[192:207], v[212:215], v[68:71], v[192:207]
    ds_read_b128 v[212:215], v10 offset:33792
    s_waitcnt lgkmcnt(3)
    v_mfma_f32_32x32x16_bf16 v[192:207], v[216:219], v[72:75], v[192:207]
    v_lshlrev_b32 v22, 16, v48
    v_fma_f32 v22, v224, v17, v22
    v_fma_f32 v176, v176, v18, v22
    v_mul_f32 v22, v176, v176
    v_fmaak_f32 v22, v21, v22, 0xc0135761
    v_mul_f32 v22, v176, v22
    v_exp_f32 v22, v22
    s_nop 0
    ds_read_b128 v[216:219], v10 offset:34816
    s_waitcnt lgkmcnt(3)
    v_mfma_f32_32x32x16_bf16 v[192:207], v[220:223], v[76:79], v[192:207]
    v_add_f32 v22, 1.0, v22
    v_rcp_f32 v22, v22
    s_nop 0
    v_mul_f32 v176, v176, v22
    v_and_b32 v23, 0xffff0000, v48
    v_fma_f32 v23, v225, v17, v23
    v_fma_f32 v177, v177, v18, v23
    v_mul_f32 v23, v177, v177
    ds_read_b128 v[220:223], v10 offset:35840
    s_waitcnt lgkmcnt(3)
    v_mfma_f32_32x32x16_bf16 v[192:207], v[208:211], v[80:83], v[192:207]
    v_fmaak_f32 v23, v21, v23, 0xc0135761
    v_mul_f32 v23, v177, v23
    v_exp_f32 v23, v23
    s_nop 0
    v_add_f32 v23, 1.0, v23
    v_rcp_f32 v23, v23
    s_nop 0
    v_mul_f32 v177, v177, v23
    ds_read_b128 v[208:211], v10 offset:36864
    s_waitcnt lgkmcnt(3)
    v_mfma_f32_32x32x16_bf16 v[192:207], v[212:215], v[84:87], v[192:207]
    v_lshlrev_b32 v22, 16, v49
    v_fma_f32 v22, v226, v17, v22
    v_fma_f32 v178, v178, v18, v22
    v_mul_f32 v22, v178, v178
    v_fmaak_f32 v22, v21, v22, 0xc0135761
    v_mul_f32 v22, v178, v22
    v_exp_f32 v22, v22
    s_nop 0
    ds_read_b128 v[212:215], v10 offset:37888
    s_waitcnt lgkmcnt(3)
    v_mfma_f32_32x32x16_bf16 v[192:207], v[216:219], v[88:91], v[192:207]
    v_add_f32 v22, 1.0, v22
    v_rcp_f32 v22, v22
    s_nop 0
    v_mul_f32 v178, v178, v22
    v_and_b32 v23, 0xffff0000, v49
    v_fma_f32 v23, v227, v17, v23
    v_fma_f32 v179, v179, v18, v23
    v_mul_f32 v23, v179, v179
    ds_read_b128 v[216:219], v10 offset:38912
    s_waitcnt lgkmcnt(3)
    v_mfma_f32_32x32x16_bf16 v[192:207], v[220:223], v[92:95], v[192:207]
    v_fmaak_f32 v23, v21, v23, 0xc0135761
    v_mul_f32 v23, v179, v23
    v_exp_f32 v23, v23
    s_nop 0
    v_add_f32 v23, 1.0, v23
    v_rcp_f32 v23, v23
    s_nop 0
    v_mul_f32 v179, v179, v23
    ds_read_b128 v[220:223], v10 offset:39936
    s_waitcnt lgkmcnt(3)
    v_mfma_f32_32x32x16_bf16 v[192:207], v[208:211], v[96:99], v[192:207]
    v_lshlrev_b32 v22, 16, v50
    v_fma_f32 v22, v228, v17, v22
    v_fma_f32 v180, v180, v18, v22
    v_mul_f32 v22, v180, v180
    v_fmaak_f32 v22, v21, v22, 0xc0135761
    v_mul_f32 v22, v180, v22
    v_exp_f32 v22, v22
    s_nop 0
    ds_read_b128 v[208:211], v10 offset:40960
    s_waitcnt lgkmcnt(3)
    v_mfma_f32_32x32x16_bf16 v[192:207], v[212:215], v[100:103], v[192:207]
    v_add_f32 v22, 1.0, v22
    v_rcp_f32 v22, v22
    s_nop 0
    v_mul_f32 v180, v180, v22
    v_and_b32 v23, 0xffff0000, v50
    v_fma_f32 v23, v229, v17, v23
    v_fma_f32 v181, v181, v18, v23
    v_mul_f32 v23, v181, v181
    ds_read_b128 v[212:215], v10 offset:41984
    s_waitcnt lgkmcnt(3)
    v_mfma_f32_32x32x16_bf16 v[192:207], v[216:219], v[104:107], v[192:207]
    v_fmaak_f32 v23, v21, v23, 0xc0135761
    v_mul_f32 v23, v181, v23
    v_exp_f32 v23, v23
    s_nop 0
    v_add_f32 v23, 1.0, v23
    v_rcp_f32 v23, v23
    s_nop 0
    v_mul_f32 v181, v181, v23
    ds_read_b128 v[216:219], v10 offset:43008
    s_waitcnt lgkmcnt(3)
    v_mfma_f32_32x32x16_bf16 v[192:207], v[220:223], v[108:111], v[192:207]
    v_lshlrev_b32 v22, 16, v51
    v_fma_f32 v22, v230, v17, v22
    v_fma_f32 v182, v182, v18, v22
    v_mul_f32 v22, v182, v182
    v_fmaak_f32 v22, v21, v22, 0xc0135761
    v_mul_f32 v22, v182, v22
    v_exp_f32 v22, v22
    s_nop 0
    ds_read_b128 v[220:223], v10 offset:44032
    s_waitcnt lgkmcnt(3)
    v_mfma_f32_32x32x16_bf16 v[192:207], v[208:211], v[112:115], v[192:207]
    v_add_f32 v22, 1.0, v22
    v_rcp_f32 v22, v22
    s_nop 0
    v_mul_f32 v182, v182, v22
    v_and_b32 v23, 0xffff0000, v51
    v_fma_f32 v23, v231, v17, v23
    v_fma_f32 v183, v183, v18, v23
    v_mul_f32 v23, v183, v183
    ds_read_b128 v[208:211], v10 offset:45056
    s_waitcnt lgkmcnt(3)
    v_mfma_f32_32x32x16_bf16 v[192:207], v[212:215], v[116:119], v[192:207]
    v_fmaak_f32 v23, v21, v23, 0xc0135761
    v_mul_f32 v23, v183, v23
    v_exp_f32 v23, v23
    s_nop 0
    v_add_f32 v23, 1.0, v23
    v_rcp_f32 v23, v23
    s_nop 0
    v_mul_f32 v183, v183, v23
    ds_read_b128 v[212:215], v10 offset:46080
    s_waitcnt lgkmcnt(3)
    v_mfma_f32_32x32x16_bf16 v[192:207], v[216:219], v[120:123], v[192:207]
    v_lshlrev_b32 v22, 16, v52
    v_fma_f32 v22, v232, v17, v22
    v_fma_f32 v184, v184, v18, v22
    v_mul_f32 v22, v184, v184
    v_fmaak_f32 v22, v21, v22, 0xc0135761
    v_mul_f32 v22, v184, v22
    v_exp_f32 v22, v22
    s_nop 0
    ds_read_b128 v[216:219], v10 offset:47104
    s_waitcnt lgkmcnt(3)
    v_mfma_f32_32x32x16_bf16 v[192:207], v[220:223], v[124:127], v[192:207]
    v_add_f32 v22, 1.0, v22
    v_rcp_f32 v22, v22
    s_nop 0
    v_mul_f32 v184, v184, v22
    v_and_b32 v23, 0xffff0000, v52
    v_fma_f32 v23, v233, v17, v23
    v_fma_f32 v185, v185, v18, v23
    v_mul_f32 v23, v185, v185
    ds_read_b128 v[220:223], v10 offset:48128
    s_waitcnt lgkmcnt(3)
    v_mfma_f32_32x32x16_bf16 v[192:207], v[208:211], v[128:131], v[192:207]
    v_fmaak_f32 v23, v21, v23, 0xc0135761
    v_mul_f32 v23, v185, v23
    v_exp_f32 v23, v23
    s_nop 0
    v_add_f32 v23, 1.0, v23
    v_rcp_f32 v23, v23
    s_nop 0
    v_mul_f32 v185, v185, v23
    ds_read_b128 v[208:211], v10 offset:49152
    s_waitcnt lgkmcnt(3)
    v_mfma_f32_32x32x16_bf16 v[192:207], v[212:215], v[132:135], v[192:207]
    v_lshlrev_b32 v22, 16, v53
    v_fma_f32 v22, v234, v17, v22
    v_fma_f32 v186, v186, v18, v22
    v_mul_f32 v22, v186, v186
    v_fmaak_f32 v22, v21, v22, 0xc0135761
    v_mul_f32 v22, v186, v22
    v_exp_f32 v22, v22
    s_nop 0
    ds_read_b128 v[212:215], v10 offset:50176
    s_waitcnt lgkmcnt(3)
    v_mfma_f32_32x32x16_bf16 v[192:207], v[216:219], v[136:139], v[192:207]
    v_add_f32 v22, 1.0, v22
    v_rcp_f32 v22, v22
    s_nop 0
    v_mul_f32 v186, v186, v22
    v_and_b32 v23, 0xffff0000, v53
    v_fma_f32 v23, v235, v17, v23
    v_fma_f32 v187, v187, v18, v23
    v_mul_f32 v23, v187, v187
    ds_read_b128 v[216:219], v10 offset:51200
    s_waitcnt lgkmcnt(3)
    v_mfma_f32_32x32x16_bf16 v[192:207], v[220:223], v[140:143], v[192:207]
    v_fmaak_f32 v23, v21, v23, 0xc0135761
    v_mul_f32 v23, v187, v23
    v_exp_f32 v23, v23
    s_nop 0
    v_add_f32 v23, 1.0, v23
    v_rcp_f32 v23, v23
    s_nop 0
    v_mul_f32 v187, v187, v23
    ds_read_b128 v[220:223], v10 offset:52224
    s_waitcnt lgkmcnt(3)
    v_mfma_f32_32x32x16_bf16 v[192:207], v[208:211], v[144:147], v[192:207]
    v_lshlrev_b32 v22, 16, v54
    v_fma_f32 v22, v236, v17, v22
    v_fma_f32 v188, v188, v18, v22
    v_mul_f32 v22, v188, v188
    v_fmaak_f32 v22, v21, v22, 0xc0135761
    v_mul_f32 v22, v188, v22
    v_exp_f32 v22, v22
    s_nop 0
    ds_read_b128 v[208:211], v10 offset:53248
    s_waitcnt lgkmcnt(3)
    v_mfma_f32_32x32x16_bf16 v[192:207], v[212:215], v[148:151], v[192:207]
    v_add_f32 v22, 1.0, v22
    v_rcp_f32 v22, v22
    s_nop 0
    v_mul_f32 v188, v188, v22
    v_and_b32 v23, 0xffff0000, v54
    v_fma_f32 v23, v237, v17, v23
    v_fma_f32 v189, v189, v18, v23
    v_mul_f32 v23, v189, v189
    ds_read_b128 v[212:215], v10 offset:54272
    s_waitcnt lgkmcnt(3)
    v_mfma_f32_32x32x16_bf16 v[192:207], v[216:219], v[152:155], v[192:207]
    v_fmaak_f32 v23, v21, v23, 0xc0135761
    v_mul_f32 v23, v189, v23
    v_exp_f32 v23, v23
    s_nop 0
    v_add_f32 v23, 1.0, v23
    v_rcp_f32 v23, v23
    s_nop 0
    v_mul_f32 v189, v189, v23
    ds_read_b128 v[216:219], v10 offset:55296
    s_waitcnt lgkmcnt(3)
    v_mfma_f32_32x32x16_bf16 v[192:207], v[220:223], v[156:159], v[192:207]
    v_lshlrev_b32 v22, 16, v55
    v_fma_f32 v22, v238, v17, v22
    v_fma_f32 v190, v190, v18, v22
    v_mul_f32 v22, v190, v190
    v_fmaak_f32 v22, v21, v22, 0xc0135761
    v_mul_f32 v22, v190, v22
    v_exp_f32 v22, v22
    s_nop 0
    ds_read_b128 v[220:223], v10 offset:56320
    s_waitcnt lgkmcnt(3)
    v_mfma_f32_32x32x16_bf16 v[192:207], v[208:211], v[160:163], v[192:207]
    v_add_f32 v22, 1.0, v22
    v_rcp_f32 v22, v22
    s_nop 0
    v_mul_f32 v190, v190, v22
    v_and_b32 v23, 0xffff0000, v55
    v_fma_f32 v23, v239, v17, v23
    v_fma_f32 v191, v191, v18, v23
    v_mul_f32 v23, v191, v191
    s_waitcnt lgkmcnt(2)
    v_mfma_f32_32x32x16_bf16 v[192:207], v[212:215], v[164:167], v[192:207]
    v_fmaak_f32 v23, v21, v23, 0xc0135761
    v_mul_f32 v23, v191, v23
    v_exp_f32 v23, v23
    s_nop 0
    v_add_f32 v23, 1.0, v23
    v_rcp_f32 v23, v23
    s_nop 0
    v_mul_f32 v191, v191, v23
    s_waitcnt lgkmcnt(1)
    v_mfma_f32_32x32x16_bf16 v[192:207], v[216:219], v[168:171], v[192:207]
    v_cvt_pk_bf16_f32 v176, v176, v177
    v_cvt_pk_bf16_f32 v177, v178, v179
    v_cvt_pk_bf16_f32 v178, v180, v181
    v_cvt_pk_bf16_f32 v179, v182, v183
    v_cvt_pk_bf16_f32 v180, v184, v185
    v_cvt_pk_bf16_f32 v181, v186, v187
    v_cvt_pk_bf16_f32 v182, v188, v189
    v_cvt_pk_bf16_f32 v183, v190, v191
    s_nop 0
    v_permlane32_swap_b32 v176, v178
    v_permlane32_swap_b32 v177, v179
    v_permlane32_swap_b32 v180, v182
    v_permlane32_swap_b32 v181, v183
    buffer_store_dwordx4 v[176:179], v9, s[52:55], s63 offen offset:0 sc1
    buffer_store_dwordx4 v[180:183], v9, s[52:55], s63 offen offset:1024 sc1
    s_waitcnt lgkmcnt(0)
    v_mfma_f32_32x32x16_bf16 v[192:207], v[220:223], v[172:175], v[192:207]
    s_waitcnt vmcnt(2)
    s_barrier
    s_nop 13
    v_lshlrev_b32 v22, 16, v56
    v_fma_f32 v22, v240, v17, v22
    v_fma_f32 v192, v192, v18, v22
    v_mul_f32 v22, v192, v192
    v_fmaak_f32 v22, v21, v22, 0xc0135761
    v_mul_f32 v22, v192, v22
    v_exp_f32 v22, v22
    s_nop 0
    v_add_f32 v22, 1.0, v22
    v_rcp_f32 v22, v22
    s_nop 0
    v_mul_f32 v192, v192, v22
    v_and_b32 v23, 0xffff0000, v56
    v_fma_f32 v23, v241, v17, v23
    v_fma_f32 v193, v193, v18, v23
    v_mul_f32 v23, v193, v193
    v_fmaak_f32 v23, v21, v23, 0xc0135761
    v_mul_f32 v23, v193, v23
    v_exp_f32 v23, v23
    s_nop 0
    v_add_f32 v23, 1.0, v23
    v_rcp_f32 v23, v23
    s_nop 0
    v_mul_f32 v193, v193, v23
    v_lshlrev_b32 v22, 16, v57
    v_fma_f32 v22, v242, v17, v22
    v_fma_f32 v194, v194, v18, v22
    v_mul_f32 v22, v194, v194
    v_fmaak_f32 v22, v21, v22, 0xc0135761
    v_mul_f32 v22, v194, v22
    v_exp_f32 v22, v22
    s_nop 0
    v_add_f32 v22, 1.0, v22
    v_rcp_f32 v22, v22
    s_nop 0
    v_mul_f32 v194, v194, v22
    v_and_b32 v23, 0xffff0000, v57
    v_fma_f32 v23, v243, v17, v23
    v_fma_f32 v195, v195, v18, v23
    v_mul_f32 v23, v195, v195
    v_fmaak_f32 v23, v21, v23, 0xc0135761
    v_mul_f32 v23, v195, v23
    v_exp_f32 v23, v23
    s_nop 0
    v_add_f32 v23, 1.0, v23
    v_rcp_f32 v23, v23
    s_nop 0
    v_mul_f32 v195, v195, v23
    v_lshlrev_b32 v22, 16, v58
    v_fma_f32 v22, v244, v17, v22
    v_fma_f32 v196, v196, v18, v22
    v_mul_f32 v22, v196, v196
    v_fmaak_f32 v22, v21, v22, 0xc0135761
    v_mul_f32 v22, v196, v22
    v_exp_f32 v22, v22
    s_nop 0
    v_add_f32 v22, 1.0, v22
    v_rcp_f32 v22, v22
    s_nop 0
    v_mul_f32 v196, v196, v22
    v_and_b32 v23, 0xffff0000, v58
    v_fma_f32 v23, v245, v17, v23
    v_fma_f32 v197, v197, v18, v23
    v_mul_f32 v23, v197, v197
    v_fmaak_f32 v23, v21, v23, 0xc0135761
    v_mul_f32 v23, v197, v23
    v_exp_f32 v23, v23
    s_nop 0
    v_add_f32 v23, 1.0, v23
    v_rcp_f32 v23, v23
    s_nop 0
    v_mul_f32 v197, v197, v23
    v_lshlrev_b32 v22, 16, v59
    v_fma_f32 v22, v246, v17, v22
    v_fma_f32 v198, v198, v18, v22
    v_mul_f32 v22, v198, v198
    v_fmaak_f32 v22, v21, v22, 0xc0135761
    v_mul_f32 v22, v198, v22
    v_exp_f32 v22, v22
    s_nop 0
    v_add_f32 v22, 1.0, v22
    v_rcp_f32 v22, v22
    s_nop 0
    v_mul_f32 v198, v198, v22
    v_and_b32 v23, 0xffff0000, v59
    v_fma_f32 v23, v247, v17, v23
    v_fma_f32 v199, v199, v18, v23
    v_mul_f32 v23, v199, v199
    v_fmaak_f32 v23, v21, v23, 0xc0135761
    v_mul_f32 v23, v199, v23
    v_exp_f32 v23, v23
    s_nop 0
    v_add_f32 v23, 1.0, v23
    v_rcp_f32 v23, v23
    s_nop 0
    v_mul_f32 v199, v199, v23
    v_lshlrev_b32 v22, 16, v60
    v_fma_f32 v22, v248, v17, v22
    v_fma_f32 v200, v200, v18, v22
    v_mul_f32 v22, v200, v200
    v_fmaak_f32 v22, v21, v22, 0xc0135761
    v_mul_f32 v22, v200, v22
    v_exp_f32 v22, v22
    s_nop 0
    v_add_f32 v22, 1.0, v22
    v_rcp_f32 v22, v22
    s_nop 0
    v_mul_f32 v200, v200, v22
    v_and_b32 v23, 0xffff0000, v60
    v_fma_f32 v23, v249, v17, v23
    v_fma_f32 v201, v201, v18, v23
    v_mul_f32 v23, v201, v201
    v_fmaak_f32 v23, v21, v23, 0xc0135761
    v_mul_f32 v23, v201, v23
    v_exp_f32 v23, v23
    s_nop 0
    v_add_f32 v23, 1.0, v23
    v_rcp_f32 v23, v23
    s_nop 0
    v_mul_f32 v201, v201, v23
    v_lshlrev_b32 v22, 16, v61
    v_fma_f32 v22, v250, v17, v22
    v_fma_f32 v202, v202, v18, v22
    v_mul_f32 v22, v202, v202
    v_fmaak_f32 v22, v21, v22, 0xc0135761
    v_mul_f32 v22, v202, v22
    v_exp_f32 v22, v22
    s_nop 0
    v_add_f32 v22, 1.0, v22
    v_rcp_f32 v22, v22
    s_nop 0
    v_mul_f32 v202, v202, v22
    v_and_b32 v23, 0xffff0000, v61
    v_fma_f32 v23, v251, v17, v23
    v_fma_f32 v203, v203, v18, v23
    v_mul_f32 v23, v203, v203
    v_fmaak_f32 v23, v21, v23, 0xc0135761
    v_mul_f32 v23, v203, v23
    v_exp_f32 v23, v23
    s_nop 0
    v_add_f32 v23, 1.0, v23
    v_rcp_f32 v23, v23
    s_nop 0
    v_mul_f32 v203, v203, v23
    v_lshlrev_b32 v22, 16, v62
    v_fma_f32 v22, v252, v17, v22
    v_fma_f32 v204, v204, v18, v22
    v_mul_f32 v22, v204, v204
    v_fmaak_f32 v22, v21, v22, 0xc0135761
    v_mul_f32 v22, v204, v22
    v_exp_f32 v22, v22
    s_nop 0
    v_add_f32 v22, 1.0, v22
    v_rcp_f32 v22, v22
    s_nop 0
    v_mul_f32 v204, v204, v22
    v_and_b32 v23, 0xffff0000, v62
    v_fma_f32 v23, v253, v17, v23
    v_fma_f32 v205, v205, v18, v23
    v_mul_f32 v23, v205, v205
    v_fmaak_f32 v23, v21, v23, 0xc0135761
    v_mul_f32 v23, v205, v23
    v_exp_f32 v23, v23
    s_nop 0
    v_add_f32 v23, 1.0, v23
    v_rcp_f32 v23, v23
    s_nop 0
    v_mul_f32 v205, v205, v23
    v_lshlrev_b32 v22, 16, v63
    v_fma_f32 v22, v254, v17, v22
    v_fma_f32 v206, v206, v18, v22
    v_mul_f32 v22, v206, v206
    v_fmaak_f32 v22, v21, v22, 0xc0135761
    v_mul_f32 v22, v206, v22
    v_exp_f32 v22, v22
    s_nop 0
    v_add_f32 v22, 1.0, v22
    v_rcp_f32 v22, v22
    s_nop 0
    v_mul_f32 v206, v206, v22
    v_and_b32 v23, 0xffff0000, v63
    v_fma_f32 v23, v255, v17, v23
    v_fma_f32 v207, v207, v18, v23
    v_mul_f32 v23, v207, v207
    v_fmaak_f32 v23, v21, v23, 0xc0135761
    v_mul_f32 v23, v207, v23
    v_exp_f32 v23, v23
    s_nop 0
    v_add_f32 v23, 1.0, v23
    v_rcp_f32 v23, v23
    s_nop 0
    v_mul_f32 v207, v207, v23
    v_cvt_pk_bf16_f32 v192, v192, v193
    v_cvt_pk_bf16_f32 v193, v194, v195
    v_cvt_pk_bf16_f32 v194, v196, v197
    v_cvt_pk_bf16_f32 v195, v198, v199
    v_cvt_pk_bf16_f32 v196, v200, v201
    v_cvt_pk_bf16_f32 v197, v202, v203
    v_cvt_pk_bf16_f32 v198, v204, v205
    v_cvt_pk_bf16_f32 v199, v206, v207
    s_nop 0
    v_permlane32_swap_b32 v192, v194
    v_permlane32_swap_b32 v193, v195
    v_permlane32_swap_b32 v196, v198
    v_permlane32_swap_b32 v197, v199
    buffer_store_dwordx4 v[192:195], v9, s[52:55], s63 offen offset:2048 sc1
    buffer_store_dwordx4 v[196:199], v9, s[52:55], s63 offen offset:3072 sc1
    s_lshl_b32 s62, s4, 7
    s_lshl_b32 s63, s5, 2
    s_add_u32 s62, s62, s63
    s_add_u32 s62, s62, 12288
    s_waitcnt vmcnt(0) lgkmcnt(0)
    s_barrier
    s_cmp_eq_u32 s3, 0
    s_cbranch_scc0 L_sig_19
    v_mov_b32 v5, s98
    v_mov_b32 v6, 0
    s_mov_b64 exec, 1
    buffer_store_dword v5, v6, s[72:75], s62 offen sc1
    s_mov_b64 exec, -1
L_sig_19:
    s_lshr_b32 s13, s2, 3
    s_mul_hi_u32 s14, s13, 0x24924925
    s_mul_i32 s14, s14, 7
    s_sub_u32 s13, s13, s14
    s_add_u32 s44, s38, 0x2700000
    s_addc_u32 s45, s39, 0
    s_and_b32 s45, s45, 0xffff
    s_mov_b32 s46, 0x188000
    s_mov_b32 s47, 0x20000
    s_and_b32 s8, s3, 1
    s_lshr_b32 s9, s3, 1
    s_lshl_b32 s9, s9, 11
    s_lshl_b32 s10, s13, 1
    s_add_u32 s10, s10, s8
    s_mul_i32 s10, s10, 114688
    s_add_u32 s10, s10, s9
    s_lshl_b32 s12, s8, 12
    s_add_u32 s12, s12, s9
    s_add_u32 s14, s10, 0
    s_add_u32 m0, s12, 81920
    s_nop 0
    buffer_load_dwordx4 v9, s[44:47], s14 offen lds
    s_add_u32 s14, s10, 1024
    s_add_u32 m0, s12, 82944
    s_nop 0
    buffer_load_dwordx4 v9, s[44:47], s14 offen lds
    s_add_u32 s14, s10, 4096
    s_add_u32 m0, s12, 90112
    s_nop 0
    buffer_load_dwordx4 v9, s[44:47], s14 offen lds
    s_add_u32 s14, s10, 5120
    s_add_u32 m0, s12, 91136
    s_nop 0
    buffer_load_dwordx4 v9, s[44:47], s14 offen lds
    s_add_u32 s14, s10, 8192
    s_add_u32 m0, s12, 98304
    s_nop 0
    buffer_load_dwordx4 v9, s[44:47], s14 offen lds
    s_add_u32 s14, s10, 9216
    s_add_u32 m0, s12, 99328
    s_nop 0
    buffer_load_dwordx4 v9, s[44:47], s14 offen lds
    s_add_u32 s14, s10, 12288
    s_add_u32 m0, s12, 106496
    s_nop 0
    buffer_load_dwordx4 v9, s[44:47], s14 offen lds
    s_add_u32 s14, s10, 13312
    s_add_u32 m0, s12, 107520
    s_nop 0
    buffer_load_dwordx4 v9, s[44:47], s14 offen lds
    s_add_u32 s14, s10, 16384
    s_add_u32 m0, s12, 114688
    s_nop 0
    buffer_load_dwordx4 v9, s[44:47], s14 offen lds
    s_add_u32 s14, s10, 17408
    s_add_u32 m0, s12, 115712
    s_nop 0
    buffer_load_dwordx4 v9, s[44:47], s14 offen lds
    s_add_u32 s14, s10, 20480
    s_add_u32 m0, s12, 122880
    s_nop 0
    buffer_load_dwordx4 v9, s[44:47], s14 offen lds
    s_add_u32 s14, s10, 21504
    s_add_u32 m0, s12, 123904
    s_nop 0
    buffer_load_dwordx4 v9, s[44:47], s14 offen lds
    s_add_u32 s14, s10, 24576
    s_add_u32 m0, s12, 131072
    s_nop 0
    buffer_load_dwordx4 v9, s[44:47], s14 offen lds
    s_add_u32 s14, s10, 25600
    s_add_u32 m0, s12, 132096
    s_nop 0
    buffer_load_dwordx4 v9, s[44:47], s14 offen lds
    s_add_u32 s14, s10, 28672
    s_add_u32 m0, s12, 139264
    s_nop 0
    buffer_load_dwordx4 v9, s[44:47], s14 offen lds
    s_add_u32 s14, s10, 29696
    s_add_u32 m0, s12, 140288
    s_nop 0
    buffer_load_dwordx4 v9, s[44:47], s14 offen lds
    s_add_u32 s14, s10, 32768
    s_add_u32 m0, s12, 147456
    s_nop 0
    buffer_load_dwordx4 v9, s[44:47], s14 offen lds
    s_add_u32 s14, s10, 33792
    s_add_u32 m0, s12, 148480
    s_nop 0
    buffer_load_dwordx4 v9, s[44:47], s14 offen lds
k3l0_end:
    s_cmp_ge_u32 s2, 224
    s_cbranch_scc1 k4l0_end
    s_and_b32 s4, s2, 7
    s_lshr_b32 s5, s2, 3
    s_mul_hi_u32 s6, s5, 0x24924925
    s_mul_i32 s7, s6, 7
    s_sub_u32 s5, s5, s7
    s_lshl_b32 s4, s4, 2
    s_add_u32 s4, s4, s6
    s_add_u32 s40, s38, 0x1200000
    s_addc_u32 s41, s39, 0
    s_and_b32 s41, s41, 0xffff
    s_mov_b32 s42, 0x700000
    s_mov_b32 s43, 0x20000
    s_add_u32 s44, s38, 0x2700000
    s_addc_u32 s45, s39, 0
    s_and_b32 s45, s45, 0xffff
    s_mov_b32 s46, 0x188000
    s_mov_b32 s47, 0x20000
    s_add_u32 s48, s38, 0x200000
    s_addc_u32 s49, s39, 0
    s_and_b32 s49, s49, 0xffff
    s_mov_b32 s50, 0x1c0000
    s_mov_b32 s51, 0x20000
    s_add_u32 s52, s38, 0x600000
    s_addc_u32 s53, s39, 0
    s_and_b32 s53, s53, 0xffff
    s_mov_b32 s54, 0x1c0000
    s_mov_b32 s55, 0x20000
    s_mov_b32 s56, s32
    s_mov_b32 s57, s33
    s_and_b32 s57, s57, 0xffff
    s_mov_b32 s58, 0x380
    s_mov_b32 s59, 0x20000
    v_lshlrev_b32 v9, 4, v1
    s_and_b32 s6, s3, 1
    s_lshr_b32 s7, s3, 1
    s_lshl_b32 s8, s4, 1
    s_add_u32 s8, s8, s6
    s_mul_i32 s8, s8, 114688
    s_lshl_b32 s9, s7, 11
    s_add_u32 s8, s8, s9
    s_lshl_b32 s10, s5, 1
    s_add_u32 s10, s10, s6
    s_mul_i32 s10, s10, 114688
    s_add_u32 s10, s10, s9
    s_lshl_b32 s12, s6, 12
    s_add_u32 s12, s12, s9
    s_lshl_b32 s13, s4, 1
    s_add_u32 s13, s13, s6
    s_lshl_b32 s15, s5, 1
    s_add_u32 s15, s15, s7
    s_mul_i32 s60, s13, 28672
    s_lshl_b32 s61, s15, 11
    s_add_u32 s60, s60, s61
    v_lshlrev_b32 v12, 3, v4
    s_lshl_b32 s61, s15, 6
    buffer_load_dwordx2 v[40:41], v12, s[56:59], s61 offen offset:0
    buffer_load_dwordx2 v[42:43], v12, s[56:59], s61 offen offset:16
    buffer_load_dwordx2 v[44:45], v12, s[56:59], s61 offen offset:32
    buffer_load_dwordx2 v[46:47], v12, s[56:59], s61 offen offset:48
    s_lshl_b32 s62, s3, 10
    v_add_u32 v13, s62, v9
    s_add_u32 s62, s62, 81920
    v_add_u32 v14, s62, v9
    v_add_u32 v16, 40960, v14
    v_add_u32 v15, 40960, v13
    s_lshr_b32 s62, s4, 1
    s_lshl_b32 s62, s62, 7
    s_add_u32 s62, s62, 12288
    s_cmp_eq_u32 s3, 3
    s_cbranch_scc0 L_pdone_21
    s_mov_b64 exec, 0x3fff
    v_lshlrev_b32 v6, 2, v1
L_poll_20:
    buffer_load_dword v5, v6, s[72:75], s62 offen sc1
    s_waitcnt vmcnt(0)
    v_cmp_ne_u32 vcc, s98, v5
    s_cbranch_vccz L_pdone_21_x
    s_sleep 2
    s_branch L_poll_20
L_pdone_21_x:
    s_mov_b64 exec, -1
L_pdone_21:
    s_barrier
    buffer_load_dwordx4 v[32:35], v9, s[48:51], s60 offen
    buffer_load_dwordx4 v[36:39], v9, s[48:51], s60 offen offset:1024
    s_add_u32 s14, s8, 0
    s_add_u32 m0, s12, 0
    s_nop 0
    buffer_load_dwordx4 v9, s[40:43], s14 offen lds
    s_add_u32 s14, s8, 1024
    s_add_u32 m0, s12, 1024
    s_nop 0
    buffer_load_dwordx4 v9, s[40:43], s14 offen lds
    s_add_u32 s14, s8, 4096
    s_add_u32 m0, s12, 8192
    s_nop 0
    buffer_load_dwordx4 v9, s[40:43], s14 offen lds
    s_add_u32 s14, s8, 5120
    s_add_u32 m0, s12, 9216
    s_nop 0
    buffer_load_dwordx4 v9, s[40:43], s14 offen lds
    s_add_u32 s14, s8, 8192
    s_add_u32 m0, s12, 16384
    s_nop 0
    buffer_load_dwordx4 v9, s[40:43], s14 offen lds
    s_add_u32 s14, s8, 9216
    s_add_u32 m0, s12, 17408
    s_nop 0
    buffer_load_dwordx4 v9, s[40:43], s14 offen lds
    s_add_u32 s14, s8, 12288
    s_add_u32 m0, s12, 24576
    s_nop 0
    buffer_load_dwordx4 v9, s[40:43], s14 offen lds
    s_add_u32 s14, s8, 13312
    s_add_u32 m0, s12, 25600
    s_nop 0
    buffer_load_dwordx4 v9, s[40:43], s14 offen lds
    s_add_u32 s14, s8, 16384
    s_add_u32 m0, s12, 32768
    s_nop 0
    buffer_load_dwordx4 v9, s[40:43], s14 offen lds
    s_add_u32 s14, s8, 17408
    s_add_u32 m0, s12, 33792
    s_nop 0
    buffer_load_dwordx4 v9, s[40:43], s14 offen lds
    s_add_u32 s14, s8, 20480
    s_add_u32 m0, s12, 40960
    s_nop 0
    buffer_load_dwordx4 v9, s[40:43], s14 offen lds
    s_add_u32 s14, s8, 21504
    s_add_u32 m0, s12, 41984
    s_nop 0
    buffer_load_dwordx4 v9, s[40:43], s14 offen lds
    s_add_u32 s14, s8, 24576
    s_add_u32 m0, s12, 49152
    s_nop 0
    buffer_load_dwordx4 v9, s[40:43], s14 offen lds
    s_add_u32 s14, s8, 25600
    s_add_u32 m0, s12, 50176
    s_nop 0
    buffer_load_dwordx4 v9, s[40:43], s14 offen lds
    s_add_u32 s14, s8, 28672
    s_add_u32 m0, s12, 57344
    s_nop 0
    buffer_load_dwordx4 v9, s[40:43], s14 offen lds
    s_add_u32 s14, s8, 29696
    s_add_u32 m0, s12, 58368
    s_nop 0
    buffer_load_dwordx4 v9, s[40:43], s14 offen lds
    s_add_u32 s14, s8, 32768
    s_add_u32 m0, s12, 65536
    s_nop 0
    buffer_load_dwordx4 v9, s[40:43], s14 offen lds
    s_add_u32 s14, s8, 33792
    s_add_u32 m0, s12, 66560
    s_nop 0
    buffer_load_dwordx4 v9, s[40:43], s14 offen lds
    s_waitcnt vmcnt(16)
    s_barrier
    ds_read_b128 v[80:83], v13 offset:0
    ds_read_b128 v[88:91], v14 offset:0
    ds_read_b128 v[84:87], v13 offset:4096
    ds_read_b128 v[92:95], v14 offset:4096
    s_waitcnt vmcnt(14)
    s_barrier
    ds_read_b128 v[96:99], v13 offset:8192
    ds_read_b128 v[104:107], v14 offset:8192
    ds_read_b128 v[100:103], v13 offset:12288
    ds_read_b128 v[108:111], v14 offset:12288
    s_waitcnt lgkmcnt(4)
    v_mfma_f32_32x32x16_bf16 v[128:143], v[88:91], v[80:83], 0
    v_mfma_f32_32x32x16_bf16 v[160:175], v[92:95], v[80:83], 0
    v_mfma_f32_32x32x16_bf16 v[144:159], v[88:91], v[84:87], 0
    v_mfma_f32_32x32x16_bf16 v[176:191], v[92:95], v[84:87], 0
    s_waitcnt vmcnt(12)
    s_barrier
    ds_read_b128 v[80:83], v13 offset:16384
    ds_read_b128 v[88:91], v14 offset:16384
    ds_read_b128 v[84:87], v13 offset:20480
    ds_read_b128 v[92:95], v14 offset:20480
    s_add_u32 s14, s8, 36864
    s_add_u32 m0, s12, 73728
    s_nop 0
    buffer_load_dwordx4 v9, s[40:43], s14 offen lds
    s_add_u32 s14, s8, 37888
    s_add_u32 m0, s12, 74752
    s_nop 0
    buffer_load_dwordx4 v9, s[40:43], s14 offen lds
    s_add_u32 s14, s10, 36864
    s_add_u32 m0, s12, 155648
    s_nop 0
    buffer_load_dwordx4 v9, s[44:47], s14 offen lds
    s_add_u32 s14, s10, 37888
    s_add_u32 m0, s12, 156672
    s_nop 0
    buffer_load_dwordx4 v9, s[44:47], s14 offen lds
    s_waitcnt lgkmcnt(4)
    v_mfma_f32_32x32x16_bf16 v[128:143], v[104:107], v[96:99], v[128:143]
    v_mfma_f32_32x32x16_bf16 v[160:175], v[108:111], v[96:99], v[160:175]
    v_mfma_f32_32x32x16_bf16 v[144:159], v[104:107], v[100:103], v[144:159]
    v_mfma_f32_32x32x16_bf16 v[176:191], v[108:111], v[100:103], v[176:191]
    s_waitcnt vmcnt(14)
    s_barrier
    ds_read_b128 v[96:99], v13 offset:24576
    ds_read_b128 v[104:107], v14 offset:24576
    ds_read_b128 v[100:103], v13 offset:28672
    ds_read_b128 v[108:111], v14 offset:28672
    s_add_u32 s14, s8, 40960
    s_add_u32 m0, s12, 0
    s_nop 0
    buffer_load_dwordx4 v9, s[40:43], s14 offen lds
    s_add_u32 s14, s8, 41984
    s_add_u32 m0, s12, 1024
    s_nop 0
    buffer_load_dwordx4 v9, s[40:43], s14 offen lds
    s_add_u32 s14, s10, 40960
    s_add_u32 m0, s12, 81920
    s_nop 0
    buffer_load_dwordx4 v9, s[44:47], s14 offen lds
    s_add_u32 s14, s10, 41984
    s_add_u32 m0, s12, 82944
    s_nop 0
    buffer_load_dwordx4 v9, s[44:47], s14 offen lds
    s_waitcnt lgkmcnt(4)
    v_mfma_f32_32x32x16_bf16 v[128:143], v[88:91], v[80:83], v[128:143]
    v_mfma_f32_32x32x16_bf16 v[160:175], v[92:95], v[80:83], v[160:175]
    v_mfma_f32_32x32x16_bf16 v[144:159], v[88:91], v[84:87], v[144:159]
    v_mfma_f32_32x32x16_bf16 v[176:191], v[92:95], v[84:87], v[176:191]
    s_waitcnt vmcnt(16)
    s_barrier
    ds_read_b128 v[80:83], v13 offset:32768
    ds_read_b128 v[88:91], v14 offset:32768
    ds_read_b128 v[84:87], v13 offset:36864
    ds_read_b128 v[92:95], v14 offset:36864
    s_add_u32 s14, s8, 45056
    s_add_u32 m0, s12, 8192
    s_nop 0
    buffer_load_dwordx4 v9, s[40:43], s14 offen lds
    s_add_u32 s14, s8, 46080
    s_add_u32 m0, s12, 9216
    s_nop 0
    buffer_load_dwordx4 v9, s[40:43], s14 offen lds
    s_add_u32 s14, s10, 45056
    s_add_u32 m0, s12, 90112
    s_nop 0
    buffer_load_dwordx4 v9, s[44:47], s14 offen lds
    s_add_u32 s14, s10, 46080
    s_add_u32 m0, s12, 91136
    s_nop 0
    buffer_load_dwordx4 v9, s[44:47], s14 offen lds
    s_waitcnt lgkmcnt(4)
    v_mfma_f32_32x32x16_bf16 v[128:143], v[104:107], v[96:99], v[128:143]
    v_mfma_f32_32x32x16_bf16 v[160:175], v[108:111], v[96:99], v[160:175]
    v_mfma_f32_32x32x16_bf16 v[144:159], v[104:107], v[100:103], v[144:159]
    v_mfma_f32_32x32x16_bf16 v[176:191], v[108:111], v[100:103], v[176:191]
    s_waitcnt vmcnt(18)
    s_barrier
    ds_read_b128 v[96:99], v15 offset:0
    ds_read_b128 v[104:107], v16 offset:0
    ds_read_b128 v[100:103], v15 offset:4096
    ds_read_b128 v[108:111], v16 offset:4096
    s_add_u32 s14, s8, 49152
    s_add_u32 m0, s12, 16384
    s_nop 0
    buffer_load_dwordx4 v9, s[40:43], s14 offen lds
    s_add_u32 s14, s8, 50176
    s_add_u32 m0, s12, 17408
    s_nop 0
    buffer_load_dwordx4 v9, s[40:43], s14 offen lds
    s_add_u32 s14, s10, 49152
    s_add_u32 m0, s12, 98304
    s_nop 0
    buffer_load_dwordx4 v9, s[44:47], s14 offen lds
    s_add_u32 s14, s10, 50176
    s_add_u32 m0, s12, 99328
    s_nop 0
    buffer_load_dwordx4 v9, s[44:47], s14 offen lds
    s_waitcnt lgkmcnt(4)
    v_mfma_f32_32x32x16_bf16 v[128:143], v[88:91], v[80:83], v[128:143]
    v_mfma_f32_32x32x16_bf16 v[160:175], v[92:95], v[80:83], v[160:175]
    v_mfma_f32_32x32x16_bf16 v[144:159], v[88:91], v[84:87], v[144:159]
    v_mfma_f32_32x32x16_bf16 v[176:191], v[92:95], v[84:87], v[176:191]
    s_waitcnt vmcnt(20)
    s_barrier
    ds_read_b128 v[80:83], v15 offset:8192
    ds_read_b128 v[88:91], v16 offset:8192
    ds_read_b128 v[84:87], v15 offset:12288
    ds_read_b128 v[92:95], v16 offset:12288
    s_add_u32 s14, s8, 53248
    s_add_u32 m0, s12, 24576
    s_nop 0
    buffer_load_dwordx4 v9, s[40:43], s14 offen lds
    s_add_u32 s14, s8, 54272
    s_add_u32 m0, s12, 25600
    s_nop 0
    buffer_load_dwordx4 v9, s[40:43], s14 offen lds
    s_add_u32 s14, s10, 53248
    s_add_u32 m0, s12, 106496
    s_nop 0
    buffer_load_dwordx4 v9, s[44:47], s14 offen lds
    s_add_u32 s14, s10, 54272
    s_add_u32 m0, s12, 107520
    s_nop 0
    buffer_load_dwordx4 v9, s[44:47], s14 offen lds
    s_waitcnt lgkmcnt(4)
    v_mfma_f32_32x32x16_bf16 v[128:143], v[104:107], v[96:99], v[128:143]
    v_mfma_f32_32x32x16_bf16 v[160:175], v[108:111], v[96:99], v[160:175]
    v_mfma_f32_32x32x16_bf16 v[144:159], v[104:107], v[100:103], v[144:159]
    v_mfma_f32_32x32x16_bf16 v[176:191], v[108:111], v[100:103], v[176:191]
    s_waitcnt vmcnt(22)
    s_barrier
    ds_read_b128 v[96:99], v15 offset:16384
    ds_read_b128 v[104:107], v16 offset:16384
    ds_read_b128 v[100:103], v15 offset:20480
    ds_read_b128 v[108:111], v16 offset:20480
    s_add_u32 s14, s8, 57344
    s_add_u32 m0, s12, 32768
    s_nop 0
    buffer_load_dwordx4 v9, s[40:43], s14 offen lds
    s_add_u32 s14, s8, 58368
    s_add_u32 m0, s12, 33792
    s_nop 0
    buffer_load_dwordx4 v9, s[40:43], s14 offen lds
    s_add_u32 s14, s10, 57344
    s_add_u32 m0, s12, 114688
    s_nop 0
    buffer_load_dwordx4 v9, s[44:47], s14 offen lds
    s_add_u32 s14, s10, 58368
    s_add_u32 m0, s12, 115712
    s_nop 0
    buffer_load_dwordx4 v9, s[44:47], s14 offen lds
    s_waitcnt lgkmcnt(4)
    v_mfma_f32_32x32x16_bf16 v[128:143], v[88:91], v[80:83], v[128:143]
    v_mfma_f32_32x32x16_bf16 v[160:175], v[92:95], v[80:83], v[160:175]
    v_mfma_f32_32x32x16_bf16 v[144:159], v[88:91], v[84:87], v[144:159]
    v_mfma_f32_32x32x16_bf16 v[176:191], v[92:95], v[84:87], v[176:191]
    s_waitcnt vmcnt(24)
    s_barrier
    ds_read_b128 v[80:83], v15 offset:24576
    ds_read_b128 v[88:91], v16 offset:24576
    ds_read_b128 v[84:87], v15 offset:28672
    ds_read_b128 v[92:95], v16 offset:28672
    s_add_u32 s14, s8, 61440
    s_add_u32 m0, s12, 40960
    s_nop 0
    buffer_load_dwordx4 v9, s[40:43], s14 offen lds
    s_add_u32 s14, s8, 62464
    s_add_u32 m0, s12, 41984
    s_nop 0
    buffer_load_dwordx4 v9, s[40:43], s14 offen lds
    s_add_u32 s14, s10, 61440
    s_add_u32 m0, s12, 122880
    s_nop 0
    buffer_load_dwordx4 v9, s[44:47], s14 offen lds
    s_add_u32 s14, s10, 62464
    s_add_u32 m0, s12, 123904
    s_nop 0
    buffer_load_dwordx4 v9, s[44:47], s14 offen lds
    s_waitcnt lgkmcnt(4)
    v_mfma_f32_32x32x16_bf16 v[128:143], v[104:107], v[96:99], v[128:143]
    v_mfma_f32_32x32x16_bf16 v[160:175], v[108:111], v[96:99], v[160:175]
    v_mfma_f32_32x32x16_bf16 v[144:159], v[104:107], v[100:103], v[144:159]
    v_mfma_f32_32x32x16_bf16 v[176:191], v[108:111], v[100:103], v[176:191]
    s_waitcnt vmcnt(24)
    s_barrier
    ds_read_b128 v[96:99], v15 offset:32768
    ds_read_b128 v[104:107], v16 offset:32768
    ds_read_b128 v[100:103], v15 offset:36864
    ds_read_b128 v[108:111], v16 offset:36864
    s_add_u32 s14, s8, 65536
    s_add_u32 m0, s12, 49152
    s_nop 0
    buffer_load_dwordx4 v9, s[40:43], s14 offen lds
    s_add_u32 s14, s8, 66560
    s_add_u32 m0, s12, 50176
    s_nop 0
    buffer_load_dwordx4 v9, s[40:43], s14 offen lds
    s_add_u32 s14, s10, 65536
    s_add_u32 m0, s12, 131072
    s_nop 0
    buffer_load_dwordx4 v9, s[44:47], s14 offen lds
    s_add_u32 s14, s10, 66560
    s_add_u32 m0, s12, 132096
    s_nop 0
    buffer_load_dwordx4 v9, s[44:47], s14 offen lds
    s_waitcnt lgkmcnt(4)
    v_mfma_f32_32x32x16_bf16 v[128:143], v[88:91], v[80:83], v[128:143]
    v_mfma_f32_32x32x16_bf16 v[160:175], v[92:95], v[80:83], v[160:175]
    v_mfma_f32_32x32x16_bf16 v[144:159], v[88:91], v[84:87], v[144:159]
    v_mfma_f32_32x32x16_bf16 v[176:191], v[92:95], v[84:87], v[176:191]
    s_waitcnt vmcnt(24)
    s_barrier
    ds_read_b128 v[80:83], v13 offset:0
    ds_read_b128 v[88:91], v14 offset:0
    ds_read_b128 v[84:87], v13 offset:4096
    ds_read_b128 v[92:95], v14 offset:4096
    s_add_u32 s14, s8, 69632
    s_add_u32 m0, s12, 57344
    s_nop 0
    buffer_load_dwordx4 v9, s[40:43], s14 offen lds
    s_add_u32 s14, s8, 70656
    s_add_u32 m0, s12, 58368
    s_nop 0
    buffer_load_dwordx4 v9, s[40:43], s14 offen lds
    s_add_u32 s14, s10, 69632
    s_add_u32 m0, s12, 139264
    s_nop 0
    buffer_load_dwordx4 v9, s[44:47], s14 offen lds
    s_add_u32 s14, s10, 70656
    s_add_u32 m0, s12, 140288
    s_nop 0
    buffer_load_dwordx4 v9, s[44:47], s14 offen lds
    s_waitcnt lgkmcnt(4)
    v_mfma_f32_32x32x16_bf16 v[128:143], v[104:107], v[96:99], v[128:143]
    v_mfma_f32_32x32x16_bf16 v[160:175], v[108:111], v[96:99], v[160:175]
    v_mfma_f32_32x32x16_bf16 v[144:159], v[104:107], v[100:103], v[144:159]
    v_mfma_f32_32x32x16_bf16 v[176:191], v[108:111], v[100:103], v[176:191]
    s_waitcnt vmcnt(24)
    s_barrier
    ds_read_b128 v[96:99], v13 offset:8192
    ds_read_b128 v[104:107], v14 offset:8192
    ds_read_b128 v[100:103], v13 offset:12288
    ds_read_b128 v[108:111], v14 offset:12288
    s_add_u32 s14, s8, 73728
    s_add_u32 m0, s12, 65536
    s_nop 0
    buffer_load_dwordx4 v9, s[40:43], s14 offen lds
    s_add_u32 s14, s8, 74752
    s_add_u32 m0, s12, 66560
    s_nop 0
    buffer_load_dwordx4 v9, s[40:43], s14 offen lds
    s_add_u32 s14, s10, 73728
    s_add_u32 m0, s12, 147456
    s_nop 0
    buffer_load_dwordx4 v9, s[44:47], s14 offen lds
    s_add_u32 s14, s10, 74752
    s_add_u32 m0, s12, 148480
    s_nop 0
    buffer_load_dwordx4 v9, s[44:47], s14 offen lds
    s_waitcnt lgkmcnt(4)
    v_mfma_f32_32x32x16_bf16 v[128:143], v[88:91], v[80:83], v[128:143]
    v_mfma_f32_32x32x16_bf16 v[160:175], v[92:95], v[80:83], v[160:175]
    v_mfma_f32_32x32x16_bf16 v[144:159], v[88:91], v[84:87], v[144:159]
    v_mfma_f32_32x32x16_bf16 v[176:191], v[92:95], v[84:87], v[176:191]
    s_waitcnt vmcnt(24)
    s_barrier
    ds_read_b128 v[80:83], v13 offset:16384
    ds_read_b128 v[88:91], v14 offset:16384
    ds_read_b128 v[84:87], v13 offset:20480
    ds_read_b128 v[92:95], v14 offset:20480
    s_add_u32 s14, s8, 77824
    s_add_u32 m0, s12, 73728
    s_nop 0
    buffer_load_dwordx4 v9, s[40:43], s14 offen lds
    s_add_u32 s14, s8, 78848
    s_add_u32 m0, s12, 74752
    s_nop 0
    buffer_load_dwordx4 v9, s[40:43], s14 offen lds
    s_add_u32 s14, s10, 77824
    s_add_u32 m0, s12, 155648
    s_nop 0
    buffer_load_dwordx4 v9, s[44:47], s14 offen lds
    s_add_u32 s14, s10, 78848
    s_add_u32 m0, s12, 156672
    s_nop 0
    buffer_load_dwordx4 v9, s[44:47], s14 offen lds
    s_waitcnt lgkmcnt(4)
    v_mfma_f32_32x32x16_bf16 v[128:143], v[104:107], v[96:99], v[128:143]
    v_mfma_f32_32x32x16_bf16 v[160:175], v[108:111], v[96:99], v[160:175]
    v_mfma_f32_32x32x16_bf16 v[144:159], v[104:107], v[100:103], v[144:159]
    v_mfma_f32_32x32x16_bf16 v[176:191], v[108:111], v[100:103], v[176:191]
    s_waitcnt vmcnt(24)
    s_barrier
    ds_read_b128 v[96:99], v13 offset:24576
    ds_read_b128 v[104:107], v14 offset:24576
    ds_read_b128 v[100:103], v13 offset:28672
    ds_read_b128 v[108:111], v14 offset:28672
    s_add_u32 s14, s8, 81920
    s_add_u32 m0, s12, 0
    s_nop 0
    buffer_load_dwordx4 v9, s[40:43], s14 offen lds
    s_add_u32 s14, s8, 82944
    s_add_u32 m0, s12, 1024
    s_nop 0
    buffer_load_dwordx4 v9, s[40:43], s14 offen lds
    s_add_u32 s14, s10, 81920
    s_add_u32 m0, s12, 81920
    s_nop 0
    buffer_load_dwordx4 v9, s[44:47], s14 offen lds
    s_add_u32 s14, s10, 82944
    s_add_u32 m0, s12, 82944
    s_nop 0
    buffer_load_dwordx4 v9, s[44:47], s14 offen lds
    s_waitcnt lgkmcnt(4)
    v_mfma_f32_32x32x16_bf16 v[128:143], v[88:91], v[80:83], v[128:143]
    v_mfma_f32_32x32x16_bf16 v[160:175], v[92:95], v[80:83], v[160:175]
    v_mfma_f32_32x32x16_bf16 v[144:159], v[88:91], v[84:87], v[144:159]
    v_mfma_f32_32x32x16_bf16 v[176:191], v[92:95], v[84:87], v[176:191]
    s_waitcnt vmcnt(24)
    s_barrier
    ds_read_b128 v[80:83], v13 offset:32768
    ds_read_b128 v[88:91], v14 offset:32768
    ds_read_b128 v[84:87], v13 offset:36864
    ds_read_b128 v[92:95], v14 offset:36864
    s_add_u32 s14, s8, 86016
    s_add_u32 m0, s12, 8192
    s_nop 0
    buffer_load_dwordx4 v9, s[40:43], s14 offen lds
    s_add_u32 s14, s8, 87040
    s_add_u32 m0, s12, 9216
    s_nop 0
    buffer_load_dwordx4 v9, s[40:43], s14 offen lds
    s_add_u32 s14, s10, 86016
    s_add_u32 m0, s12, 90112
    s_nop 0
    buffer_load_dwordx4 v9, s[44:47], s14 offen lds
    s_add_u32 s14, s10, 87040
    s_add_u32 m0, s12, 91136
    s_nop 0
    buffer_load_dwordx4 v9, s[44:47], s14 offen lds
    s_waitcnt lgkmcnt(4)
    v_mfma_f32_32x32x16_bf16 v[128:143], v[104:107], v[96:99], v[128:143]
    v_mfma_f32_32x32x16_bf16 v[160:175], v[108:111], v[96:99], v[160:175]
    v_mfma_f32_32x32x16_bf16 v[144:159], v[104:107], v[100:103], v[144:159]
    v_mfma_f32_32x32x16_bf16 v[176:191], v[108:111], v[100:103], v[176:191]
    s_waitcnt vmcnt(24)
    s_barrier
    ds_read_b128 v[96:99], v15 offset:0
    ds_read_b128 v[104:107], v16 offset:0
    ds_read_b128 v[100:103], v15 offset:4096
    ds_read_b128 v[108:111], v16 offset:4096
    s_add_u32 s14, s8, 90112
    s_add_u32 m0, s12, 16384
    s_nop 0
    buffer_load_dwordx4 v9, s[40:43], s14 offen lds
    s_add_u32 s14, s8, 91136
    s_add_u32 m0, s12, 17408
    s_nop 0
    buffer_load_dwordx4 v9, s[40:43], s14 offen lds
    s_add_u32 s14, s10, 90112
    s_add_u32 m0, s12, 98304
    s_nop 0
    buffer_load_dwordx4 v9, s[44:47], s14 offen lds
    s_add_u32 s14, s10, 91136
    s_add_u32 m0, s12, 99328
    s_nop 0
    buffer_load_dwordx4 v9, s[44:47], s14 offen lds
    s_waitcnt lgkmcnt(4)
    v_mfma_f32_32x32x16_bf16 v[128:143], v[88:91], v[80:83], v[128:143]
    v_mfma_f32_32x32x16_bf16 v[160:175], v[92:95], v[80:83], v[160:175]
    v_mfma_f32_32x32x16_bf16 v[144:159], v[88:91], v[84:87], v[144:159]
    v_mfma_f32_32x32x16_bf16 v[176:191], v[92:95], v[84:87], v[176:191]
    s_waitcnt vmcnt(24)
    s_barrier
    ds_read_b128 v[80:83], v15 offset:8192
    ds_read_b128 v[88:91], v16 offset:8192
    ds_read_b128 v[84:87], v15 offset:12288
    ds_read_b128 v[92:95], v16 offset:12288
    s_add_u32 s14, s8, 94208
    s_add_u32 m0, s12, 24576
    s_nop 0
    buffer_load_dwordx4 v9, s[40:43], s14 offen lds
    s_add_u32 s14, s8, 95232
    s_add_u32 m0, s12, 25600
    s_nop 0
    buffer_load_dwordx4 v9, s[40:43], s14 offen lds
    s_add_u32 s14, s10, 94208
    s_add_u32 m0, s12, 106496
    s_nop 0
    buffer_load_dwordx4 v9, s[44:47], s14 offen lds
    s_add_u32 s14, s10, 95232
    s_add_u32 m0, s12, 107520
    s_nop 0
    buffer_load_dwordx4 v9, s[44:47], s14 offen lds
    s_waitcnt lgkmcnt(4)
    v_mfma_f32_32x32x16_bf16 v[128:143], v[104:107], v[96:99], v[128:143]
    v_mfma_f32_32x32x16_bf16 v[160:175], v[108:111], v[96:99], v[160:175]
    v_mfma_f32_32x32x16_bf16 v[144:159], v[104:107], v[100:103], v[144:159]
    v_mfma_f32_32x32x16_bf16 v[176:191], v[108:111], v[100:103], v[176:191]
    s_waitcnt vmcnt(24)
    s_barrier
    ds_read_b128 v[96:99], v15 offset:16384
    ds_read_b128 v[104:107], v16 offset:16384
    ds_read_b128 v[100:103], v15 offset:20480
    ds_read_b128 v[108:111], v16 offset:20480
    s_add_u32 s14, s8, 98304
    s_add_u32 m0, s12, 32768
    s_nop 0
    buffer_load_dwordx4 v9, s[40:43], s14 offen lds
    s_add_u32 s14, s8, 99328
    s_add_u32 m0, s12, 33792
    s_nop 0
    buffer_load_dwordx4 v9, s[40:43], s14 offen lds
    s_add_u32 s14, s10, 98304
    s_add_u32 m0, s12, 114688
    s_nop 0
    buffer_load_dwordx4 v9, s[44:47], s14 offen lds
    s_add_u32 s14, s10, 99328
    s_add_u32 m0, s12, 115712
    s_nop 0
    buffer_load_dwordx4 v9, s[44:47], s14 offen lds
    s_waitcnt lgkmcnt(4)
    v_mfma_f32_32x32x16_bf16 v[128:143], v[88:91], v[80:83], v[128:143]
    v_mfma_f32_32x32x16_bf16 v[160:175], v[92:95], v[80:83], v[160:175]
    v_mfma_f32_32x32x16_bf16 v[144:159], v[88:91], v[84:87], v[144:159]
    v_mfma_f32_32x32x16_bf16 v[176:191], v[92:95], v[84:87], v[176:191]
    s_waitcnt vmcnt(24)
    s_barrier
    ds_read_b128 v[80:83], v15 offset:24576
    ds_read_b128 v[88:91], v16 offset:24576
    ds_read_b128 v[84:87], v15 offset:28672
    ds_read_b128 v[92:95], v16 offset:28672
    s_add_u32 s14, s8, 102400
    s_add_u32 m0, s12, 40960
    s_nop 0
    buffer_load_dwordx4 v9, s[40:43], s14 offen lds
    s_add_u32 s14, s8, 103424
    s_add_u32 m0, s12, 41984
    s_nop 0
    buffer_load_dwordx4 v9, s[40:43], s14 offen lds
    s_add_u32 s14, s10, 102400
    s_add_u32 m0, s12, 122880
    s_nop 0
    buffer_load_dwordx4 v9, s[44:47], s14 offen lds
    s_add_u32 s14, s10, 103424
    s_add_u32 m0, s12, 123904
    s_nop 0
    buffer_load_dwordx4 v9, s[44:47], s14 offen lds
    s_waitcnt lgkmcnt(4)
    v_mfma_f32_32x32x16_bf16 v[128:143], v[104:107], v[96:99], v[128:143]
    v_mfma_f32_32x32x16_bf16 v[160:175], v[108:111], v[96:99], v[160:175]
    v_mfma_f32_32x32x16_bf16 v[144:159], v[104:107], v[100:103], v[144:159]
    v_mfma_f32_32x32x16_bf16 v[176:191], v[108:111], v[100:103], v[176:191]
    s_waitcnt vmcnt(24)
    s_barrier
    ds_read_b128 v[96:99], v15 offset:32768
    ds_read_b128 v[104:107], v16 offset:32768
    ds_read_b128 v[100:103], v15 offset:36864
    ds_read_b128 v[108:111], v16 offset:36864
    s_add_u32 s14, s8, 106496
    s_add_u32 m0, s12, 49152
    s_nop 0
    buffer_load_dwordx4 v9, s[40:43], s14 offen lds
    s_add_u32 s14, s8, 107520
    s_add_u32 m0, s12, 50176
    s_nop 0
    buffer_load_dwordx4 v9, s[40:43], s14 offen lds
    s_add_u32 s14, s10, 106496
    s_add_u32 m0, s12, 131072
    s_nop 0
    buffer_load_dwordx4 v9, s[44:47], s14 offen lds
    s_add_u32 s14, s10, 107520
    s_add_u32 m0, s12, 132096
    s_nop 0
    buffer_load_dwordx4 v9, s[44:47], s14 offen lds
    s_waitcnt lgkmcnt(4)
    v_mfma_f32_32x32x16_bf16 v[128:143], v[88:91], v[80:83], v[128:143]
    v_mfma_f32_32x32x16_bf16 v[160:175], v[92:95], v[80:83], v[160:175]
    v_mfma_f32_32x32x16_bf16 v[144:159], v[88:91], v[84:87], v[144:159]
    v_mfma_f32_32x32x16_bf16 v[176:191], v[92:95], v[84:87], v[176:191]
    s_waitcnt vmcnt(24)
    s_barrier
    ds_read_b128 v[80:83], v13 offset:0
    ds_read_b128 v[88:91], v14 offset:0
    ds_read_b128 v[84:87], v13 offset:4096
    ds_read_b128 v[92:95], v14 offset:4096
    s_add_u32 s14, s8, 110592
    s_add_u32 m0, s12, 57344
    s_nop 0
    buffer_load_dwordx4 v9, s[40:43], s14 offen lds
    s_add_u32 s14, s8, 111616
    s_add_u32 m0, s12, 58368
    s_nop 0
    buffer_load_dwordx4 v9, s[40:43], s14 offen lds
    s_add_u32 s14, s10, 110592
    s_add_u32 m0, s12, 139264
    s_nop 0
    buffer_load_dwordx4 v9, s[44:47], s14 offen lds
    s_add_u32 s14, s10, 111616
    s_add_u32 m0, s12, 140288
    s_nop 0
    buffer_load_dwordx4 v9, s[44:47], s14 offen lds
    s_waitcnt lgkmcnt(4)
    v_mfma_f32_32x32x16_bf16 v[128:143], v[104:107], v[96:99], v[128:143]
    v_mfma_f32_32x32x16_bf16 v[160:175], v[108:111], v[96:99], v[160:175]
    v_mfma_f32_32x32x16_bf16 v[144:159], v[104:107], v[100:103], v[144:159]
    v_mfma_f32_32x32x16_bf16 v[176:191], v[108:111], v[100:103], v[176:191]
    s_waitcnt vmcnt(24)
    s_barrier
    ds_read_b128 v[96:99], v13 offset:8192
    ds_read_b128 v[104:107], v14 offset:8192
    ds_read_b128 v[100:103], v13 offset:12288
    ds_read_b128 v[108:111], v14 offset:12288
    s_waitcnt lgkmcnt(4)
    v_mfma_f32_32x32x16_bf16 v[128:143], v[88:91], v[80:83], v[128:143]
    v_mfma_f32_32x32x16_bf16 v[160:175], v[92:95], v[80:83], v[160:175]
    v_mfma_f32_32x32x16_bf16 v[144:159], v[88:91], v[84:87], v[144:159]
    v_mfma_f32_32x32x16_bf16 v[176:191], v[92:95], v[84:87], v[176:191]
    s_waitcnt vmcnt(20)
    s_barrier
    ds_read_b128 v[80:83], v13 offset:16384
    ds_read_b128 v[88:91], v14 offset:16384
    ds_read_b128 v[84:87], v13 offset:20480
    ds_read_b128 v[92:95], v14 offset:20480
    s_waitcnt lgkmcnt(4)
    v_mfma_f32_32x32x16_bf16 v[128:143], v[104:107], v[96:99], v[128:143]
    v_mfma_f32_32x32x16_bf16 v[160:175], v[108:111], v[96:99], v[160:175]
    v_mfma_f32_32x32x16_bf16 v[144:159], v[104:107], v[100:103], v[144:159]
    v_mfma_f32_32x32x16_bf16 v[176:191], v[108:111], v[100:103], v[176:191]
    s_waitcnt vmcnt(16)
    s_barrier
    ds_read_b128 v[96:99], v13 offset:24576
    ds_read_b128 v[104:107], v14 offset:24576
    ds_read_b128 v[100:103], v13 offset:28672
    ds_read_b128 v[108:111], v14 offset:28672
    s_waitcnt lgkmcnt(4)
    v_mfma_f32_32x32x16_bf16 v[128:143], v[88:91], v[80:83], v[128:143]
    v_mfma_f32_32x32x16_bf16 v[160:175], v[92:95], v[80:83], v[160:175]
    v_mfma_f32_32x32x16_bf16 v[144:159], v[88:91], v[84:87], v[144:159]
    v_mfma_f32_32x32x16_bf16 v[176:191], v[92:95], v[84:87], v[176:191]
    s_waitcnt vmcnt(12)
    s_barrier
    ds_read_b128 v[80:83], v13 offset:32768
    ds_read_b128 v[88:91], v14 offset:32768
    ds_read_b128 v[84:87], v13 offset:36864
    ds_read_b128 v[92:95], v14 offset:36864
    s_waitcnt lgkmcnt(4)
    v_mfma_f32_32x32x16_bf16 v[128:143], v[104:107], v[96:99], v[128:143]
    v_mfma_f32_32x32x16_bf16 v[160:175], v[108:111], v[96:99], v[160:175]
    v_mfma_f32_32x32x16_bf16 v[144:159], v[104:107], v[100:103], v[144:159]
    v_mfma_f32_32x32x16_bf16 v[176:191], v[108:111], v[100:103], v[176:191]
    s_waitcnt vmcnt(8)
    s_barrier
    ds_read_b128 v[96:99], v15 offset:0
    ds_read_b128 v[104:107], v16 offset:0
    ds_read_b128 v[100:103], v15 offset:4096
    ds_read_b128 v[108:111], v16 offset:4096
    s_waitcnt lgkmcnt(4)
    v_mfma_f32_32x32x16_bf16 v[128:143], v[88:91], v[80:83], v[128:143]
    v_mfma_f32_32x32x16_bf16 v[160:175], v[92:95], v[80:83], v[160:175]
    v_mfma_f32_32x32x16_bf16 v[144:159], v[88:91], v[84:87], v[144:159]
    v_mfma_f32_32x32x16_bf16 v[176:191], v[92:95], v[84:87], v[176:191]
    s_waitcnt vmcnt(4)
    s_barrier
    ds_read_b128 v[80:83], v15 offset:8192
    ds_read_b128 v[88:91], v16 offset:8192
    ds_read_b128 v[84:87], v15 offset:12288
    ds_read_b128 v[92:95], v16 offset:12288
    s_waitcnt lgkmcnt(4)
    v_mfma_f32_32x32x16_bf16 v[128:143], v[104:107], v[96:99], v[128:143]
    v_mfma_f32_32x32x16_bf16 v[160:175], v[108:111], v[96:99], v[160:175]
    v_mfma_f32_32x32x16_bf16 v[144:159], v[104:107], v[100:103], v[144:159]
    v_mfma_f32_32x32x16_bf16 v[176:191], v[108:111], v[100:103], v[176:191]
    s_waitcnt vmcnt(0)
    s_barrier
    ds_read_b128 v[96:99], v15 offset:16384
    ds_read_b128 v[104:107], v16 offset:16384
    ds_read_b128 v[100:103], v15 offset:20480
    ds_read_b128 v[108:111], v16 offset:20480
    s_waitcnt lgkmcnt(4)
    v_mfma_f32_32x32x16_bf16 v[128:143], v[88:91], v[80:83], v[128:143]
    v_mfma_f32_32x32x16_bf16 v[160:175], v[92:95], v[80:83], v[160:175]
    v_mfma_f32_32x32x16_bf16 v[144:159], v[88:91], v[84:87], v[144:159]
    v_mfma_f32_32x32x16_bf16 v[176:191], v[92:95], v[84:87], v[176:191]
    s_waitcnt lgkmcnt(0)
    v_mfma_f32_32x32x16_bf16 v[128:143], v[104:107], v[96:99], v[128:143]
    v_mfma_f32_32x32x16_bf16 v[160:175], v[108:111], v[96:99], v[160:175]
    v_mfma_f32_32x32x16_bf16 v[144:159], v[104:107], v[100:103], v[144:159]
    v_mfma_f32_32x32x16_bf16 v[176:191], v[108:111], v[100:103], v[176:191]
    s_barrier
    s_nop 13
    s_lshl_b32 s62, s3, 12
    v_add_u32 v17, s62, v9
    ds_write_b128 v17, v[128:131] offset:0
    ds_write_b128 v17, v[132:135] offset:1024
    ds_write_b128 v17, v[136:139] offset:2048
    ds_write_b128 v17, v[140:143] offset:3072
    ds_write_b128 v17, v[144:147] offset:16384
    ds_write_b128 v17, v[148:151] offset:17408
    ds_write_b128 v17, v[152:155] offset:18432
    ds_write_b128 v17, v[156:159] offset:19456
    ds_write_b128 v17, v[160:163] offset:32768
    ds_write_b128 v17, v[164:167] offset:33792
    ds_write_b128 v17, v[168:171] offset:34816
    ds_write_b128 v17, v[172:175] offset:35840
    ds_write_b128 v17, v[176:179] offset:49152
    ds_write_b128 v17, v[180:183] offset:50176
    ds_write_b128 v17, v[184:187] offset:51200
    ds_write_b128 v17, v[188:191] offset:52224
    s_lshl_b32 s62, s3, 14
    v_add_u32 v17, s62, v9
    s_waitcnt lgkmcnt(0)
    s_barrier
    ds_read_b128 v[128:131], v17 offset:0
    ds_read_b128 v[132:135], v17 offset:1024
    ds_read_b128 v[136:139], v17 offset:2048
    ds_read_b128 v[140:143], v17 offset:3072
    ds_read_b128 v[144:147], v17 offset:4096
    ds_read_b128 v[148:151], v17 offset:5120
    ds_read_b128 v[152:155], v17 offset:6144
    ds_read_b128 v[156:159], v17 offset:7168
    ds_read_b128 v[160:163], v17 offset:8192
    ds_read_b128 v[164:167], v17 offset:9216
    ds_read_b128 v[168:171], v17 offset:10240
    ds_read_b128 v[172:175], v17 offset:11264
    ds_read_b128 v[176:179], v17 offset:12288
    ds_read_b128 v[180:183], v17 offset:13312
    ds_read_b128 v[184:187], v17 offset:14336
    ds_read_b128 v[188:191], v17 offset:15360
    s_waitcnt lgkmcnt(0)
    v_add_f32 v128, v128, v144
    v_add_f32 v160, v160, v176
    v_add_f32 v64, v128, v160
    v_add_f32 v129, v129, v145
    v_add_f32 v161, v161, v177
    v_add_f32 v65, v129, v161
    v_add_f32 v130, v130, v146
    v_add_f32 v162, v162, v178
    v_add_f32 v66, v130, v162
    v_add_f32 v131, v131, v147
    v_add_f32 v163, v163, v179
    v_add_f32 v67, v131, v163
    v_add_f32 v132, v132, v148
    v_add_f32 v164, v164, v180
    v_add_f32 v68, v132, v164
    v_add_f32 v133, v133, v149
    v_add_f32 v165, v165, v181
    v_add_f32 v69, v133, v165
    v_add_f32 v134, v134, v150
    v_add_f32 v166, v166, v182
    v_add_f32 v70, v134, v166
    v_add_f32 v135, v135, v151
    v_add_f32 v167, v167, v183
    v_add_f32 v71, v135, v167
    v_add_f32 v136, v136, v152
    v_add_f32 v168, v168, v184
    v_add_f32 v72, v136, v168
    v_add_f32 v137, v137, v153
    v_add_f32 v169, v169, v185
    v_add_f32 v73, v137, v169
    v_add_f32 v138, v138, v154
    v_add_f32 v170, v170, v186
    v_add_f32 v74, v138, v170
    v_add_f32 v139, v139, v155
    v_add_f32 v171, v171, v187
    v_add_f32 v75, v139, v171
    v_add_f32 v140, v140, v156
    v_add_f32 v172, v172, v188
    v_add_f32 v76, v140, v172
    v_add_f32 v141, v141, v157
    v_add_f32 v173, v173, v189
    v_add_f32 v77, v141, v173
    v_add_f32 v142, v142, v158
    v_add_f32 v174, v174, v190
    v_add_f32 v78, v142, v174
    v_add_f32 v143, v143, v159
    v_add_f32 v175, v175, v191
    v_add_f32 v79, v143, v175
    s_barrier
    v_permlane32_swap_b32 v32, v34
    v_permlane32_swap_b32 v33, v35
    v_permlane32_swap_b32 v36, v38
    v_permlane32_swap_b32 v37, v39
    s_nop 11
    v_lshlrev_b32 v20, 16, v32
    v_and_b32 v21, 0xffff0000, v32
    v_lshlrev_b32 v22, 16, v40
    v_and_b32 v23, 0xffff0000, v40
    v_add_f32 v64, v64, v22
    v_add_f32 v65, v65, v23
    v_add_f32 v64, v64, v20
    v_add_f32 v65, v65, v21
    v_cvt_pk_bf16_f32 v32, v64, v65
    v_lshlrev_b32 v20, 16, v33
    v_and_b32 v21, 0xffff0000, v33
    v_lshlrev_b32 v22, 16, v41
    v_and_b32 v23, 0xffff0000, v41
    v_add_f32 v66, v66, v22
    v_add_f32 v67, v67, v23
    v_add_f32 v66, v66, v20
    v_add_f32 v67, v67, v21
    v_cvt_pk_bf16_f32 v33, v66, v67
    v_lshlrev_b32 v20, 16, v34
    v_and_b32 v21, 0xffff0000, v34
    v_lshlrev_b32 v22, 16, v42
    v_and_b32 v23, 0xffff0000, v42
    v_add_f32 v68, v68, v22
    v_add_f32 v69, v69, v23
    v_add_f32 v68, v68, v20
    v_add_f32 v69, v69, v21
    v_cvt_pk_bf16_f32 v34, v68, v69
    v_lshlrev_b32 v20, 16, v35
    v_and_b32 v21, 0xffff0000, v35
    v_lshlrev_b32 v22, 16, v43
    v_and_b32 v23, 0xffff0000, v43
    v_add_f32 v70, v70, v22
    v_add_f32 v71, v71, v23
    v_add_f32 v70, v70, v20
    v_add_f32 v71, v71, v21
    v_cvt_pk_bf16_f32 v35, v70, v71
    v_lshlrev_b32 v20, 16, v36
    v_and_b32 v21, 0xffff0000, v36
    v_lshlrev_b32 v22, 16, v44
    v_and_b32 v23, 0xffff0000, v44
    v_add_f32 v72, v72, v22
    v_add_f32 v73, v73, v23
    v_add_f32 v72, v72, v20
    v_add_f32 v73, v73, v21
    v_cvt_pk_bf16_f32 v36, v72, v73
    v_lshlrev_b32 v20, 16, v37
    v_and_b32 v21, 0xffff0000, v37
    v_lshlrev_b32 v22, 16, v45
    v_and_b32 v23, 0xffff0000, v45
    v_add_f32 v74, v74, v22
    v_add_f32 v75, v75, v23
    v_add_f32 v74, v74, v20
    v_add_f32 v75, v75, v21
    v_cvt_pk_bf16_f32 v37, v74, v75
    v_lshlrev_b32 v20, 16, v38
    v_and_b32 v21, 0xffff0000, v38
    v_lshlrev_b32 v22, 16, v46
    v_and_b32 v23, 0xffff0000, v46
    v_add_f32 v76, v76, v22
    v_add_f32 v77, v77, v23
    v_add_f32 v76, v76, v20
    v_add_f32 v77, v77, v21
    v_cvt_pk_bf16_f32 v38, v76, v77
    v_lshlrev_b32 v20, 16, v39
    v_and_b32 v21, 0xffff0000, v39
    v_lshlrev_b32 v22, 16, v47
    v_and_b32 v23, 0xffff0000, v47
    v_add_f32 v78, v78, v22
    v_add_f32 v79, v79, v23
    v_add_f32 v78, v78, v20
    v_add_f32 v79, v79, v21
    v_cvt_pk_bf16_f32 v39, v78, v79
    s_nop 0
    v_permlane32_swap_b32 v32, v34
    v_permlane32_swap_b32 v33, v35
    v_permlane32_swap_b32 v36, v38
    v_permlane32_swap_b32 v37, v39
    buffer_store_dwordx4 v[32:35], v9, s[52:55], s60 offen offset:0 sc1
    buffer_store_dwordx4 v[36:39], v9, s[52:55], s60 offen offset:1024 sc1
    s_lshr_b32 s62, s4, 1
    s_lshl_b32 s62, s62, 7
    s_and_b32 s63, s4, 1
    s_mul_i32 s63, s63, 7
    s_add_u32 s63, s63, s5
    s_lshl_b32 s63, s63, 2
    s_add_u32 s62, s62, s63
    s_add_u32 s62, s62, 16384
    s_waitcnt vmcnt(0) lgkmcnt(0)
    s_barrier
    s_cmp_eq_u32 s3, 0
    s_cbranch_scc0 L_sig_22
    v_mov_b32 v5, s98
    v_mov_b32 v6, 0
    s_mov_b64 exec, 1
    buffer_store_dword v5, v6, s[72:75], s62 offen sc1
    s_mov_b64 exec, -1
L_sig_22:
    s_lshr_b32 s8, s2, 4
    s_add_u32 s44, s38, 0x2200000
    s_addc_u32 s45, s39, 0
    s_and_b32 s45, s45, 0xffff
    s_mov_b32 s46, 0x150000
    s_mov_b32 s47, 0x20000
    s_mul_i32 s8, s8, 86016
    v_lshlrev_b32 v9, 4, v1
    s_cmp_eq_u32 s3, 0
    s_cbranch_scc0 k1pa_dw0
    s_add_u32 s11, s8, 0
    s_mov_b32 m0, 65536
    s_nop 0
    buffer_load_dwordx4 v9, s[44:47], s11 offen lds
    s_add_u32 s11, s8, 29696
    s_mov_b32 m0, 95232
    s_nop 0
    buffer_load_dwordx4 v9, s[44:47], s11 offen lds
    s_add_u32 s11, s8, 59392
    s_mov_b32 m0, 124928
    s_nop 0
    buffer_load_dwordx4 v9, s[44:47], s11 offen lds
    s_add_u32 s11, s8, 4096
    s_mov_b32 m0, 69632
    s_nop 0
    buffer_load_dwordx4 v9, s[44:47], s11 offen lds
    s_add_u32 s11, s8, 33792
    s_mov_b32 m0, 99328
    s_nop 0
    buffer_load_dwordx4 v9, s[44:47], s11 offen lds
    s_add_u32 s11, s8, 63488
    s_mov_b32 m0, 129024
    s_nop 0
    buffer_load_dwordx4 v9, s[44:47], s11 offen lds
    s_add_u32 s11, s8, 8192
    s_mov_b32 m0, 73728
    s_nop 0
    buffer_load_dwordx4 v9, s[44:47], s11 offen lds
    s_add_u32 s11, s8, 37888
    s_mov_b32 m0, 103424
    s_nop 0
    buffer_load_dwordx4 v9, s[44:47], s11 offen lds
    s_add_u32 s11, s8, 67584
    s_mov_b32 m0, 133120
    s_nop 0
    buffer_load_dwordx4 v9, s[44:47], s11 offen lds
    s_add_u32 s11, s8, 12288
    s_mov_b32 m0, 77824
    s_nop 0
    buffer_load_dwordx4 v9, s[44:47], s11 offen lds
    s_add_u32 s11, s8, 41984
    s_mov_b32 m0, 107520
    s_nop 0
    buffer_load_dwordx4 v9, s[44:47], s11 offen lds
    s_add_u32 s11, s8, 71680
    s_mov_b32 m0, 137216
    s_nop 0
    buffer_load_dwordx4 v9, s[44:47], s11 offen lds
    s_add_u32 s11, s8, 16384
    s_mov_b32 m0, 81920
    s_nop 0
    buffer_load_dwordx4 v9, s[44:47], s11 offen lds
    s_add_u32 s11, s8, 46080
    s_mov_b32 m0, 111616
    s_nop 0
    buffer_load_dwordx4 v9, s[44:47], s11 offen lds
    s_add_u32 s11, s8, 75776
    s_mov_b32 m0, 141312
    s_nop 0
    buffer_load_dwordx4 v9, s[44:47], s11 offen lds
    s_add_u32 s11, s8, 20480
    s_mov_b32 m0, 86016
    s_nop 0
    buffer_load_dwordx4 v9, s[44:47], s11 offen lds
    s_add_u32 s11, s8, 50176
    s_mov_b32 m0, 115712
    s_nop 0
    buffer_load_dwordx4 v9, s[44:47], s11 offen lds
    s_add_u32 s11, s8, 79872
    s_mov_b32 m0, 145408
    s_nop 0
    buffer_load_dwordx4 v9, s[44:47], s11 offen lds
    s_add_u32 s11, s8, 24576
    s_mov_b32 m0, 90112
    s_nop 0
    buffer_load_dwordx4 v9, s[44:47], s11 offen lds
    s_add_u32 s11, s8, 54272
    s_mov_b32 m0, 119808
    s_nop 0
    buffer_load_dwordx4 v9, s[44:47], s11 offen lds
    s_add_u32 s11, s8, 83968
    s_mov_b32 m0, 149504
    s_nop 0
    buffer_load_dwordx4 v9, s[44:47], s11 offen lds
k1pa_dw0:
    s_cmp_eq_u32 s3, 1
    s_cbranch_scc0 k1pa_dw1
    s_add_u32 s11, s8, 28672
    s_mov_b32 m0, 94208
    s_nop 0
    buffer_load_dwordx4 v9, s[44:47], s11 offen lds
    s_add_u32 s11, s8, 58368
    s_mov_b32 m0, 123904
    s_nop 0
    buffer_load_dwordx4 v9, s[44:47], s11 offen lds
    s_add_u32 s11, s8, 3072
    s_mov_b32 m0, 68608
    s_nop 0
    buffer_load_dwordx4 v9, s[44:47], s11 offen lds
    s_add_u32 s11, s8, 32768
    s_mov_b32 m0, 98304
    s_nop 0
    buffer_load_dwordx4 v9, s[44:47], s11 offen lds
    s_add_u32 s11, s8, 62464
    s_mov_b32 m0, 128000
    s_nop 0
    buffer_load_dwordx4 v9, s[44:47], s11 offen lds
    s_add_u32 s11, s8, 7168
    s_mov_b32 m0, 72704
    s_nop 0
    buffer_load_dwordx4 v9, s[44:47], s11 offen lds
    s_add_u32 s11, s8, 36864
    s_mov_b32 m0, 102400
    s_nop 0
    buffer_load_dwordx4 v9, s[44:47], s11 offen lds
    s_add_u32 s11, s8, 66560
    s_mov_b32 m0, 132096
    s_nop 0
    buffer_load_dwordx4 v9, s[44:47], s11 offen lds
    s_add_u32 s11, s8, 11264
    s_mov_b32 m0, 76800
    s_nop 0
    buffer_load_dwordx4 v9, s[44:47], s11 offen lds
    s_add_u32 s11, s8, 40960
    s_mov_b32 m0, 106496
    s_nop 0
    buffer_load_dwordx4 v9, s[44:47], s11 offen lds
    s_add_u32 s11, s8, 70656
    s_mov_b32 m0, 136192
    s_nop 0
    buffer_load_dwordx4 v9, s[44:47], s11 offen lds
    s_add_u32 s11, s8, 15360
    s_mov_b32 m0, 80896
    s_nop 0
    buffer_load_dwordx4 v9, s[44:47], s11 offen lds
    s_add_u32 s11, s8, 45056
    s_mov_b32 m0, 110592
    s_nop 0
    buffer_load_dwordx4 v9, s[44:47], s11 offen lds
    s_add_u32 s11, s8, 74752
    s_mov_b32 m0, 140288
    s_nop 0
    buffer_load_dwordx4 v9, s[44:47], s11 offen lds
    s_add_u32 s11, s8, 19456
    s_mov_b32 m0, 84992
    s_nop 0
    buffer_load_dwordx4 v9, s[44:47], s11 offen lds
    s_add_u32 s11, s8, 49152
    s_mov_b32 m0, 114688
    s_nop 0
    buffer_load_dwordx4 v9, s[44:47], s11 offen lds
    s_add_u32 s11, s8, 78848
    s_mov_b32 m0, 144384
    s_nop 0
    buffer_load_dwordx4 v9, s[44:47], s11 offen lds
    s_add_u32 s11, s8, 23552
    s_mov_b32 m0, 89088
    s_nop 0
    buffer_load_dwordx4 v9, s[44:47], s11 offen lds
    s_add_u32 s11, s8, 53248
    s_mov_b32 m0, 118784
    s_nop 0
    buffer_load_dwordx4 v9, s[44:47], s11 offen lds
    s_add_u32 s11, s8, 82944
    s_mov_b32 m0, 148480
    s_nop 0
    buffer_load_dwordx4 v9, s[44:47], s11 offen lds
    s_add_u32 s11, s8, 27648
    s_mov_b32 m0, 93184
    s_nop 0
    buffer_load_dwordx4 v9, s[44:47], s11 offen lds
k1pa_dw1:
    s_cmp_eq_u32 s3, 2
    s_cbranch_scc0 k1pa_dw2
    s_add_u32 s11, s8, 57344
    s_mov_b32 m0, 122880
    s_nop 0
    buffer_load_dwordx4 v9, s[44:47], s11 offen lds
    s_add_u32 s11, s8, 2048
    s_mov_b32 m0, 67584
    s_nop 0
    buffer_load_dwordx4 v9, s[44:47], s11 offen lds
    s_add_u32 s11, s8, 31744
    s_mov_b32 m0, 97280
    s_nop 0
    buffer_load_dwordx4 v9, s[44:47], s11 offen lds
    s_add_u32 s11, s8, 61440
    s_mov_b32 m0, 126976
    s_nop 0
    buffer_load_dwordx4 v9, s[44:47], s11 offen lds
    s_add_u32 s11, s8, 6144
    s_mov_b32 m0, 71680
    s_nop 0
    buffer_load_dwordx4 v9, s[44:47], s11 offen lds
    s_add_u32 s11, s8, 35840
    s_mov_b32 m0, 101376
    s_nop 0
    buffer_load_dwordx4 v9, s[44:47], s11 offen lds
    s_add_u32 s11, s8, 65536
    s_mov_b32 m0, 131072
    s_nop 0
    buffer_load_dwordx4 v9, s[44:47], s11 offen lds
    s_add_u32 s11, s8, 10240
    s_mov_b32 m0, 75776
    s_nop 0
    buffer_load_dwordx4 v9, s[44:47], s11 offen lds
    s_add_u32 s11, s8, 39936
    s_mov_b32 m0, 105472
    s_nop 0
    buffer_load_dwordx4 v9, s[44:47], s11 offen lds
    s_add_u32 s11, s8, 69632
    s_mov_b32 m0, 135168
    s_nop 0
    buffer_load_dwordx4 v9, s[44:47], s11 offen lds
    s_add_u32 s11, s8, 14336
    s_mov_b32 m0, 79872
    s_nop 0
    buffer_load_dwordx4 v9, s[44:47], s11 offen lds
    s_add_u32 s11, s8, 44032
    s_mov_b32 m0, 109568
    s_nop 0
    buffer_load_dwordx4 v9, s[44:47], s11 offen lds
    s_add_u32 s11, s8, 73728
    s_mov_b32 m0, 139264
    s_nop 0
    buffer_load_dwordx4 v9, s[44:47], s11 offen lds
    s_add_u32 s11, s8, 18432
    s_mov_b32 m0, 83968
    s_nop 0
    buffer_load_dwordx4 v9, s[44:47], s11 offen lds
    s_add_u32 s11, s8, 48128
    s_mov_b32 m0, 113664
    s_nop 0
    buffer_load_dwordx4 v9, s[44:47], s11 offen lds
    s_add_u32 s11, s8, 77824
    s_mov_b32 m0, 143360
    s_nop 0
    buffer_load_dwordx4 v9, s[44:47], s11 offen lds
    s_add_u32 s11, s8, 22528
    s_mov_b32 m0, 88064
    s_nop 0
    buffer_load_dwordx4 v9, s[44:47], s11 offen lds
    s_add_u32 s11, s8, 52224
    s_mov_b32 m0, 117760
    s_nop 0
    buffer_load_dwordx4 v9, s[44:47], s11 offen lds
    s_add_u32 s11, s8, 81920
    s_mov_b32 m0, 147456
    s_nop 0
    buffer_load_dwordx4 v9, s[44:47], s11 offen lds
    s_add_u32 s11, s8, 26624
    s_mov_b32 m0, 92160
    s_nop 0
    buffer_load_dwordx4 v9, s[44:47], s11 offen lds
    s_add_u32 s11, s8, 56320
    s_mov_b32 m0, 121856
    s_nop 0
    buffer_load_dwordx4 v9, s[44:47], s11 offen lds
k1pa_dw2:
    s_cmp_eq_u32 s3, 3
    s_cbranch_scc0 k1pa_dw3
    s_add_u32 s11, s8, 1024
    s_mov_b32 m0, 66560
    s_nop 0
    buffer_load_dwordx4 v9, s[44:47], s11 offen lds
    s_add_u32 s11, s8, 30720
    s_mov_b32 m0, 96256
    s_nop 0
    buffer_load_dwordx4 v9, s[44:47], s11 offen lds
    s_add_u32 s11, s8, 60416
    s_mov_b32 m0, 125952
    s_nop 0
    buffer_load_dwordx4 v9, s[44:47], s11 offen lds
    s_add_u32 s11, s8, 5120
    s_mov_b32 m0, 70656
    s_nop 0
    buffer_load_dwordx4 v9, s[44:47], s11 offen lds
    s_add_u32 s11, s8, 34816
    s_mov_b32 m0, 100352
    s_nop 0
    buffer_load_dwordx4 v9, s[44:47], s11 offen lds
    s_add_u32 s11, s8, 64512
    s_mov_b32 m0, 130048
    s_nop 0
    buffer_load_dwordx4 v9, s[44:47], s11 offen lds
    s_add_u32 s11, s8, 9216
    s_mov_b32 m0, 74752
    s_nop 0
    buffer_load_dwordx4 v9, s[44:47], s11 offen lds
    s_add_u32 s11, s8, 38912
    s_mov_b32 m0, 104448
    s_nop 0
    buffer_load_dwordx4 v9, s[44:47], s11 offen lds
    s_add_u32 s11, s8, 68608
    s_mov_b32 m0, 134144
    s_nop 0
    buffer_load_dwordx4 v9, s[44:47], s11 offen lds
    s_add_u32 s11, s8, 13312
    s_mov_b32 m0, 78848
    s_nop 0
    buffer_load_dwordx4 v9, s[44:47], s11 offen lds
    s_add_u32 s11, s8, 43008
    s_mov_b32 m0, 108544
    s_nop 0
    buffer_load_dwordx4 v9, s[44:47], s11 offen lds
    s_add_u32 s11, s8, 72704
    s_mov_b32 m0, 138240
    s_nop 0
    buffer_load_dwordx4 v9, s[44:47], s11 offen lds
    s_add_u32 s11, s8, 17408
    s_mov_b32 m0, 82944
    s_nop 0
    buffer_load_dwordx4 v9, s[44:47], s11 offen lds
    s_add_u32 s11, s8, 47104
    s_mov_b32 m0, 112640
    s_nop 0
    buffer_load_dwordx4 v9, s[44:47], s11 offen lds
    s_add_u32 s11, s8, 76800
    s_mov_b32 m0, 142336
    s_nop 0
    buffer_load_dwordx4 v9, s[44:47], s11 offen lds
    s_add_u32 s11, s8, 21504
    s_mov_b32 m0, 87040
    s_nop 0
    buffer_load_dwordx4 v9, s[44:47], s11 offen lds
    s_add_u32 s11, s8, 51200
    s_mov_b32 m0, 116736
    s_nop 0
    buffer_load_dwordx4 v9, s[44:47], s11 offen lds
    s_add_u32 s11, s8, 80896
    s_mov_b32 m0, 146432
    s_nop 0
    buffer_load_dwordx4 v9, s[44:47], s11 offen lds
    s_add_u32 s11, s8, 25600
    s_mov_b32 m0, 91136
    s_nop 0
    buffer_load_dwordx4 v9, s[44:47], s11 offen lds
    s_add_u32 s11, s8, 55296
    s_mov_b32 m0, 120832
    s_nop 0
    buffer_load_dwordx4 v9, s[44:47], s11 offen lds
    s_add_u32 s11, s8, 84992
    s_mov_b32 m0, 150528
    s_nop 0
    buffer_load_dwordx4 v9, s[44:47], s11 offen lds
k1pa_dw3:
    s_branch k4l0_done
k4l0_end:
    s_lshr_b32 s8, s2, 4
    s_add_u32 s44, s38, 0x2200000
    s_addc_u32 s45, s39, 0
    s_and_b32 s45, s45, 0xffff
    s_mov_b32 s46, 0x150000
    s_mov_b32 s47, 0x20000
    s_mul_i32 s8, s8, 86016
    v_lshlrev_b32 v9, 4, v1
    s_cmp_eq_u32 s3, 0
    s_cbranch_scc0 k1pb_dw0
    s_add_u32 s11, s8, 0
    s_mov_b32 m0, 65536
    s_nop 0
    buffer_load_dwordx4 v9, s[44:47], s11 offen lds
    s_add_u32 s11, s8, 29696
    s_mov_b32 m0, 95232
    s_nop 0
    buffer_load_dwordx4 v9, s[44:47], s11 offen lds
    s_add_u32 s11, s8, 59392
    s_mov_b32 m0, 124928
    s_nop 0
    buffer_load_dwordx4 v9, s[44:47], s11 offen lds
    s_add_u32 s11, s8, 4096
    s_mov_b32 m0, 69632
    s_nop 0
    buffer_load_dwordx4 v9, s[44:47], s11 offen lds
    s_add_u32 s11, s8, 33792
    s_mov_b32 m0, 99328
    s_nop 0
    buffer_load_dwordx4 v9, s[44:47], s11 offen lds
    s_add_u32 s11, s8, 63488
    s_mov_b32 m0, 129024
    s_nop 0
    buffer_load_dwordx4 v9, s[44:47], s11 offen lds
    s_add_u32 s11, s8, 8192
    s_mov_b32 m0, 73728
    s_nop 0
    buffer_load_dwordx4 v9, s[44:47], s11 offen lds
    s_add_u32 s11, s8, 37888
    s_mov_b32 m0, 103424
    s_nop 0
    buffer_load_dwordx4 v9, s[44:47], s11 offen lds
    s_add_u32 s11, s8, 67584
    s_mov_b32 m0, 133120
    s_nop 0
    buffer_load_dwordx4 v9, s[44:47], s11 offen lds
    s_add_u32 s11, s8, 12288
    s_mov_b32 m0, 77824
    s_nop 0
    buffer_load_dwordx4 v9, s[44:47], s11 offen lds
    s_add_u32 s11, s8, 41984
    s_mov_b32 m0, 107520
    s_nop 0
    buffer_load_dwordx4 v9, s[44:47], s11 offen lds
    s_add_u32 s11, s8, 71680
    s_mov_b32 m0, 137216
    s_nop 0
    buffer_load_dwordx4 v9, s[44:47], s11 offen lds
    s_add_u32 s11, s8, 16384
    s_mov_b32 m0, 81920
    s_nop 0
    buffer_load_dwordx4 v9, s[44:47], s11 offen lds
    s_add_u32 s11, s8, 46080
    s_mov_b32 m0, 111616
    s_nop 0
    buffer_load_dwordx4 v9, s[44:47], s11 offen lds
    s_add_u32 s11, s8, 75776
    s_mov_b32 m0, 141312
    s_nop 0
    buffer_load_dwordx4 v9, s[44:47], s11 offen lds
    s_add_u32 s11, s8, 20480
    s_mov_b32 m0, 86016
    s_nop 0
    buffer_load_dwordx4 v9, s[44:47], s11 offen lds
    s_add_u32 s11, s8, 50176
    s_mov_b32 m0, 115712
    s_nop 0
    buffer_load_dwordx4 v9, s[44:47], s11 offen lds
    s_add_u32 s11, s8, 79872
    s_mov_b32 m0, 145408
    s_nop 0
    buffer_load_dwordx4 v9, s[44:47], s11 offen lds
    s_add_u32 s11, s8, 24576
    s_mov_b32 m0, 90112
    s_nop 0
    buffer_load_dwordx4 v9, s[44:47], s11 offen lds
    s_add_u32 s11, s8, 54272
    s_mov_b32 m0, 119808
    s_nop 0
    buffer_load_dwordx4 v9, s[44:47], s11 offen lds
    s_add_u32 s11, s8, 83968
    s_mov_b32 m0, 149504
    s_nop 0
    buffer_load_dwordx4 v9, s[44:47], s11 offen lds
k1pb_dw0:
    s_cmp_eq_u32 s3, 1
    s_cbranch_scc0 k1pb_dw1
    s_add_u32 s11, s8, 28672
    s_mov_b32 m0, 94208
    s_nop 0
    buffer_load_dwordx4 v9, s[44:47], s11 offen lds
    s_add_u32 s11, s8, 58368
    s_mov_b32 m0, 123904
    s_nop 0
    buffer_load_dwordx4 v9, s[44:47], s11 offen lds
    s_add_u32 s11, s8, 3072
    s_mov_b32 m0, 68608
    s_nop 0
    buffer_load_dwordx4 v9, s[44:47], s11 offen lds
    s_add_u32 s11, s8, 32768
    s_mov_b32 m0, 98304
    s_nop 0
    buffer_load_dwordx4 v9, s[44:47], s11 offen lds
    s_add_u32 s11, s8, 62464
    s_mov_b32 m0, 128000
    s_nop 0
    buffer_load_dwordx4 v9, s[44:47], s11 offen lds
    s_add_u32 s11, s8, 7168
    s_mov_b32 m0, 72704
    s_nop 0
    buffer_load_dwordx4 v9, s[44:47], s11 offen lds
    s_add_u32 s11, s8, 36864
    s_mov_b32 m0, 102400
    s_nop 0
    buffer_load_dwordx4 v9, s[44:47], s11 offen lds
    s_add_u32 s11, s8, 66560
    s_mov_b32 m0, 132096
    s_nop 0
    buffer_load_dwordx4 v9, s[44:47], s11 offen lds
    s_add_u32 s11, s8, 11264
    s_mov_b32 m0, 76800
    s_nop 0
    buffer_load_dwordx4 v9, s[44:47], s11 offen lds
    s_add_u32 s11, s8, 40960
    s_mov_b32 m0, 106496
    s_nop 0
    buffer_load_dwordx4 v9, s[44:47], s11 offen lds
    s_add_u32 s11, s8, 70656
    s_mov_b32 m0, 136192
    s_nop 0
    buffer_load_dwordx4 v9, s[44:47], s11 offen lds
    s_add_u32 s11, s8, 15360
    s_mov_b32 m0, 80896
    s_nop 0
    buffer_load_dwordx4 v9, s[44:47], s11 offen lds
    s_add_u32 s11, s8, 45056
    s_mov_b32 m0, 110592
    s_nop 0
    buffer_load_dwordx4 v9, s[44:47], s11 offen lds
    s_add_u32 s11, s8, 74752
    s_mov_b32 m0, 140288
    s_nop 0
    buffer_load_dwordx4 v9, s[44:47], s11 offen lds
    s_add_u32 s11, s8, 19456
    s_mov_b32 m0, 84992
    s_nop 0
    buffer_load_dwordx4 v9, s[44:47], s11 offen lds
    s_add_u32 s11, s8, 49152
    s_mov_b32 m0, 114688
    s_nop 0
    buffer_load_dwordx4 v9, s[44:47], s11 offen lds
    s_add_u32 s11, s8, 78848
    s_mov_b32 m0, 144384
    s_nop 0
    buffer_load_dwordx4 v9, s[44:47], s11 offen lds
    s_add_u32 s11, s8, 23552
    s_mov_b32 m0, 89088
    s_nop 0
    buffer_load_dwordx4 v9, s[44:47], s11 offen lds
    s_add_u32 s11, s8, 53248
    s_mov_b32 m0, 118784
    s_nop 0
    buffer_load_dwordx4 v9, s[44:47], s11 offen lds
    s_add_u32 s11, s8, 82944
    s_mov_b32 m0, 148480
    s_nop 0
    buffer_load_dwordx4 v9, s[44:47], s11 offen lds
    s_add_u32 s11, s8, 27648
    s_mov_b32 m0, 93184
    s_nop 0
    buffer_load_dwordx4 v9, s[44:47], s11 offen lds
k1pb_dw1:
    s_cmp_eq_u32 s3, 2
    s_cbranch_scc0 k1pb_dw2
    s_add_u32 s11, s8, 57344
    s_mov_b32 m0, 122880
    s_nop 0
    buffer_load_dwordx4 v9, s[44:47], s11 offen lds
    s_add_u32 s11, s8, 2048
    s_mov_b32 m0, 67584
    s_nop 0
    buffer_load_dwordx4 v9, s[44:47], s11 offen lds
    s_add_u32 s11, s8, 31744
    s_mov_b32 m0, 97280
    s_nop 0
    buffer_load_dwordx4 v9, s[44:47], s11 offen lds
    s_add_u32 s11, s8, 61440
    s_mov_b32 m0, 126976
    s_nop 0
    buffer_load_dwordx4 v9, s[44:47], s11 offen lds
    s_add_u32 s11, s8, 6144
    s_mov_b32 m0, 71680
    s_nop 0
    buffer_load_dwordx4 v9, s[44:47], s11 offen lds
    s_add_u32 s11, s8, 35840
    s_mov_b32 m0, 101376
    s_nop 0
    buffer_load_dwordx4 v9, s[44:47], s11 offen lds
    s_add_u32 s11, s8, 65536
    s_mov_b32 m0, 131072
    s_nop 0
    buffer_load_dwordx4 v9, s[44:47], s11 offen lds
    s_add_u32 s11, s8, 10240
    s_mov_b32 m0, 75776
    s_nop 0
    buffer_load_dwordx4 v9, s[44:47], s11 offen lds
    s_add_u32 s11, s8, 39936
    s_mov_b32 m0, 105472
    s_nop 0
    buffer_load_dwordx4 v9, s[44:47], s11 offen lds
    s_add_u32 s11, s8, 69632
    s_mov_b32 m0, 135168
    s_nop 0
    buffer_load_dwordx4 v9, s[44:47], s11 offen lds
    s_add_u32 s11, s8, 14336
    s_mov_b32 m0, 79872
    s_nop 0
    buffer_load_dwordx4 v9, s[44:47], s11 offen lds
    s_add_u32 s11, s8, 44032
    s_mov_b32 m0, 109568
    s_nop 0
    buffer_load_dwordx4 v9, s[44:47], s11 offen lds
    s_add_u32 s11, s8, 73728
    s_mov_b32 m0, 139264
    s_nop 0
    buffer_load_dwordx4 v9, s[44:47], s11 offen lds
    s_add_u32 s11, s8, 18432
    s_mov_b32 m0, 83968
    s_nop 0
    buffer_load_dwordx4 v9, s[44:47], s11 offen lds
    s_add_u32 s11, s8, 48128
    s_mov_b32 m0, 113664
    s_nop 0
    buffer_load_dwordx4 v9, s[44:47], s11 offen lds
    s_add_u32 s11, s8, 77824
    s_mov_b32 m0, 143360
    s_nop 0
    buffer_load_dwordx4 v9, s[44:47], s11 offen lds
    s_add_u32 s11, s8, 22528
    s_mov_b32 m0, 88064
    s_nop 0
    buffer_load_dwordx4 v9, s[44:47], s11 offen lds
    s_add_u32 s11, s8, 52224
    s_mov_b32 m0, 117760
    s_nop 0
    buffer_load_dwordx4 v9, s[44:47], s11 offen lds
    s_add_u32 s11, s8, 81920
    s_mov_b32 m0, 147456
    s_nop 0
    buffer_load_dwordx4 v9, s[44:47], s11 offen lds
    s_add_u32 s11, s8, 26624
    s_mov_b32 m0, 92160
    s_nop 0
    buffer_load_dwordx4 v9, s[44:47], s11 offen lds
    s_add_u32 s11, s8, 56320
    s_mov_b32 m0, 121856
    s_nop 0
    buffer_load_dwordx4 v9, s[44:47], s11 offen lds
k1pb_dw2:
    s_cmp_eq_u32 s3, 3
    s_cbranch_scc0 k1pb_dw3
    s_add_u32 s11, s8, 1024
    s_mov_b32 m0, 66560
    s_nop 0
    buffer_load_dwordx4 v9, s[44:47], s11 offen lds
    s_add_u32 s11, s8, 30720
    s_mov_b32 m0, 96256
    s_nop 0
    buffer_load_dwordx4 v9, s[44:47], s11 offen lds
    s_add_u32 s11, s8, 60416
    s_mov_b32 m0, 125952
    s_nop 0
    buffer_load_dwordx4 v9, s[44:47], s11 offen lds
    s_add_u32 s11, s8, 5120
    s_mov_b32 m0, 70656
    s_nop 0
    buffer_load_dwordx4 v9, s[44:47], s11 offen lds
    s_add_u32 s11, s8, 34816
    s_mov_b32 m0, 100352
    s_nop 0
    buffer_load_dwordx4 v9, s[44:47], s11 offen lds
    s_add_u32 s11, s8, 64512
    s_mov_b32 m0, 130048
    s_nop 0
    buffer_load_dwordx4 v9, s[44:47], s11 offen lds
    s_add_u32 s11, s8, 9216
    s_mov_b32 m0, 74752
    s_nop 0
    buffer_load_dwordx4 v9, s[44:47], s11 offen lds
    s_add_u32 s11, s8, 38912
    s_mov_b32 m0, 104448
    s_nop 0
    buffer_load_dwordx4 v9, s[44:47], s11 offen lds
    s_add_u32 s11, s8, 68608
    s_mov_b32 m0, 134144
    s_nop 0
    buffer_load_dwordx4 v9, s[44:47], s11 offen lds
    s_add_u32 s11, s8, 13312
    s_mov_b32 m0, 78848
    s_nop 0
    buffer_load_dwordx4 v9, s[44:47], s11 offen lds
    s_add_u32 s11, s8, 43008
    s_mov_b32 m0, 108544
    s_nop 0
    buffer_load_dwordx4 v9, s[44:47], s11 offen lds
    s_add_u32 s11, s8, 72704
    s_mov_b32 m0, 138240
    s_nop 0
    buffer_load_dwordx4 v9, s[44:47], s11 offen lds
    s_add_u32 s11, s8, 17408
    s_mov_b32 m0, 82944
    s_nop 0
    buffer_load_dwordx4 v9, s[44:47], s11 offen lds
    s_add_u32 s11, s8, 47104
    s_mov_b32 m0, 112640
    s_nop 0
    buffer_load_dwordx4 v9, s[44:47], s11 offen lds
    s_add_u32 s11, s8, 76800
    s_mov_b32 m0, 142336
    s_nop 0
    buffer_load_dwordx4 v9, s[44:47], s11 offen lds
    s_add_u32 s11, s8, 21504
    s_mov_b32 m0, 87040
    s_nop 0
    buffer_load_dwordx4 v9, s[44:47], s11 offen lds
    s_add_u32 s11, s8, 51200
    s_mov_b32 m0, 116736
    s_nop 0
    buffer_load_dwordx4 v9, s[44:47], s11 offen lds
    s_add_u32 s11, s8, 80896
    s_mov_b32 m0, 146432
    s_nop 0
    buffer_load_dwordx4 v9, s[44:47], s11 offen lds
    s_add_u32 s11, s8, 25600
    s_mov_b32 m0, 91136
    s_nop 0
    buffer_load_dwordx4 v9, s[44:47], s11 offen lds
    s_add_u32 s11, s8, 55296
    s_mov_b32 m0, 120832
    s_nop 0
    buffer_load_dwordx4 v9, s[44:47], s11 offen lds
    s_add_u32 s11, s8, 84992
    s_mov_b32 m0, 150528
    s_nop 0
    buffer_load_dwordx4 v9, s[44:47], s11 offen lds
k1pb_dw3:
k4l0_done:
    s_and_b32 s4, s2, 7
    s_lshr_b32 s5, s2, 3
    s_lshl_b32 s4, s4, 1
    s_and_b32 s6, s5, 1
    s_add_u32 s4, s4, s6
    s_lshr_b32 s5, s5, 1
    s_add_u32 s40, s38, 0x600000
    s_addc_u32 s41, s39, 0
    s_and_b32 s41, s41, 0xffff
    s_mov_b32 s42, 0x1c0000
    s_mov_b32 s43, 0x20000
    s_add_u32 s44, s38, 0x2200000
    s_addc_u32 s45, s39, 0
    s_and_b32 s45, s45, 0xffff
    s_mov_b32 s46, 0x150000
    s_mov_b32 s47, 0x20000
    s_mov_b32 s48, s20
    s_mov_b32 s49, s21
    s_and_b32 s49, s49, 0xffff
    s_mov_b32 s50, 0x6200
    s_mov_b32 s51, 0x20000
    s_add_u32 s52, s38, 0xc00000
    s_addc_u32 s53, s39, 0
    s_and_b32 s53, s53, 0xffff
    s_mov_b32 s54, 0x400000
    s_mov_b32 s55, 0x20000
    s_add_u32 s56, s38, 0x1020000
    s_addc_u32 s57, s39, 0
    s_and_b32 s57, s57, 0xffff
    s_mov_b32 s58, 0x20000
    s_mov_b32 s59, 0x20000
    s_add_u32 s64, s38, 0x2900000
    s_addc_u32 s65, s39, 0
    s_and_b32 s65, s65, 0xffff
    s_mov_b32 s66, 0x4000
    s_mov_b32 s67, 0x20000
    v_lshlrev_b32 v9, 4, v1
    s_lshl_b32 s6, s4, 2
    s_add_u32 s6, s6, s3
    v_lshlrev_b32 v8, 1, v3
    v_mul_u32_u24 v7, 224, v4
    v_add_u32 v8, v8, v7
    s_mul_i32 s12, s5, 1568
    v_add_u32 v8, s12, v8
    v_mov_b32 v10, 0x40000000
    v_cmp_gt_u32 vcc, 28, v3
    s_nop 1
    v_cndmask_b32 v8, v10, v8, vcc
    v_cmp_eq_u32 vcc, 0, v4
    s_nop 1
    v_cndmask_b32 v7, v10, v8, vcc
    buffer_load_ushort v32, v8, s[48:51], 0 offen offset:0
    buffer_load_ushort v33, v8, s[48:51], 0 offen offset:56
    buffer_load_ushort v34, v8, s[48:51], 0 offen offset:112
    buffer_load_ushort v35, v8, s[48:51], 0 offen offset:168
    buffer_load_ushort v36, v8, s[48:51], 0 offen offset:448
    buffer_load_ushort v37, v8, s[48:51], 0 offen offset:504
    buffer_load_ushort v38, v8, s[48:51], 0 offen offset:560
    buffer_load_ushort v39, v8, s[48:51], 0 offen offset:616
    buffer_load_ushort v40, v8, s[48:51], 0 offen offset:896
    buffer_load_ushort v41, v8, s[48:51], 0 offen offset:952
    buffer_load_ushort v42, v8, s[48:51], 0 offen offset:1008
    buffer_load_ushort v43, v8, s[48:51], 0 offen offset:1064
    buffer_load_ushort v44, v7, s[48:51], 0 offen offset:1344
    buffer_load_ushort v45, v7, s[48:51], 0 offen offset:1400
    buffer_load_ushort v46, v7, s[48:51], 0 offen offset:1456
    buffer_load_ushort v47, v7, s[48:51], 0 offen offset:1512
    s_mul_i32 s12, s5, 384
    v_lshlrev_b32 v7, 4, v4
    buffer_load_dwordx4 v[240:243], v7, s[64:67], s12 offen offset:0
    buffer_load_dwordx4 v[244:247], v7, s[64:67], s12 offen offset:32
    buffer_load_dwordx4 v[248:251], v7, s[64:67], s12 offen offset:64
    buffer_load_dwordx4 v[252:255], v7, s[64:67], s12 offen offset:96
    buffer_load_dwordx4 v[16:19], v7, s[64:67], s12 offen offset:128
    buffer_load_dwordx4 v[20:23], v7, s[64:67], s12 offen offset:160
    buffer_load_dwordx4 v[24:27], v7, s[64:67], s12 offen offset:192
    buffer_load_dwordx4 v[28:31], v7, s[64:67], s12 offen offset:224
    v_lshlrev_b32 v7, 2, v3
    buffer_load_dword v56, v7, s[64:67], s12 offen offset:256
    s_mov_b32 s60, 0
    s_mov_b32 s61, -1
    v_add_u32 v10, 122880, v9
    v_add_u32 v11, 65536, v9
    s_lshl_b32 s14, s4, 7
    s_add_u32 s14, s14, 16384
    s_cmp_eq_u32 s3, 3
    s_cbranch_scc0 L_pdone_24
    s_mov_b64 exec, 0x3fff
    v_lshlrev_b32 v6, 2, v1
L_poll_23:
    buffer_load_dword v5, v6, s[72:75], s14 offen sc1
    s_waitcnt vmcnt(0)
    v_cmp_ne_u32 vcc, s98, v5
    s_cbranch_vccz L_pdone_24_x
    s_sleep 2
    s_branch L_poll_23
L_pdone_24_x:
    s_mov_b64 exec, -1
L_pdone_24:
    s_barrier
    s_mul_i32 s7, s6, 28672
    buffer_load_dwordx4 v[64:67], v9, s[40:43], s7 offen offset:0
    buffer_load_dwordx4 v[68:71], v9, s[40:43], s7 offen offset:1024
    buffer_load_dwordx4 v[72:75], v9, s[40:43], s7 offen offset:2048
    buffer_load_dwordx4 v[76:79], v9, s[40:43], s7 offen offset:3072
    s_add_u32 s7, s7, 4096
    buffer_load_dwordx4 v[80:83], v9, s[40:43], s7 offen offset:0
    buffer_load_dwordx4 v[84:87], v9, s[40:43], s7 offen offset:1024
    buffer_load_dwordx4 v[88:91], v9, s[40:43], s7 offen offset:2048
    buffer_load_dwordx4 v[92:95], v9, s[40:43], s7 offen offset:3072
    s_add_u32 s7, s7, 4096
    buffer_load_dwordx4 v[96:99], v9, s[40:43], s7 offen offset:0
    buffer_load_dwordx4 v[100:103], v9, s[40:43], s7 offen offset:1024
    buffer_load_dwordx4 v[104:107], v9, s[40:43], s7 offen offset:2048
    buffer_load_dwordx4 v[108:111], v9, s[40:43], s7 offen offset:3072
    s_add_u32 s7, s7, 4096
    buffer_load_dwordx4 v[112:115], v9, s[40:43], s7 offen offset:0
    buffer_load_dwordx4 v[116:119], v9, s[40:43], s7 offen offset:1024
    buffer_load_dwordx4 v[120:123], v9, s[40:43], s7 offen offset:2048
    buffer_load_dwordx4 v[124:127], v9, s[40:43], s7 offen offset:3072
    s_add_u32 s7, s7, 4096
    buffer_load_dwordx4 v[128:131], v9, s[40:43], s7 offen offset:0
    buffer_load_dwordx4 v[132:135], v9, s[40:43], s7 offen offset:1024
    buffer_load_dwordx4 v[136:139], v9, s[40:43], s7 offen offset:2048
    buffer_load_dwordx4 v[140:143], v9, s[40:43], s7 offen offset:3072
    s_add_u32 s7, s7, 4096
    buffer_load_dwordx4 v[144:147], v9, s[40:43], s7 offen offset:0
    buffer_load_dwordx4 v[148:151], v9, s[40:43], s7 offen offset:1024
    buffer_load_dwordx4 v[152:155], v9, s[40:43], s7 offen offset:2048
    buffer_load_dwordx4 v[156:159], v9, s[40:43], s7 offen offset:3072
    s_add_u32 s7, s7, 4096
    buffer_load_dwordx4 v[160:163], v9, s[40:43], s7 offen offset:0
    buffer_load_dwordx4 v[164:167], v9, s[40:43], s7 offen offset:1024
    buffer_load_dwordx4 v[168:171], v9, s[40:43], s7 offen offset:2048
    buffer_load_dwordx4 v[172:175], v9, s[40:43], s7 offen offset:3072
    s_mul_i32 s13, s3, 5120
    s_add_u32 s13, s13, 32768
    s_waitcnt vmcnt(28)
    v_lshl_or_b32 v48, v33, 16, v32
    v_lshl_or_b32 v49, v35, 16, v34
    v_lshl_or_b32 v50, v37, 16, v36
    v_lshl_or_b32 v51, v39, 16, v38
    v_lshl_or_b32 v52, v41, 16, v40
    v_lshl_or_b32 v53, v43, 16, v42
    v_lshl_or_b32 v54, v45, 16, v44
    v_lshl_or_b32 v55, v47, 16, v46
    v_mov_b32 v14, 0
    v_mov_b32 v15, 0
    s_barrier
    ds_read_b128 v[224:227], v11 offset:0
    ds_read_b128 v[228:231], v11 offset:28672
    ds_read_b128 v[232:235], v10 offset:0
    ds_read_b128 v[32:35], v11 offset:1024
    ds_read_b128 v[36:39], v11 offset:29696
    ds_read_b128 v[40:43], v10 offset:1024
    s_waitcnt vmcnt(27) lgkmcnt(3)
    v_mfma_f32_32x32x16_bf16 v[176:191], v[224:227], v[64:67], 0
    v_lshlrev_b32 v57, 16, v64
    v_and_b32 v58, 0xffff0000, v64
    v_add_f32 v14, v14, v57
    v_fmac_f32 v15, v57, v57
    v_add_f32 v14, v14, v58
    v_fmac_f32 v15, v58, v58
    v_lshlrev_b32 v57, 16, v65
    v_and_b32 v58, 0xffff0000, v65
    v_mfma_f32_32x32x16_bf16 v[192:207], v[228:231], v[64:67], 0
    v_add_f32 v14, v14, v57
    v_fmac_f32 v15, v57, v57
    v_add_f32 v14, v14, v58
    v_fmac_f32 v15, v58, v58
    v_lshlrev_b32 v57, 16, v66
    v_and_b32 v58, 0xffff0000, v66
    v_add_f32 v14, v14, v57
    v_fmac_f32 v15, v57, v57
    v_mfma_f32_32x32x16_bf16 v[208:223], v[64:67], v[232:235], 0
    v_add_f32 v14, v14, v58
    v_fmac_f32 v15, v58, v58
    v_lshlrev_b32 v57, 16, v67
    v_and_b32 v58, 0xffff0000, v67
    v_add_f32 v14, v14, v57
    v_fmac_f32 v15, v57, v57
    v_add_f32 v14, v14, v58
    v_fmac_f32 v15, v58, v58
    ds_read_b128 v[224:227], v11 offset:2048
    ds_read_b128 v[228:231], v11 offset:30720
    ds_read_b128 v[232:235], v10 offset:2048
    s_waitcnt vmcnt(26) lgkmcnt(3)
    v_mfma_f32_32x32x16_bf16 v[176:191], v[32:35], v[68:71], v[176:191]
    v_lshlrev_b32 v57, 16, v68
    v_and_b32 v58, 0xffff0000, v68
    v_add_f32 v14, v14, v57
    v_fmac_f32 v15, v57, v57
    v_add_f32 v14, v14, v58
    v_fmac_f32 v15, v58, v58
    v_lshlrev_b32 v57, 16, v69
    v_and_b32 v58, 0xffff0000, v69
    v_mfma_f32_32x32x16_bf16 v[192:207], v[36:39], v[68:71], v[192:207]
    v_add_f32 v14, v14, v57
    v_fmac_f32 v15, v57, v57
    v_add_f32 v14, v14, v58
    v_fmac_f32 v15, v58, v58
    v_lshlrev_b32 v57, 16, v70
    v_and_b32 v58, 0xffff0000, v70
    v_add_f32 v14, v14, v57
    v_fmac_f32 v15, v57, v57
    v_mfma_f32_32x32x16_bf16 v[208:223], v[68:71], v[40:43], v[208:223]
    v_add_f32 v14, v14, v58
    v_fmac_f32 v15, v58, v58
    v_lshlrev_b32 v57, 16, v71
    v_and_b32 v58, 0xffff0000, v71
    v_add_f32 v14, v14, v57
    v_fmac_f32 v15, v57, v57
    v_add_f32 v14, v14, v58
    v_fmac_f32 v15, v58, v58
    ds_read_b128 v[32:35], v11 offset:3072
    ds_read_b128 v[36:39], v11 offset:31744
    ds_read_b128 v[40:43], v10 offset:3072
    s_waitcnt vmcnt(25) lgkmcnt(3)
    v_mfma_f32_32x32x16_bf16 v[176:191], v[224:227], v[72:75], v[176:191]
    v_lshlrev_b32 v57, 16, v72
    v_and_b32 v58, 0xffff0000, v72
    v_add_f32 v14, v14, v57
    v_fmac_f32 v15, v57, v57
    v_add_f32 v14, v14, v58
    v_fmac_f32 v15, v58, v58
    v_lshlrev_b32 v57, 16, v73
    v_and_b32 v58, 0xffff0000, v73
    v_mfma_f32_32x32x16_bf16 v[192:207], v[228:231], v[72:75], v[192:207]
    v_add_f32 v14, v14, v57
    v_fmac_f32 v15, v57, v57
    v_add_f32 v14, v14, v58
    v_fmac_f32 v15, v58, v58
    v_lshlrev_b32 v57, 16, v74
    v_and_b32 v58, 0xffff0000, v74
    v_add_f32 v14, v14, v57
    v_fmac_f32 v15, v57, v57
    v_mfma_f32_32x32x16_bf16 v[208:223], v[72:75], v[232:235], v[208:223]
    v_add_f32 v14, v14, v58
    v_fmac_f32 v15, v58, v58
    v_lshlrev_b32 v57, 16, v75
    v_and_b32 v58, 0xffff0000, v75
    v_add_f32 v14, v14, v57
    v_fmac_f32 v15, v57, v57
    v_add_f32 v14, v14, v58
    v_fmac_f32 v15, v58, v58
    ds_read_b128 v[224:227], v11 offset:4096
    ds_read_b128 v[228:231], v11 offset:32768
    ds_read_b128 v[232:235], v10 offset:4096
    s_waitcnt vmcnt(24) lgkmcnt(3)
    v_mfma_f32_32x32x16_bf16 v[176:191], v[32:35], v[76:79], v[176:191]
    v_lshlrev_b32 v57, 16, v76
    v_and_b32 v58, 0xffff0000, v76
    v_add_f32 v14, v14, v57
    v_fmac_f32 v15, v57, v57
    v_add_f32 v14, v14, v58
    v_fmac_f32 v15, v58, v58
    v_lshlrev_b32 v57, 16, v77
    v_and_b32 v58, 0xffff0000, v77
    v_mfma_f32_32x32x16_bf16 v[192:207], v[36:39], v[76:79], v[192:207]
    v_add_f32 v14, v14, v57
    v_fmac_f32 v15, v57, v57
    v_add_f32 v14, v14, v58
    v_fmac_f32 v15, v58, v58
    v_lshlrev_b32 v57, 16, v78
    v_and_b32 v58, 0xffff0000, v78
    v_add_f32 v14, v14, v57
    v_fmac_f32 v15, v57, v57
    v_mfma_f32_32x32x16_bf16 v[208:223], v[76:79], v[40:43], v[208:223]
    v_add_f32 v14, v14, v58
    v_fmac_f32 v15, v58, v58
    v_lshlrev_b32 v57, 16, v79
    v_and_b32 v58, 0xffff0000, v79
    v_add_f32 v14, v14, v57
    v_fmac_f32 v15, v57, v57
    v_add_f32 v14, v14, v58
    v_fmac_f32 v15, v58, v58
    ds_read_b128 v[32:35], v11 offset:5120
    ds_read_b128 v[36:39], v11 offset:33792
    ds_read_b128 v[40:43], v10 offset:5120
    s_waitcnt vmcnt(23) lgkmcnt(3)
    v_mfma_f32_32x32x16_bf16 v[176:191], v[224:227], v[80:83], v[176:191]
    v_lshlrev_b32 v57, 16, v80
    v_and_b32 v58, 0xffff0000, v80
    v_add_f32 v14, v14, v57
    v_fmac_f32 v15, v57, v57
    v_add_f32 v14, v14, v58
    v_fmac_f32 v15, v58, v58
    v_lshlrev_b32 v57, 16, v81
    v_and_b32 v58, 0xffff0000, v81
    v_mfma_f32_32x32x16_bf16 v[192:207], v[228:231], v[80:83], v[192:207]
    v_add_f32 v14, v14, v57
    v_fmac_f32 v15, v57, v57
    v_add_f32 v14, v14, v58
    v_fmac_f32 v15, v58, v58
    v_lshlrev_b32 v57, 16, v82
    v_and_b32 v58, 0xffff0000, v82
    v_add_f32 v14, v14, v57
    v_fmac_f32 v15, v57, v57
    v_mfma_f32_32x32x16_bf16 v[208:223], v[80:83], v[232:235], v[208:223]
    v_add_f32 v14, v14, v58
    v_fmac_f32 v15, v58, v58
    v_lshlrev_b32 v57, 16, v83
    v_and_b32 v58, 0xffff0000, v83
    v_add_f32 v14, v14, v57
    v_fmac_f32 v15, v57, v57
    v_add_f32 v14, v14, v58
    v_fmac_f32 v15, v58, v58
    ds_read_b128 v[224:227], v11 offset:6144
    ds_read_b128 v[228:231], v11 offset:34816
    ds_read_b128 v[232:235], v10 offset:6144
    s_waitcnt vmcnt(22) lgkmcnt(3)
    v_mfma_f32_32x32x16_bf16 v[176:191], v[32:35], v[84:87], v[176:191]
    v_lshlrev_b32 v57, 16, v84
    v_and_b32 v58, 0xffff0000, v84
    v_add_f32 v14, v14, v57
    v_fmac_f32 v15, v57, v57
    v_add_f32 v14, v14, v58
    v_fmac_f32 v15, v58, v58
    v_lshlrev_b32 v57, 16, v85
    v_and_b32 v58, 0xffff0000, v85
    v_mfma_f32_32x32x16_bf16 v[192:207], v[36:39], v[84:87], v[192:207]
    v_add_f32 v14, v14, v57
    v_fmac_f32 v15, v57, v57
    v_add_f32 v14, v14, v58
    v_fmac_f32 v15, v58, v58
    v_lshlrev_b32 v57, 16, v86
    v_and_b32 v58, 0xffff0000, v86
    v_add_f32 v14, v14, v57
    v_fmac_f32 v15, v57, v57
    v_mfma_f32_32x32x16_bf16 v[208:223], v[84:87], v[40:43], v[208:223]
    v_add_f32 v14, v14, v58
    v_fmac_f32 v15, v58, v58
    v_lshlrev_b32 v57, 16, v87
    v_and_b32 v58, 0xffff0000, v87
    v_add_f32 v14, v14, v57
    v_fmac_f32 v15, v57, v57
    v_add_f32 v14, v14, v58
    v_fmac_f32 v15, v58, v58
    ds_read_b128 v[32:35], v11 offset:7168
    ds_read_b128 v[36:39], v11 offset:35840
    ds_read_b128 v[40:43], v10 offset:7168
    s_waitcnt vmcnt(21) lgkmcnt(3)
    v_mfma_f32_32x32x16_bf16 v[176:191], v[224:227], v[88:91], v[176:191]
    v_lshlrev_b32 v57, 16, v88
    v_and_b32 v58, 0xffff0000, v88
    v_add_f32 v14, v14, v57
    v_fmac_f32 v15, v57, v57
    v_add_f32 v14, v14, v58
    v_fmac_f32 v15, v58, v58
    v_lshlrev_b32 v57, 16, v89
    v_and_b32 v58, 0xffff0000, v89
    v_mfma_f32_32x32x16_bf16 v[192:207], v[228:231], v[88:91], v[192:207]
    v_add_f32 v14, v14, v57
    v_fmac_f32 v15, v57, v57
    v_add_f32 v14, v14, v58
    v_fmac_f32 v15, v58, v58
    v_lshlrev_b32 v57, 16, v90
    v_and_b32 v58, 0xffff0000, v90
    v_add_f32 v14, v14, v57
    v_fmac_f32 v15, v57, v57
    v_mfma_f32_32x32x16_bf16 v[208:223], v[88:91], v[232:235], v[208:223]
    v_add_f32 v14, v14, v58
    v_fmac_f32 v15, v58, v58
    v_lshlrev_b32 v57, 16, v91
    v_and_b32 v58, 0xffff0000, v91
    v_add_f32 v14, v14, v57
    v_fmac_f32 v15, v57, v57
    v_add_f32 v14, v14, v58
    v_fmac_f32 v15, v58, v58
    ds_read_b128 v[224:227], v11 offset:8192
    ds_read_b128 v[228:231], v11 offset:36864
    ds_read_b128 v[232:235], v10 offset:8192
    s_waitcnt vmcnt(20) lgkmcnt(3)
    v_mfma_f32_32x32x16_bf16 v[176:191], v[32:35], v[92:95], v[176:191]
    v_lshlrev_b32 v57, 16, v92
    v_and_b32 v58, 0xffff0000, v92
    v_add_f32 v14, v14, v57
    v_fmac_f32 v15, v57, v57
    v_add_f32 v14, v14, v58
    v_fmac_f32 v15, v58, v58
    v_lshlrev_b32 v57, 16, v93
    v_and_b32 v58, 0xffff0000, v93
    v_mfma_f32_32x32x16_bf16 v[192:207], v[36:39], v[92:95], v[192:207]
    v_add_f32 v14, v14, v57
    v_fmac_f32 v15, v57, v57
    v_add_f32 v14, v14, v58
    v_fmac_f32 v15, v58, v58
    v_lshlrev_b32 v57, 16, v94
    v_and_b32 v58, 0xffff0000, v94
    v_add_f32 v14, v14, v57
    v_fmac_f32 v15, v57, v57
    v_mfma_f32_32x32x16_bf16 v[208:223], v[92:95], v[40:43], v[208:223]
    v_add_f32 v14, v14, v58
    v_fmac_f32 v15, v58, v58
    v_lshlrev_b32 v57, 16, v95
    v_and_b32 v58, 0xffff0000, v95
    v_add_f32 v14, v14, v57
    v_fmac_f32 v15, v57, v57
    v_add_f32 v14, v14, v58
    v_fmac_f32 v15, v58, v58
    ds_read_b128 v[32:35], v11 offset:9216
    ds_read_b128 v[36:39], v11 offset:37888
    ds_read_b128 v[40:43], v10 offset:9216
    s_waitcnt vmcnt(19) lgkmcnt(3)
    v_mfma_f32_32x32x16_bf16 v[176:191], v[224:227], v[96:99], v[176:191]
    v_lshlrev_b32 v57, 16, v96
    v_and_b32 v58, 0xffff0000, v96
    v_add_f32 v14, v14, v57
    v_fmac_f32 v15, v57, v57
    v_add_f32 v14, v14, v58
    v_fmac_f32 v15, v58, v58
    v_lshlrev_b32 v57, 16, v97
    v_and_b32 v58, 0xffff0000, v97
    v_mfma_f32_32x32x16_bf16 v[192:207], v[228:231], v[96:99], v[192:207]
    v_add_f32 v14, v14, v57
    v_fmac_f32 v15, v57, v57
    v_add_f32 v14, v14, v58
    v_fmac_f32 v15, v58, v58
    v_lshlrev_b32 v57, 16, v98
    v_and_b32 v58, 0xffff0000, v98
    v_add_f32 v14, v14, v57
    v_fmac_f32 v15, v57, v57
    v_mfma_f32_32x32x16_bf16 v[208:223], v[96:99], v[232:235], v[208:223]
    v_add_f32 v14, v14, v58
    v_fmac_f32 v15, v58, v58
    v_lshlrev_b32 v57, 16, v99
    v_and_b32 v58, 0xffff0000, v99
    v_add_f32 v14, v14, v57
    v_fmac_f32 v15, v57, v57
    v_add_f32 v14, v14, v58
    v_fmac_f32 v15, v58, v58
    ds_read_b128 v[224:227], v11 offset:10240
    ds_read_b128 v[228:231], v11 offset:38912
    ds_read_b128 v[232:235], v10 offset:10240
    s_waitcnt vmcnt(18) lgkmcnt(3)
    v_mfma_f32_32x32x16_bf16 v[176:191], v[32:35], v[100:103], v[176:191]
    v_lshlrev_b32 v57, 16, v100
    v_and_b32 v58, 0xffff0000, v100
    v_add_f32 v14, v14, v57
    v_fmac_f32 v15, v57, v57
    v_add_f32 v14, v14, v58
    v_fmac_f32 v15, v58, v58
    v_lshlrev_b32 v57, 16, v101
    v_and_b32 v58, 0xffff0000, v101
    v_mfma_f32_32x32x16_bf16 v[192:207], v[36:39], v[100:103], v[192:207]
    v_add_f32 v14, v14, v57
    v_fmac_f32 v15, v57, v57
    v_add_f32 v14, v14, v58
    v_fmac_f32 v15, v58, v58
    v_lshlrev_b32 v57, 16, v102
    v_and_b32 v58, 0xffff0000, v102
    v_add_f32 v14, v14, v57
    v_fmac_f32 v15, v57, v57
    v_mfma_f32_32x32x16_bf16 v[208:223], v[100:103], v[40:43], v[208:223]
    v_add_f32 v14, v14, v58
    v_fmac_f32 v15, v58, v58
    v_lshlrev_b32 v57, 16, v103
    v_and_b32 v58, 0xffff0000, v103
    v_add_f32 v14, v14, v57
    v_fmac_f32 v15, v57, v57
    v_add_f32 v14, v14, v58
    v_fmac_f32 v15, v58, v58
    ds_read_b128 v[32:35], v11 offset:11264
    ds_read_b128 v[36:39], v11 offset:39936
    ds_read_b128 v[40:43], v10 offset:11264
    s_waitcnt vmcnt(17) lgkmcnt(3)
    v_mfma_f32_32x32x16_bf16 v[176:191], v[224:227], v[104:107], v[176:191]
    v_lshlrev_b32 v57, 16, v104
    v_and_b32 v58, 0xffff0000, v104
    v_add_f32 v14, v14, v57
    v_fmac_f32 v15, v57, v57
    v_add_f32 v14, v14, v58
    v_fmac_f32 v15, v58, v58
    v_lshlrev_b32 v57, 16, v105
    v_and_b32 v58, 0xffff0000, v105
    v_mfma_f32_32x32x16_bf16 v[192:207], v[228:231], v[104:107], v[192:207]
    v_add_f32 v14, v14, v57
    v_fmac_f32 v15, v57, v57
    v_add_f32 v14, v14, v58
    v_fmac_f32 v15, v58, v58
    v_lshlrev_b32 v57, 16, v106
    v_and_b32 v58, 0xffff0000, v106
    v_add_f32 v14, v14, v57
    v_fmac_f32 v15, v57, v57
    v_mfma_f32_32x32x16_bf16 v[208:223], v[104:107], v[232:235], v[208:223]
    v_add_f32 v14, v14, v58
    v_fmac_f32 v15, v58, v58
    v_lshlrev_b32 v57, 16, v107
    v_and_b32 v58, 0xffff0000, v107
    v_add_f32 v14, v14, v57
    v_fmac_f32 v15, v57, v57
    v_add_f32 v14, v14, v58
    v_fmac_f32 v15, v58, v58
    ds_read_b128 v[224:227], v11 offset:12288
    ds_read_b128 v[228:231], v11 offset:40960
    ds_read_b128 v[232:235], v10 offset:12288
    s_waitcnt vmcnt(16) lgkmcnt(3)
    v_mfma_f32_32x32x16_bf16 v[176:191], v[32:35], v[108:111], v[176:191]
    v_lshlrev_b32 v57, 16, v108
    v_and_b32 v58, 0xffff0000, v108
    v_add_f32 v14, v14, v57
    v_fmac_f32 v15, v57, v57
    v_add_f32 v14, v14, v58
    v_fmac_f32 v15, v58, v58
    v_lshlrev_b32 v57, 16, v109
    v_and_b32 v58, 0xffff0000, v109
    v_mfma_f32_32x32x16_bf16 v[192:207], v[36:39], v[108:111], v[192:207]
    v_add_f32 v14, v14, v57
    v_fmac_f32 v15, v57, v57
    v_add_f32 v14, v14, v58
    v_fmac_f32 v15, v58, v58
    v_lshlrev_b32 v57, 16, v110
    v_and_b32 v58, 0xffff0000, v110
    v_add_f32 v14, v14, v57
    v_fmac_f32 v15, v57, v57
    v_mfma_f32_32x32x16_bf16 v[208:223], v[108:111], v[40:43], v[208:223]
    v_add_f32 v14, v14, v58
    v_fmac_f32 v15, v58, v58
    v_lshlrev_b32 v57, 16, v111
    v_and_b32 v58, 0xffff0000, v111
    v_add_f32 v14, v14, v57
    v_fmac_f32 v15, v57, v57
    v_add_f32 v14, v14, v58
    v_fmac_f32 v15, v58, v58
    ds_read_b128 v[32:35], v11 offset:13312
    ds_read_b128 v[36:39], v11 offset:41984
    ds_read_b128 v[40:43], v10 offset:13312
    s_waitcnt vmcnt(15) lgkmcnt(3)
    v_mfma_f32_32x32x16_bf16 v[176:191], v[224:227], v[112:115], v[176:191]
    v_lshlrev_b32 v57, 16, v112
    v_and_b32 v58, 0xffff0000, v112
    v_add_f32 v14, v14, v57
    v_fmac_f32 v15, v57, v57
    v_add_f32 v14, v14, v58
    v_fmac_f32 v15, v58, v58
    v_lshlrev_b32 v57, 16, v113
    v_and_b32 v58, 0xffff0000, v113
    v_mfma_f32_32x32x16_bf16 v[192:207], v[228:231], v[112:115], v[192:207]
    v_add_f32 v14, v14, v57
    v_fmac_f32 v15, v57, v57
    v_add_f32 v14, v14, v58
    v_fmac_f32 v15, v58, v58
    v_lshlrev_b32 v57, 16, v114
    v_and_b32 v58, 0xffff0000, v114
    v_add_f32 v14, v14, v57
    v_fmac_f32 v15, v57, v57
    v_mfma_f32_32x32x16_bf16 v[208:223], v[112:115], v[232:235], v[208:223]
    v_add_f32 v14, v14, v58
    v_fmac_f32 v15, v58, v58
    v_lshlrev_b32 v57, 16, v115
    v_and_b32 v58, 0xffff0000, v115
    v_add_f32 v14, v14, v57
    v_fmac_f32 v15, v57, v57
    v_add_f32 v14, v14, v58
    v_fmac_f32 v15, v58, v58
    ds_read_b128 v[224:227], v11 offset:14336
    ds_read_b128 v[228:231], v11 offset:43008
    ds_read_b128 v[232:235], v10 offset:14336
    s_waitcnt vmcnt(14) lgkmcnt(3)
    v_mfma_f32_32x32x16_bf16 v[176:191], v[32:35], v[116:119], v[176:191]
    v_lshlrev_b32 v57, 16, v116
    v_and_b32 v58, 0xffff0000, v116
    v_add_f32 v14, v14, v57
    v_fmac_f32 v15, v57, v57
    v_add_f32 v14, v14, v58
    v_fmac_f32 v15, v58, v58
    v_lshlrev_b32 v57, 16, v117
    v_and_b32 v58, 0xffff0000, v117
    v_mfma_f32_32x32x16_bf16 v[192:207], v[36:39], v[116:119], v[192:207]
    v_add_f32 v14, v14, v57
    v_fmac_f32 v15, v57, v57
    v_add_f32 v14, v14, v58
    v_fmac_f32 v15, v58, v58
    v_lshlrev_b32 v57, 16, v118
    v_and_b32 v58, 0xffff0000, v118
    v_add_f32 v14, v14, v57
    v_fmac_f32 v15, v57, v57
    v_mfma_f32_32x32x16_bf16 v[208:223], v[116:119], v[40:43], v[208:223]
    v_add_f32 v14, v14, v58
    v_fmac_f32 v15, v58, v58
    v_lshlrev_b32 v57, 16, v119
    v_and_b32 v58, 0xffff0000, v119
    v_add_f32 v14, v14, v57
    v_fmac_f32 v15, v57, v57
    v_add_f32 v14, v14, v58
    v_fmac_f32 v15, v58, v58
    ds_read_b128 v[32:35], v11 offset:15360
    ds_read_b128 v[36:39], v11 offset:44032
    ds_read_b128 v[40:43], v10 offset:15360
    s_waitcnt vmcnt(13) lgkmcnt(3)
    v_mfma_f32_32x32x16_bf16 v[176:191], v[224:227], v[120:123], v[176:191]
    v_lshlrev_b32 v57, 16, v120
    v_and_b32 v58, 0xffff0000, v120
    v_add_f32 v14, v14, v57
    v_fmac_f32 v15, v57, v57
    v_add_f32 v14, v14, v58
    v_fmac_f32 v15, v58, v58
    v_lshlrev_b32 v57, 16, v121
    v_and_b32 v58, 0xffff0000, v121
    v_mfma_f32_32x32x16_bf16 v[192:207], v[228:231], v[120:123], v[192:207]
    v_add_f32 v14, v14, v57
    v_fmac_f32 v15, v57, v57
    v_add_f32 v14, v14, v58
    v_fmac_f32 v15, v58, v58
    v_lshlrev_b32 v57, 16, v122
    v_and_b32 v58, 0xffff0000, v122
    v_add_f32 v14, v14, v57
    v_fmac_f32 v15, v57, v57
    v_mfma_f32_32x32x16_bf16 v[208:223], v[120:123], v[232:235], v[208:223]
    v_add_f32 v14, v14, v58
    v_fmac_f32 v15, v58, v58
    v_lshlrev_b32 v57, 16, v123
    v_and_b32 v58, 0xffff0000, v123
    v_add_f32 v14, v14, v57
    v_fmac_f32 v15, v57, v57
    v_add_f32 v14, v14, v58
    v_fmac_f32 v15, v58, v58
    ds_read_b128 v[224:227], v11 offset:16384
    ds_read_b128 v[228:231], v11 offset:45056
    ds_read_b128 v[232:235], v10 offset:16384
    s_waitcnt vmcnt(12) lgkmcnt(3)
    v_mfma_f32_32x32x16_bf16 v[176:191], v[32:35], v[124:127], v[176:191]
    v_lshlrev_b32 v57, 16, v124
    v_and_b32 v58, 0xffff0000, v124
    v_add_f32 v14, v14, v57
    v_fmac_f32 v15, v57, v57
    v_add_f32 v14, v14, v58
    v_fmac_f32 v15, v58, v58
    v_lshlrev_b32 v57, 16, v125
    v_and_b32 v58, 0xffff0000, v125
    v_mfma_f32_32x32x16_bf16 v[192:207], v[36:39], v[124:127], v[192:207]
    v_add_f32 v14, v14, v57
    v_fmac_f32 v15, v57, v57
    v_add_f32 v14, v14, v58
    v_fmac_f32 v15, v58, v58
    v_lshlrev_b32 v57, 16, v126
    v_and_b32 v58, 0xffff0000, v126
    v_add_f32 v14, v14, v57
    v_fmac_f32 v15, v57, v57
    v_mfma_f32_32x32x16_bf16 v[208:223], v[124:127], v[40:43], v[208:223]
    v_add_f32 v14, v14, v58
    v_fmac_f32 v15, v58, v58
    v_lshlrev_b32 v57, 16, v127
    v_and_b32 v58, 0xffff0000, v127
    v_add_f32 v14, v14, v57
    v_fmac_f32 v15, v57, v57
    v_add_f32 v14, v14, v58
    v_fmac_f32 v15, v58, v58
    ds_read_b128 v[32:35], v11 offset:17408
    ds_read_b128 v[36:39], v11 offset:46080
    ds_read_b128 v[40:43], v10 offset:17408
    s_waitcnt vmcnt(11) lgkmcnt(3)
    v_mfma_f32_32x32x16_bf16 v[176:191], v[224:227], v[128:131], v[176:191]
    v_lshlrev_b32 v57, 16, v128
    v_and_b32 v58, 0xffff0000, v128
    v_add_f32 v14, v14, v57
    v_fmac_f32 v15, v57, v57
    v_add_f32 v14, v14, v58
    v_fmac_f32 v15, v58, v58
    v_lshlrev_b32 v57, 16, v129
    v_and_b32 v58, 0xffff0000, v129
    v_mfma_f32_32x32x16_bf16 v[192:207], v[228:231], v[128:131], v[192:207]
    v_add_f32 v14, v14, v57
    v_fmac_f32 v15, v57, v57
    v_add_f32 v14, v14, v58
    v_fmac_f32 v15, v58, v58
    v_lshlrev_b32 v57, 16, v130
    v_and_b32 v58, 0xffff0000, v130
    v_add_f32 v14, v14, v57
    v_fmac_f32 v15, v57, v57
    v_mfma_f32_32x32x16_bf16 v[208:223], v[128:131], v[232:235], v[208:223]
    v_add_f32 v14, v14, v58
    v_fmac_f32 v15, v58, v58
    v_lshlrev_b32 v57, 16, v131
    v_and_b32 v58, 0xffff0000, v131
    v_add_f32 v14, v14, v57
    v_fmac_f32 v15, v57, v57
    v_add_f32 v14, v14, v58
    v_fmac_f32 v15, v58, v58
    ds_read_b128 v[224:227], v11 offset:18432
    ds_read_b128 v[228:231], v11 offset:47104
    ds_read_b128 v[232:235], v10 offset:18432
    s_waitcnt vmcnt(10) lgkmcnt(3)
    v_mfma_f32_32x32x16_bf16 v[176:191], v[32:35], v[132:135], v[176:191]
    v_lshlrev_b32 v57, 16, v132
    v_and_b32 v58, 0xffff0000, v132
    v_add_f32 v14, v14, v57
    v_fmac_f32 v15, v57, v57
    v_add_f32 v14, v14, v58
    v_fmac_f32 v15, v58, v58
    v_lshlrev_b32 v57, 16, v133
    v_and_b32 v58, 0xffff0000, v133
    v_mfma_f32_32x32x16_bf16 v[192:207], v[36:39], v[132:135], v[192:207]
    v_add_f32 v14, v14, v57
    v_fmac_f32 v15, v57, v57
    v_add_f32 v14, v14, v58
    v_fmac_f32 v15, v58, v58
    v_lshlrev_b32 v57, 16, v134
    v_and_b32 v58, 0xffff0000, v134
    v_add_f32 v14, v14, v57
    v_fmac_f32 v15, v57, v57
    v_mfma_f32_32x32x16_bf16 v[208:223], v[132:135], v[40:43], v[208:223]
    v_add_f32 v14, v14, v58
    v_fmac_f32 v15, v58, v58
    v_lshlrev_b32 v57, 16, v135
    v_and_b32 v58, 0xffff0000, v135
    v_add_f32 v14, v14, v57
    v_fmac_f32 v15, v57, v57
    v_add_f32 v14, v14, v58
    v_fmac_f32 v15, v58, v58
    ds_read_b128 v[32:35], v11 offset:19456
    ds_read_b128 v[36:39], v11 offset:48128
    ds_read_b128 v[40:43], v10 offset:19456
    s_waitcnt vmcnt(9) lgkmcnt(3)
    v_mfma_f32_32x32x16_bf16 v[176:191], v[224:227], v[136:139], v[176:191]
    v_lshlrev_b32 v57, 16, v136
    v_and_b32 v58, 0xffff0000, v136
    v_add_f32 v14, v14, v57
    v_fmac_f32 v15, v57, v57
    v_add_f32 v14, v14, v58
    v_fmac_f32 v15, v58, v58
    v_lshlrev_b32 v57, 16, v137
    v_and_b32 v58, 0xffff0000, v137
    v_mfma_f32_32x32x16_bf16 v[192:207], v[228:231], v[136:139], v[192:207]
    v_add_f32 v14, v14, v57
    v_fmac_f32 v15, v57, v57
    v_add_f32 v14, v14, v58
    v_fmac_f32 v15, v58, v58
    v_lshlrev_b32 v57, 16, v138
    v_and_b32 v58, 0xffff0000, v138
    v_add_f32 v14, v14, v57
    v_fmac_f32 v15, v57, v57
    v_mfma_f32_32x32x16_bf16 v[208:223], v[136:139], v[232:235], v[208:223]
    v_add_f32 v14, v14, v58
    v_fmac_f32 v15, v58, v58
    v_lshlrev_b32 v57, 16, v139
    v_and_b32 v58, 0xffff0000, v139
    v_add_f32 v14, v14, v57
    v_fmac_f32 v15, v57, v57
    v_add_f32 v14, v14, v58
    v_fmac_f32 v15, v58, v58
    ds_read_b128 v[224:227], v11 offset:20480
    ds_read_b128 v[228:231], v11 offset:49152
    ds_read_b128 v[232:235], v10 offset:20480
    s_waitcnt vmcnt(8) lgkmcnt(3)
    v_mfma_f32_32x32x16_bf16 v[176:191], v[32:35], v[140:143], v[176:191]
    v_lshlrev_b32 v57, 16, v140
    v_and_b32 v58, 0xffff0000, v140
    v_add_f32 v14, v14, v57
    v_fmac_f32 v15, v57, v57
    v_add_f32 v14, v14, v58
    v_fmac_f32 v15, v58, v58
    v_lshlrev_b32 v57, 16, v141
    v_and_b32 v58, 0xffff0000, v141
    v_mfma_f32_32x32x16_bf16 v[192:207], v[36:39], v[140:143], v[192:207]
    v_add_f32 v14, v14, v57
    v_fmac_f32 v15, v57, v57
    v_add_f32 v14, v14, v58
    v_fmac_f32 v15, v58, v58
    v_lshlrev_b32 v57, 16, v142
    v_and_b32 v58, 0xffff0000, v142
    v_add_f32 v14, v14, v57
    v_fmac_f32 v15, v57, v57
    v_mfma_f32_32x32x16_bf16 v[208:223], v[140:143], v[40:43], v[208:223]
    v_add_f32 v14, v14, v58
    v_fmac_f32 v15, v58, v58
    v_lshlrev_b32 v57, 16, v143
    v_and_b32 v58, 0xffff0000, v143
    v_add_f32 v14, v14, v57
    v_fmac_f32 v15, v57, v57
    v_add_f32 v14, v14, v58
    v_fmac_f32 v15, v58, v58
    ds_read_b128 v[32:35], v11 offset:21504
    ds_read_b128 v[36:39], v11 offset:50176
    ds_read_b128 v[40:43], v10 offset:21504
    s_waitcnt vmcnt(7) lgkmcnt(3)
    v_mfma_f32_32x32x16_bf16 v[176:191], v[224:227], v[144:147], v[176:191]
    v_lshlrev_b32 v57, 16, v144
    v_and_b32 v58, 0xffff0000, v144
    v_add_f32 v14, v14, v57
    v_fmac_f32 v15, v57, v57
    v_add_f32 v14, v14, v58
    v_fmac_f32 v15, v58, v58
    v_lshlrev_b32 v57, 16, v145
    v_and_b32 v58, 0xffff0000, v145
    v_mfma_f32_32x32x16_bf16 v[192:207], v[228:231], v[144:147], v[192:207]
    v_add_f32 v14, v14, v57
    v_fmac_f32 v15, v57, v57
    v_add_f32 v14, v14, v58
    v_fmac_f32 v15, v58, v58
    v_lshlrev_b32 v57, 16, v146
    v_and_b32 v58, 0xffff0000, v146
    v_add_f32 v14, v14, v57
    v_fmac_f32 v15, v57, v57
    v_mfma_f32_32x32x16_bf16 v[208:223], v[144:147], v[232:235], v[208:223]
    v_add_f32 v14, v14, v58
    v_fmac_f32 v15, v58, v58
    v_lshlrev_b32 v57, 16, v147
    v_and_b32 v58, 0xffff0000, v147
    v_add_f32 v14, v14, v57
    v_fmac_f32 v15, v57, v57
    v_add_f32 v14, v14, v58
    v_fmac_f32 v15, v58, v58
    ds_read_b128 v[224:227], v11 offset:22528
    ds_read_b128 v[228:231], v11 offset:51200
    ds_read_b128 v[232:235], v10 offset:22528
    s_waitcnt vmcnt(6) lgkmcnt(3)
    v_mfma_f32_32x32x16_bf16 v[176:191], v[32:35], v[148:151], v[176:191]
    v_lshlrev_b32 v57, 16, v148
    v_and_b32 v58, 0xffff0000, v148
    v_add_f32 v14, v14, v57
    v_fmac_f32 v15, v57, v57
    v_add_f32 v14, v14, v58
    v_fmac_f32 v15, v58, v58
    v_lshlrev_b32 v57, 16, v149
    v_and_b32 v58, 0xffff0000, v149
    v_mfma_f32_32x32x16_bf16 v[192:207], v[36:39], v[148:151], v[192:207]
    v_add_f32 v14, v14, v57
    v_fmac_f32 v15, v57, v57
    v_add_f32 v14, v14, v58
    v_fmac_f32 v15, v58, v58
    v_lshlrev_b32 v57, 16, v150
    v_and_b32 v58, 0xffff0000, v150
    v_add_f32 v14, v14, v57
    v_fmac_f32 v15, v57, v57
    v_mfma_f32_32x32x16_bf16 v[208:223], v[148:151], v[40:43], v[208:223]
    v_add_f32 v14, v14, v58
    v_fmac_f32 v15, v58, v58
    v_lshlrev_b32 v57, 16, v151
    v_and_b32 v58, 0xffff0000, v151
    v_add_f32 v14, v14, v57
    v_fmac_f32 v15, v57, v57
    v_add_f32 v14, v14, v58
    v_fmac_f32 v15, v58, v58
    ds_read_b128 v[32:35], v11 offset:23552
    ds_read_b128 v[36:39], v11 offset:52224
    ds_read_b128 v[40:43], v10 offset:23552
    s_waitcnt vmcnt(5) lgkmcnt(3)
    v_mfma_f32_32x32x16_bf16 v[176:191], v[224:227], v[152:155], v[176:191]
    v_lshlrev_b32 v57, 16, v152
    v_and_b32 v58, 0xffff0000, v152
    v_add_f32 v14, v14, v57
    v_fmac_f32 v15, v57, v57
    v_add_f32 v14, v14, v58
    v_fmac_f32 v15, v58, v58
    v_lshlrev_b32 v57, 16, v153
    v_and_b32 v58, 0xffff0000, v153
    v_mfma_f32_32x32x16_bf16 v[192:207], v[228:231], v[152:155], v[192:207]
    v_add_f32 v14, v14, v57
    v_fmac_f32 v15, v57, v57
    v_add_f32 v14, v14, v58
    v_fmac_f32 v15, v58, v58
    v_lshlrev_b32 v57, 16, v154
    v_and_b32 v58, 0xffff0000, v154
    v_add_f32 v14, v14, v57
    v_fmac_f32 v15, v57, v57
    v_mfma_f32_32x32x16_bf16 v[208:223], v[152:155], v[232:235], v[208:223]
    v_add_f32 v14, v14, v58
    v_fmac_f32 v15, v58, v58
    v_lshlrev_b32 v57, 16, v155
    v_and_b32 v58, 0xffff0000, v155
    v_add_f32 v14, v14, v57
    v_fmac_f32 v15, v57, v57
    v_add_f32 v14, v14, v58
    v_fmac_f32 v15, v58, v58
    ds_read_b128 v[224:227], v11 offset:24576
    ds_read_b128 v[228:231], v11 offset:53248
    ds_read_b128 v[232:235], v10 offset:24576
    s_waitcnt vmcnt(4) lgkmcnt(3)
    v_mfma_f32_32x32x16_bf16 v[176:191], v[32:35], v[156:159], v[176:191]
    v_lshlrev_b32 v57, 16, v156
    v_and_b32 v58, 0xffff0000, v156
    v_add_f32 v14, v14, v57
    v_fmac_f32 v15, v57, v57
    v_add_f32 v14, v14, v58
    v_fmac_f32 v15, v58, v58
    v_lshlrev_b32 v57, 16, v157
    v_and_b32 v58, 0xffff0000, v157
    v_mfma_f32_32x32x16_bf16 v[192:207], v[36:39], v[156:159], v[192:207]
    v_add_f32 v14, v14, v57
    v_fmac_f32 v15, v57, v57
    v_add_f32 v14, v14, v58
    v_fmac_f32 v15, v58, v58
    v_lshlrev_b32 v57, 16, v158
    v_and_b32 v58, 0xffff0000, v158
    v_add_f32 v14, v14, v57
    v_fmac_f32 v15, v57, v57
    v_mfma_f32_32x32x16_bf16 v[208:223], v[156:159], v[40:43], v[208:223]
    v_add_f32 v14, v14, v58
    v_fmac_f32 v15, v58, v58
    v_lshlrev_b32 v57, 16, v159
    v_and_b32 v58, 0xffff0000, v159
    v_add_f32 v14, v14, v57
    v_fmac_f32 v15, v57, v57
    v_add_f32 v14, v14, v58
    v_fmac_f32 v15, v58, v58
    ds_read_b128 v[32:35], v11 offset:25600
    ds_read_b128 v[36:39], v11 offset:54272
    ds_read_b128 v[40:43], v10 offset:25600
    s_waitcnt vmcnt(3) lgkmcnt(3)
    v_mfma_f32_32x32x16_bf16 v[176:191], v[224:227], v[160:163], v[176:191]
    v_lshlrev_b32 v57, 16, v160
    v_and_b32 v58, 0xffff0000, v160
    v_add_f32 v14, v14, v57
    v_fmac_f32 v15, v57, v57
    v_add_f32 v14, v14, v58
    v_fmac_f32 v15, v58, v58
    v_lshlrev_b32 v57, 16, v161
    v_and_b32 v58, 0xffff0000, v161
    v_mfma_f32_32x32x16_bf16 v[192:207], v[228:231], v[160:163], v[192:207]
    v_add_f32 v14, v14, v57
    v_fmac_f32 v15, v57, v57
    v_add_f32 v14, v14, v58
    v_fmac_f32 v15, v58, v58
    v_lshlrev_b32 v57, 16, v162
    v_and_b32 v58, 0xffff0000, v162
    v_add_f32 v14, v14, v57
    v_fmac_f32 v15, v57, v57
    v_mfma_f32_32x32x16_bf16 v[208:223], v[160:163], v[232:235], v[208:223]
    v_add_f32 v14, v14, v58
    v_fmac_f32 v15, v58, v58
    v_lshlrev_b32 v57, 16, v163
    v_and_b32 v58, 0xffff0000, v163
    v_add_f32 v14, v14, v57
    v_fmac_f32 v15, v57, v57
    v_add_f32 v14, v14, v58
    v_fmac_f32 v15, v58, v58
    ds_read_b128 v[224:227], v11 offset:26624
    ds_read_b128 v[228:231], v11 offset:55296
    ds_read_b128 v[232:235], v10 offset:26624
    s_waitcnt vmcnt(2) lgkmcnt(3)
    v_mfma_f32_32x32x16_bf16 v[176:191], v[32:35], v[164:167], v[176:191]
    v_lshlrev_b32 v57, 16, v164
    v_and_b32 v58, 0xffff0000, v164
    v_add_f32 v14, v14, v57
    v_fmac_f32 v15, v57, v57
    v_add_f32 v14, v14, v58
    v_fmac_f32 v15, v58, v58
    v_lshlrev_b32 v57, 16, v165
    v_and_b32 v58, 0xffff0000, v165
    v_mfma_f32_32x32x16_bf16 v[192:207], v[36:39], v[164:167], v[192:207]
    v_add_f32 v14, v14, v57
    v_fmac_f32 v15, v57, v57
    v_add_f32 v14, v14, v58
    v_fmac_f32 v15, v58, v58
    v_lshlrev_b32 v57, 16, v166
    v_and_b32 v58, 0xffff0000, v166
    v_add_f32 v14, v14, v57
    v_fmac_f32 v15, v57, v57
    v_mfma_f32_32x32x16_bf16 v[208:223], v[164:167], v[40:43], v[208:223]
    v_add_f32 v14, v14, v58
    v_fmac_f32 v15, v58, v58
    v_lshlrev_b32 v57, 16, v167
    v_and_b32 v58, 0xffff0000, v167
    v_add_f32 v14, v14, v57
    v_fmac_f32 v15, v57, v57
    v_add_f32 v14, v14, v58
    v_fmac_f32 v15, v58, v58
    ds_read_b128 v[32:35], v11 offset:27648
    ds_read_b128 v[36:39], v11 offset:56320
    ds_read_b128 v[40:43], v10 offset:27648
    s_waitcnt vmcnt(1) lgkmcnt(3)
    v_mfma_f32_32x32x16_bf16 v[176:191], v[224:227], v[168:171], v[176:191]
    v_lshlrev_b32 v57, 16, v168
    v_and_b32 v58, 0xffff0000, v168
    v_add_f32 v14, v14, v57
    v_fmac_f32 v15, v57, v57
    v_add_f32 v14, v14, v58
    v_fmac_f32 v15, v58, v58
    v_lshlrev_b32 v57, 16, v169
    v_and_b32 v58, 0xffff0000, v169
    v_mfma_f32_32x32x16_bf16 v[192:207], v[228:231], v[168:171], v[192:207]
    v_add_f32 v14, v14, v57
    v_fmac_f32 v15, v57, v57
    v_add_f32 v14, v14, v58
    v_fmac_f32 v15, v58, v58
    v_lshlrev_b32 v57, 16, v170
    v_and_b32 v58, 0xffff0000, v170
    v_add_f32 v14, v14, v57
    v_fmac_f32 v15, v57, v57
    v_mfma_f32_32x32x16_bf16 v[208:223], v[168:171], v[232:235], v[208:223]
    v_add_f32 v14, v14, v58
    v_fmac_f32 v15, v58, v58
    v_lshlrev_b32 v57, 16, v171
    v_and_b32 v58, 0xffff0000, v171
    v_add_f32 v14, v14, v57
    v_fmac_f32 v15, v57, v57
    v_add_f32 v14, v14, v58
    v_fmac_f32 v15, v58, v58
    s_waitcnt vmcnt(0) lgkmcnt(0)
    v_mfma_f32_32x32x16_bf16 v[176:191], v[32:35], v[172:175], v[176:191]
    v_lshlrev_b32 v57, 16, v172
    v_and_b32 v58, 0xffff0000, v172
    v_add_f32 v14, v14, v57
    v_fmac_f32 v15, v57, v57
    v_add_f32 v14, v14, v58
    v_fmac_f32 v15, v58, v58
    v_lshlrev_b32 v57, 16, v173
    v_and_b32 v58, 0xffff0000, v173
    v_mfma_f32_32x32x16_bf16 v[192:207], v[36:39], v[172:175], v[192:207]
    v_add_f32 v14, v14, v57
    v_fmac_f32 v15, v57, v57
    v_add_f32 v14, v14, v58
    v_fmac_f32 v15, v58, v58
    v_lshlrev_b32 v57, 16, v174
    v_and_b32 v58, 0xffff0000, v174
    v_add_f32 v14, v14, v57
    v_fmac_f32 v15, v57, v57
    v_mfma_f32_32x32x16_bf16 v[208:223], v[172:175], v[40:43], v[208:223]
    v_add_f32 v14, v14, v58
    v_fmac_f32 v15, v58, v58
    v_lshlrev_b32 v57, 16, v175
    v_and_b32 v58, 0xffff0000, v175
    v_add_f32 v14, v14, v57
    v_fmac_f32 v15, v57, v57
    v_add_f32 v14, v14, v58
    v_fmac_f32 v15, v58, v58
    v_mov_b32 v57, v14
    s_nop 1
    v_permlane32_swap_b32 v14, v57
    s_nop 0
    v_add_f32 v14, v14, v57
    v_mov_b32 v57, v15
    s_nop 1
    v_permlane32_swap_b32 v15, v57
    s_nop 0
    v_add_f32 v15, v15, v57
    v_mul_f32 v14, 0x3b124925, v14
    v_mul_f32 v15, 0x3b124925, v15
    v_fma_f32 v15, -v14, v14, v15
    v_max_f32 v15, 0, v15
    v_add_f32 v15, 0x3727c5ac, v15
    v_rsq_f32 v59, v15
    s_nop 0
    v_mul_f32 v58, v14, v59
    v_sub_f32 v58, 0, v58
    v_lshlrev_b32 v12, 2, v3
    v_add_u32 v12, s13, v12
    ds_write_b32 v12, v59 offset:4096
    ds_write_b32 v12, v58 offset:4224
    v_lshlrev_b32 v13, 4, v4
    v_add_u32 v13, s13, v13
    s_nop 7
    v_mul_f32 v64, v58, v16
    v_fma_f32 v64, v192, v59, v64
    v_mul_f32 v65, v58, v17
    v_fma_f32 v65, v193, v59, v65
    v_mul_f32 v66, v58, v18
    v_fma_f32 v66, v194, v59, v66
    v_mul_f32 v67, v58, v19
    v_fma_f32 v67, v195, v59, v67
    v_mul_f32 v68, v58, v20
    v_fma_f32 v68, v196, v59, v68
    v_mul_f32 v69, v58, v21
    v_fma_f32 v69, v197, v59, v69
    v_mul_f32 v70, v58, v22
    v_fma_f32 v70, v198, v59, v70
    v_mul_f32 v71, v58, v23
    v_fma_f32 v71, v199, v59, v71
    v_mul_f32 v72, v58, v24
    v_fma_f32 v72, v200, v59, v72
    v_mul_f32 v73, v58, v25
    v_fma_f32 v73, v201, v59, v73
    v_mul_f32 v74, v58, v26
    v_fma_f32 v74, v202, v59, v74
    v_mul_f32 v75, v58, v27
    v_fma_f32 v75, v203, v59, v75
    v_mul_f32 v76, v58, v28
    v_fma_f32 v76, v204, v59, v76
    v_mul_f32 v77, v58, v29
    v_fma_f32 v77, v205, v59, v77
    v_mul_f32 v78, v58, v30
    v_fma_f32 v78, v206, v59, v78
    v_mul_f32 v79, v58, v31
    v_fma_f32 v79, v207, v59, v79
    v_cvt_pk_bf16_f32 v80, v64, v65
    v_cvt_pk_bf16_f32 v81, v66, v67
    v_cvt_pk_bf16_f32 v82, v68, v69
    v_cvt_pk_bf16_f32 v83, v70, v71
    v_cvt_pk_bf16_f32 v84, v72, v73
    v_cvt_pk_bf16_f32 v85, v74, v75
    v_cvt_pk_bf16_f32 v86, v76, v77
    v_cvt_pk_bf16_f32 v87, v78, v79
    s_nop 1
    v_mfma_f32_32x32x16_bf16 v[96:111], v[48:51], v[80:83], 0
    v_mfma_f32_32x32x16_bf16 v[96:111], v[52:55], v[84:87], v[96:111]
    v_mov_b32 v24, 0xff7fffff
    v_mov_b32 v25, 0x7f7fffff
    s_nop 13
    v_cndmask_b32 v26, v108, v24, s[60:61]
    v_cndmask_b32 v144, v108, v25, s[60:61]
    v_cndmask_b32 v27, v109, v24, s[60:61]
    v_cndmask_b32 v145, v109, v25, s[60:61]
    v_cndmask_b32 v28, v110, v24, s[60:61]
    v_cndmask_b32 v146, v110, v25, s[60:61]
    v_cndmask_b32 v29, v111, v24, s[60:61]
    v_cndmask_b32 v147, v111, v25, s[60:61]
    v_max3_f32 v30, v96, v97, v98
    v_min3_f32 v31, v96, v97, v98
    v_max3_f32 v30, v99, v100, v30
    v_min3_f32 v31, v99, v100, v31
    v_max3_f32 v30, v101, v102, v30
    v_min3_f32 v31, v101, v102, v31
    v_max3_f32 v30, v103, v104, v30
    v_min3_f32 v31, v103, v104, v31
    v_max3_f32 v30, v105, v106, v30
    v_min3_f32 v31, v105, v106, v31
    v_max_f32 v30, v107, v30
    v_min_f32 v31, v107, v31
    v_max3_f32 v30, v26, v27, v30
    v_min3_f32 v31, v144, v145, v31
    v_max3_f32 v30, v28, v29, v30
    v_min3_f32 v31, v146, v147, v31
    v_mov_b32 v12, v30
    s_nop 1
    v_permlane32_swap_b32 v30, v12
    s_nop 0
    v_max_f32 v30, v30, v12
    v_mov_b32 v12, v31
    s_nop 1
    v_permlane32_swap_b32 v31, v12
    s_nop 0
    v_min_f32 v31, v31, v12
    v_mov_b32 v24, 0x3fb8aa3b
    v_mul_f32 v30, 0xbfb8aa3b, v30
    v_mul_f32 v31, 0x3fb8aa3b, v31
    v_fma_f32 v112, v96, v24, v30
    v_fma_f32 v128, -v96, v24, v31
    v_fma_f32 v113, v97, v24, v30
    v_fma_f32 v129, -v97, v24, v31
    v_fma_f32 v114, v98, v24, v30
    v_fma_f32 v130, -v98, v24, v31
    v_fma_f32 v115, v99, v24, v30
    v_fma_f32 v131, -v99, v24, v31
    v_fma_f32 v116, v100, v24, v30
    v_fma_f32 v132, -v100, v24, v31
    v_fma_f32 v117, v101, v24, v30
    v_fma_f32 v133, -v101, v24, v31
    v_fma_f32 v118, v102, v24, v30
    v_fma_f32 v134, -v102, v24, v31
    v_fma_f32 v119, v103, v24, v30
    v_fma_f32 v135, -v103, v24, v31
    v_fma_f32 v120, v104, v24, v30
    v_fma_f32 v136, -v104, v24, v31
    v_fma_f32 v121, v105, v24, v30
    v_fma_f32 v137, -v105, v24, v31
    v_fma_f32 v122, v106, v24, v30
    v_fma_f32 v138, -v106, v24, v31
    v_fma_f32 v123, v107, v24, v30
    v_fma_f32 v139, -v107, v24, v31
    v_fma_f32 v124, v108, v24, v30
    v_fma_f32 v140, -v108, v24, v31
    v_fma_f32 v125, v109, v24, v30
    v_fma_f32 v141, -v109, v24, v31
    v_fma_f32 v126, v110, v24, v30
    v_fma_f32 v142, -v110, v24, v31
    v_fma_f32 v127, v111, v24, v30
    v_fma_f32 v143, -v111, v24, v31
    v_exp_f32 v112, v112
    v_exp_f32 v128, v128
    v_exp_f32 v113, v113
    v_exp_f32 v129, v129
    v_exp_f32 v114, v114
    v_exp_f32 v130, v130
    v_exp_f32 v115, v115
    v_exp_f32 v131, v131
    v_exp_f32 v116, v116
    v_exp_f32 v132, v132
    v_exp_f32 v117, v117
    v_exp_f32 v133, v133
    v_exp_f32 v118, v118
    v_exp_f32 v134, v134
    v_exp_f32 v119, v119
    v_exp_f32 v135, v135
    v_exp_f32 v120, v120
    v_exp_f32 v136, v136
    v_exp_f32 v121, v121
    v_exp_f32 v137, v137
    v_exp_f32 v122, v122
    v_exp_f32 v138, v138
    v_exp_f32 v123, v123
    v_exp_f32 v139, v139
    v_exp_f32 v124, v124
    v_exp_f32 v140, v140
    v_exp_f32 v125, v125
    v_exp_f32 v141, v141
    v_exp_f32 v126, v126
    v_exp_f32 v142, v142
    v_exp_f32 v127, v127
    v_exp_f32 v143, v143
    s_nop 0
    v_cndmask_b32 v124, v124, 0, s[60:61]
    v_cndmask_b32 v140, v140, 0, s[60:61]
    v_cndmask_b32 v125, v125, 0, s[60:61]
    v_cndmask_b32 v141, v141, 0, s[60:61]
    v_cndmask_b32 v126, v126, 0, s[60:61]
    v_cndmask_b32 v142, v142, 0, s[60:61]
    v_cndmask_b32 v127, v127, 0, s[60:61]
    v_cndmask_b32 v143, v143, 0, s[60:61]
    v_add_f32 v30, v112, v113
    v_add_f32 v31, v128, v129
    v_add_f32 v30, v114, v30
    v_add_f32 v31, v130, v31
    v_add_f32 v30, v115, v30
    v_add_f32 v31, v131, v31
    v_add_f32 v30, v116, v30
    v_add_f32 v31, v132, v31
    v_add_f32 v30, v117, v30
    v_add_f32 v31, v133, v31
    v_add_f32 v30, v118, v30
    v_add_f32 v31, v134, v31
    v_add_f32 v30, v119, v30
    v_add_f32 v31, v135, v31
    v_add_f32 v30, v120, v30
    v_add_f32 v31, v136, v31
    v_add_f32 v30, v121, v30
    v_add_f32 v31, v137, v31
    v_add_f32 v30, v122, v30
    v_add_f32 v31, v138, v31
    v_add_f32 v30, v123, v30
    v_add_f32 v31, v139, v31
    v_add_f32 v30, v124, v30
    v_add_f32 v31, v140, v31
    v_add_f32 v30, v125, v30
    v_add_f32 v31, v141, v31
    v_add_f32 v30, v126, v30
    v_add_f32 v31, v142, v31
    v_add_f32 v30, v127, v30
    v_add_f32 v31, v143, v31
    v_mov_b32 v12, v30
    s_nop 1
    v_permlane32_swap_b32 v30, v12
    s_nop 0
    v_add_f32 v30, v30, v12
    v_mov_b32 v12, v31
    s_nop 1
    v_permlane32_swap_b32 v31, v12
    s_nop 0
    v_add_f32 v31, v31, v12
    v_rcp_f32 v30, v30
    v_rcp_f32 v31, v31
    s_nop 0
    v_mul_f32 v112, v30, v112
    v_mul_f32 v128, v31, v128
    v_mul_f32 v113, v30, v113
    v_mul_f32 v129, v31, v129
    v_mul_f32 v114, v30, v114
    v_mul_f32 v130, v31, v130
    v_mul_f32 v115, v30, v115
    v_mul_f32 v131, v31, v131
    v_mul_f32 v116, v30, v116
    v_mul_f32 v132, v31, v132
    v_mul_f32 v117, v30, v117
    v_mul_f32 v133, v31, v133
    v_mul_f32 v118, v30, v118
    v_mul_f32 v134, v31, v134
    v_mul_f32 v119, v30, v119
    v_mul_f32 v135, v31, v135
    v_mul_f32 v120, v30, v120
    v_mul_f32 v136, v31, v136
    v_mul_f32 v121, v30, v121
    v_mul_f32 v137, v31, v137
    v_mul_f32 v122, v30, v122
    v_mul_f32 v138, v31, v138
    v_mul_f32 v123, v30, v123
    v_mul_f32 v139, v31, v139
    v_mul_f32 v124, v30, v124
    v_mul_f32 v140, v31, v140
    v_mul_f32 v125, v30, v125
    v_mul_f32 v141, v31, v141
    v_mul_f32 v126, v30, v126
    v_mul_f32 v142, v31, v142
    v_mul_f32 v127, v30, v127
    v_mul_f32 v143, v31, v143
    v_cvt_pk_bf16_f32 v112, v112, v113
    v_cvt_pk_bf16_f32 v128, v128, v129
    v_cvt_pk_bf16_f32 v113, v114, v115
    v_cvt_pk_bf16_f32 v129, v130, v131
    v_cvt_pk_bf16_f32 v114, v116, v117
    v_cvt_pk_bf16_f32 v130, v132, v133
    v_cvt_pk_bf16_f32 v115, v118, v119
    v_cvt_pk_bf16_f32 v131, v134, v135
    v_cvt_pk_bf16_f32 v116, v120, v121
    v_cvt_pk_bf16_f32 v132, v136, v137
    v_cvt_pk_bf16_f32 v117, v122, v123
    v_cvt_pk_bf16_f32 v133, v138, v139
    v_cvt_pk_bf16_f32 v118, v124, v125
    v_cvt_pk_bf16_f32 v134, v140, v141
    v_cvt_pk_bf16_f32 v119, v126, v127
    v_cvt_pk_bf16_f32 v135, v142, v143
    v_lshlrev_b32 v12, 6, v3
    v_lshl_add_u32 v12, v4, 3, v12
    v_add_u32 v12, s13, v12
    ds_write_b64 v12, v[112:113] offset:0
    ds_write_b64 v12, v[128:129] offset:2048
    ds_write_b64 v12, v[114:115] offset:16
    ds_write_b64 v12, v[130:131] offset:2064
    ds_write_b64 v12, v[116:117] offset:32
    ds_write_b64 v12, v[132:133] offset:2080
    ds_write_b64 v12, v[118:119] offset:48
    ds_write_b64 v12, v[134:135] offset:2096
    ds_read_b128 v[64:67], v13 offset:4096
    ds_read_b128 v[80:83], v13 offset:4224
    ds_read_b128 v[68:71], v13 offset:4128
    ds_read_b128 v[84:87], v13 offset:4256
    ds_read_b128 v[72:75], v13 offset:4160
    ds_read_b128 v[88:91], v13 offset:4288
    ds_read_b128 v[76:79], v13 offset:4192
    ds_read_b128 v[92:95], v13 offset:4320
    v_cmp_gt_u32 vcc, 28, v3
    v_mov_b32 v24, 0
    v_mov_b32 v25, 1.0
    v_cmp_eq_u32 s[62:63], 28, v3
    s_nop 1
    v_cndmask_b32 v24, v24, v25, s[62:63]
    s_waitcnt lgkmcnt(0)
    v_mul_f32 v80, v56, v80
    v_fma_f32 v80, v208, v64, v80
    v_cndmask_b32 v80, v24, v80, vcc
    v_mul_f32 v81, v56, v81
    v_fma_f32 v81, v209, v65, v81
    v_cndmask_b32 v81, v24, v81, vcc
    v_mul_f32 v82, v56, v82
    v_fma_f32 v82, v210, v66, v82
    v_cndmask_b32 v82, v24, v82, vcc
    v_mul_f32 v83, v56, v83
    v_fma_f32 v83, v211, v67, v83
    v_cndmask_b32 v83, v24, v83, vcc
    v_mul_f32 v84, v56, v84
    v_fma_f32 v84, v212, v68, v84
    v_cndmask_b32 v84, v24, v84, vcc
    v_mul_f32 v85, v56, v85
    v_fma_f32 v85, v213, v69, v85
    v_cndmask_b32 v85, v24, v85, vcc
    v_mul_f32 v86, v56, v86
    v_fma_f32 v86, v214, v70, v86
    v_cndmask_b32 v86, v24, v86, vcc
    v_mul_f32 v87, v56, v87
    v_fma_f32 v87, v215, v71, v87
    v_cndmask_b32 v87, v24, v87, vcc
    v_mul_f32 v88, v56, v88
    v_fma_f32 v88, v216, v72, v88
    v_cndmask_b32 v88, v24, v88, vcc
    v_mul_f32 v89, v56, v89
    v_fma_f32 v89, v217, v73, v89
    v_cndmask_b32 v89, v24, v89, vcc
    v_mul_f32 v90, v56, v90
    v_fma_f32 v90, v218, v74, v90
    v_cndmask_b32 v90, v24, v90, vcc
    v_mul_f32 v91, v56, v91
    v_fma_f32 v91, v219, v75, v91
    v_cndmask_b32 v91, v24, v91, vcc
    v_mul_f32 v92, v56, v92
    v_fma_f32 v92, v220, v76, v92
    v_cndmask_b32 v92, v24, v92, vcc
    v_mul_f32 v93, v56, v93
    v_fma_f32 v93, v221, v77, v93
    v_cndmask_b32 v93, v24, v93, vcc
    v_mul_f32 v94, v56, v94
    v_fma_f32 v94, v222, v78, v94
    v_cndmask_b32 v94, v24, v94, vcc
    v_mul_f32 v95, v56, v95
    v_fma_f32 v95, v223, v79, v95
    v_cndmask_b32 v95, v24, v95, vcc
    v_cvt_pk_bf16_f32 v96, v80, v81
    v_cvt_pk_bf16_f32 v97, v82, v83
    v_cvt_pk_bf16_f32 v98, v84, v85
    v_cvt_pk_bf16_f32 v99, v86, v87
    v_cvt_pk_bf16_f32 v100, v88, v89
    v_cvt_pk_bf16_f32 v101, v90, v91
    v_cvt_pk_bf16_f32 v102, v92, v93
    v_cvt_pk_bf16_f32 v103, v94, v95
    v_and_b32 v26, 15, v1
    v_lshrrev_b32 v27, 2, v26
    v_and_b32 v26, 3, v26
    v_lshlrev_b32 v26, 3, v26
    v_lshl_add_u32 v27, v4, 2, v27
    v_lshl_add_u32 v26, v27, 6, v26
    v_bfe_u32 v27, v1, 4, 1
    v_lshl_add_u32 v26, v27, 5, v26
    v_add_u32 v26, s13, v26
    ds_read_b64_tr_b16 v[144:145], v26 offset:0
    ds_read_b64_tr_b16 v[146:147], v26 offset:512
    ds_read_b64_tr_b16 v[148:149], v26 offset:1024
    ds_read_b64_tr_b16 v[150:151], v26 offset:1536
    ds_read_b64_tr_b16 v[152:153], v26 offset:2048
    ds_read_b64_tr_b16 v[154:155], v26 offset:2560
    ds_read_b64_tr_b16 v[156:157], v26 offset:3072
    ds_read_b64_tr_b16 v[158:159], v26 offset:3584
    s_waitcnt lgkmcnt(0)
    v_mfma_f32_32x32x16_bf16 v[192:207], v[144:147], v[96:99], 0
    v_mfma_f32_32x32x16_bf16 v[192:207], v[148:151], v[100:103], v[192:207]
    v_mfma_f32_32x32x16_bf16 v[208:223], v[152:155], v[96:99], 0
    v_mfma_f32_32x32x16_bf16 v[208:223], v[156:159], v[100:103], v[208:223]
    s_barrier
    s_nop 11
    s_lshl_b32 s12, s3, 13
    v_lshlrev_b32 v12, 5, v1
    v_add_u32 v12, s12, v12
    ds_write_b128 v12, v[192:195] offset:0
    ds_write_b128 v12, v[196:199] offset:16
    ds_write_b128 v12, v[200:203] offset:2048
    ds_write_b128 v12, v[204:207] offset:2064
    ds_write_b128 v12, v[208:211] offset:4096
    ds_write_b128 v12, v[212:215] offset:4112
    ds_write_b128 v12, v[216:219] offset:6144
    ds_write_b128 v12, v[220:223] offset:6160
    s_waitcnt lgkmcnt(0)
    s_barrier
    v_lshlrev_b32 v12, 2, v0
    ds_read_b32 v64, v12 offset:0
    ds_read_b32 v65, v12 offset:8192
    ds_read_b32 v66, v12 offset:16384
    ds_read_b32 v67, v12 offset:24576
    ds_read_b32 v68, v12 offset:1024
    ds_read_b32 v69, v12 offset:9216
    ds_read_b32 v70, v12 offset:17408
    ds_read_b32 v71, v12 offset:25600
    ds_read_b32 v72, v12 offset:2048
    ds_read_b32 v73, v12 offset:10240
    ds_read_b32 v74, v12 offset:18432
    ds_read_b32 v75, v12 offset:26624
    ds_read_b32 v76, v12 offset:3072
    ds_read_b32 v77, v12 offset:11264
    ds_read_b32 v78, v12 offset:19456
    ds_read_b32 v79, v12 offset:27648
    ds_read_b32 v80, v12 offset:4096
    ds_read_b32 v81, v12 offset:12288
    ds_read_b32 v82, v12 offset:20480
    ds_read_b32 v83, v12 offset:28672
    ds_read_b32 v84, v12 offset:5120
    ds_read_b32 v85, v12 offset:13312
    ds_read_b32 v86, v12 offset:21504
    ds_read_b32 v87, v12 offset:29696
    ds_read_b32 v88, v12 offset:6144
    ds_read_b32 v89, v12 offset:14336
    ds_read_b32 v90, v12 offset:22528
    ds_read_b32 v91, v12 offset:30720
    ds_read_b32 v92, v12 offset:7168
    ds_read_b32 v93, v12 offset:15360
    ds_read_b32 v94, v12 offset:23552
    ds_read_b32 v95, v12 offset:31744
    s_lshl_b32 s12, s5, 13
    s_waitcnt lgkmcnt(15)
    v_add_f32 v64, v64, v65
    v_add_f32 v66, v66, v67
    v_add_f32 v64, v64, v66
    buffer_atomic_add_f32 v64, v12, s[56:59], s12 offen offset:0 sc1
    s_waitcnt lgkmcnt(15)
    v_add_f32 v68, v68, v69
    v_add_f32 v70, v70, v71
    v_add_f32 v68, v68, v70
    buffer_atomic_add_f32 v68, v12, s[56:59], s12 offen offset:1024 sc1
    s_waitcnt lgkmcnt(15)
    v_add_f32 v72, v72, v73
    v_add_f32 v74, v74, v75
    v_add_f32 v72, v72, v74
    buffer_atomic_add_f32 v72, v12, s[56:59], s12 offen offset:2048 sc1
    s_waitcnt lgkmcnt(15)
    v_add_f32 v76, v76, v77
    v_add_f32 v78, v78, v79
    v_add_f32 v76, v76, v78
    buffer_atomic_add_f32 v76, v12, s[56:59], s12 offen offset:3072 sc1
    s_add_u32 s12, s12, 4096
    s_waitcnt lgkmcnt(12)
    v_add_f32 v80, v80, v81
    v_add_f32 v82, v82, v83
    v_add_f32 v80, v80, v82
    buffer_atomic_add_f32 v80, v12, s[56:59], s12 offen offset:0 sc1
    s_waitcnt lgkmcnt(8)
    v_add_f32 v84, v84, v85
    v_add_f32 v86, v86, v87
    v_add_f32 v84, v84, v86
    buffer_atomic_add_f32 v84, v12, s[56:59], s12 offen offset:1024 sc1
    s_waitcnt lgkmcnt(4)
    v_add_f32 v88, v88, v89
    v_add_f32 v90, v90, v91
    v_add_f32 v88, v88, v90
    buffer_atomic_add_f32 v88, v12, s[56:59], s12 offen offset:2048 sc1
    s_waitcnt lgkmcnt(0)
    v_add_f32 v92, v92, v93
    v_add_f32 v94, v94, v95
    v_add_f32 v92, v92, v94
    buffer_atomic_add_f32 v92, v12, s[56:59], s12 offen offset:3072 sc1
    s_lshl_b32 s12, s2, 2
    s_add_u32 s12, s12, 2048
    s_waitcnt vmcnt(0) lgkmcnt(0)
    s_barrier
    s_cmp_eq_u32 s3, 0
    s_cbranch_scc0 L_sig_25
    v_mov_b32 v5, s98
    v_mov_b32 v6, 0
    s_mov_b64 exec, 1
    buffer_store_dword v5, v6, s[72:75], s12 offen sc1
    s_mov_b64 exec, -1
L_sig_25:
    s_cmp_eq_u32 s2, 255
    s_cbranch_scc0 L_agg_26
    s_cmp_eq_u32 s3, 3
    s_cbranch_scc0 L_agg_26
    s_mov_b32 s13, 2048
    v_lshlrev_b32 v6, 4, v1
    v_lshlrev_b32 v7, 2, v1
L_pb_27:
    buffer_load_dwordx4 v[12:15], v6, s[72:75], s13 offen sc1
    s_waitcnt vmcnt(0)
    s_mov_b64 s[60:61], 0
    v_add_u32 v16, 0, v7
    s_movk_i32 s14, 256
    v_cmp_gt_u32 s[62:63], s14, v16
    v_cmp_ne_u32 vcc, s98, v12
    s_and_b64 s[62:63], s[62:63], vcc
    s_or_b64 s[60:61], s[60:61], s[62:63]
    v_add_u32 v16, 1, v7
    s_movk_i32 s14, 256
    v_cmp_gt_u32 s[62:63], s14, v16
    v_cmp_ne_u32 vcc, s98, v13
    s_and_b64 s[62:63], s[62:63], vcc
    s_or_b64 s[60:61], s[60:61], s[62:63]
    v_add_u32 v16, 2, v7
    s_movk_i32 s14, 256
    v_cmp_gt_u32 s[62:63], s14, v16
    v_cmp_ne_u32 vcc, s98, v14
    s_and_b64 s[62:63], s[62:63], vcc
    s_or_b64 s[60:61], s[60:61], s[62:63]
    v_add_u32 v16, 3, v7
    s_movk_i32 s14, 256
    v_cmp_gt_u32 s[62:63], s14, v16
    v_cmp_ne_u32 vcc, s98, v15
    s_and_b64 s[62:63], s[62:63], vcc
    s_or_b64 s[60:61], s[60:61], s[62:63]
    s_cmp_eq_u64 s[60:61], 0
    s_cbranch_scc1 L_pb_27_x
    s_sleep 2
    s_branch L_pb_27
L_pb_27_x:
    v_lshlrev_b32 v6, 7, v1
    v_mov_b32 v5, s98
    s_mov_b64 exec, 0xffff
    s_mov_b32 s13, 6144
    buffer_store_dword v5, v6, s[72:75], s13 offen sc1
    s_mov_b64 exec, -1
L_agg_26:
    s_lshr_b32 s13, s2, 3
    s_mul_hi_u32 s14, s13, 0x24924925
    s_mul_i32 s14, s14, 7
    s_sub_u32 s13, s13, s14
    s_add_u32 s44, s38, 0x2600000
    s_addc_u32 s45, s39, 0
    s_and_b32 s45, s45, 0xffff
    s_mov_b32 s46, 0x70000
    s_mov_b32 s47, 0x20000
    s_lshl_b32 s13, s13, 16
    s_lshl_b32 s14, s3, 14
    s_add_u32 s13, s13, s14
    s_add_u32 s14, s14, 65536
    s_add_u32 s11, s13, 0
    s_add_u32 m0, s14, 0
    s_nop 0
    buffer_load_dwordx4 v9, s[44:47], s11 offen lds
    s_add_u32 s11, s13, 1024
    s_add_u32 m0, s14, 1024
    s_nop 0
    buffer_load_dwordx4 v9, s[44:47], s11 offen lds
    s_add_u32 s11, s13, 2048
    s_add_u32 m0, s14, 2048
    s_nop 0
    buffer_load_dwordx4 v9, s[44:47], s11 offen lds
    s_add_u32 s11, s13, 3072
    s_add_u32 m0, s14, 3072
    s_nop 0
    buffer_load_dwordx4 v9, s[44:47], s11 offen lds
    s_add_u32 s11, s13, 4096
    s_add_u32 m0, s14, 4096
    s_nop 0
    buffer_load_dwordx4 v9, s[44:47], s11 offen lds
    s_add_u32 s11, s13, 5120
    s_add_u32 m0, s14, 5120
    s_nop 0
    buffer_load_dwordx4 v9, s[44:47], s11 offen lds
    s_add_u32 s11, s13, 6144
    s_add_u32 m0, s14, 6144
    s_nop 0
    buffer_load_dwordx4 v9, s[44:47], s11 offen lds
    s_add_u32 s11, s13, 7168
    s_add_u32 m0, s14, 7168
    s_nop 0
    buffer_load_dwordx4 v9, s[44:47], s11 offen lds
    s_add_u32 s11, s13, 8192
    s_add_u32 m0, s14, 8192
    s_nop 0
    buffer_load_dwordx4 v9, s[44:47], s11 offen lds
    s_add_u32 s11, s13, 9216
    s_add_u32 m0, s14, 9216
    s_nop 0
    buffer_load_dwordx4 v9, s[44:47], s11 offen lds
    s_add_u32 s11, s13, 10240
    s_add_u32 m0, s14, 10240
    s_nop 0
    buffer_load_dwordx4 v9, s[44:47], s11 offen lds
    s_add_u32 s11, s13, 11264
    s_add_u32 m0, s14, 11264
    s_nop 0
    buffer_load_dwordx4 v9, s[44:47], s11 offen lds
    s_add_u32 s11, s13, 12288
    s_add_u32 m0, s14, 12288
    s_nop 0
    buffer_load_dwordx4 v9, s[44:47], s11 offen lds
    s_add_u32 s11, s13, 13312
    s_add_u32 m0, s14, 13312
    s_nop 0
    buffer_load_dwordx4 v9, s[44:47], s11 offen lds
    s_add_u32 s11, s13, 14336
    s_add_u32 m0, s14, 14336
    s_nop 0
    buffer_load_dwordx4 v9, s[44:47], s11 offen lds
    s_add_u32 s11, s13, 15360
    s_add_u32 m0, s14, 15360
    s_nop 0
    buffer_load_dwordx4 v9, s[44:47], s11 offen lds
    s_mov_b32 s60, 0
    s_mov_b32 s61, -1
    v_mul_f32 v64, v58, v240
    v_fma_f32 v64, v176, v59, v64
    v_mul_f32 v65, v58, v241
    v_fma_f32 v65, v177, v59, v65
    v_mul_f32 v66, v58, v242
    v_fma_f32 v66, v178, v59, v66
    v_mul_f32 v67, v58, v243
    v_fma_f32 v67, v179, v59, v67
    v_mul_f32 v68, v58, v244
    v_fma_f32 v68, v180, v59, v68
    v_mul_f32 v69, v58, v245
    v_fma_f32 v69, v181, v59, v69
    v_mul_f32 v70, v58, v246
    v_fma_f32 v70, v182, v59, v70
    v_mul_f32 v71, v58, v247
    v_fma_f32 v71, v183, v59, v71
    v_mul_f32 v72, v58, v248
    v_fma_f32 v72, v184, v59, v72
    v_mul_f32 v73, v58, v249
    v_fma_f32 v73, v185, v59, v73
    v_mul_f32 v74, v58, v250
    v_fma_f32 v74, v186, v59, v74
    v_mul_f32 v75, v58, v251
    v_fma_f32 v75, v187, v59, v75
    v_mul_f32 v76, v58, v252
    v_fma_f32 v76, v188, v59, v76
    v_mul_f32 v77, v58, v253
    v_fma_f32 v77, v189, v59, v77
    v_mul_f32 v78, v58, v254
    v_fma_f32 v78, v190, v59, v78
    v_mul_f32 v79, v58, v255
    v_fma_f32 v79, v191, v59, v79
    v_cvt_pk_bf16_f32 v80, v64, v65
    v_cvt_pk_bf16_f32 v81, v66, v67
    v_cvt_pk_bf16_f32 v82, v68, v69
    v_cvt_pk_bf16_f32 v83, v70, v71
    v_cvt_pk_bf16_f32 v84, v72, v73
    v_cvt_pk_bf16_f32 v85, v74, v75
    v_cvt_pk_bf16_f32 v86, v76, v77
    v_cvt_pk_bf16_f32 v87, v78, v79
    s_nop 1
    v_mfma_f32_32x32x16_bf16 v[96:111], v[48:51], v[80:83], 0
    v_mfma_f32_32x32x16_bf16 v[96:111], v[52:55], v[84:87], v[96:111]
    v_mov_b32 v24, 0xff7fffff
    v_mov_b32 v25, 0x7f7fffff
    s_nop 13
    v_cndmask_b32 v26, v108, v24, s[60:61]
    v_cndmask_b32 v144, v108, v25, s[60:61]
    v_cndmask_b32 v27, v109, v24, s[60:61]
    v_cndmask_b32 v145, v109, v25, s[60:61]
    v_cndmask_b32 v28, v110, v24, s[60:61]
    v_cndmask_b32 v146, v110, v25, s[60:61]
    v_cndmask_b32 v29, v111, v24, s[60:61]
    v_cndmask_b32 v147, v111, v25, s[60:61]
    v_max3_f32 v30, v96, v97, v98
    v_min3_f32 v31, v96, v97, v98
    v_max3_f32 v30, v99, v100, v30
    v_min3_f32 v31, v99, v100, v31
    v_max3_f32 v30, v101, v102, v30
    v_min3_f32 v31, v101, v102, v31
    v_max3_f32 v30, v103, v104, v30
    v_min3_f32 v31, v103, v104, v31
    v_max3_f32 v30, v105, v106, v30
    v_min3_f32 v31, v105, v106, v31
    v_max_f32 v30, v107, v30
    v_min_f32 v31, v107, v31
    v_max3_f32 v30, v26, v27, v30
    v_min3_f32 v31, v144, v145, v31
    v_max3_f32 v30, v28, v29, v30
    v_min3_f32 v31, v146, v147, v31
    v_mov_b32 v12, v30
    s_nop 1
    v_permlane32_swap_b32 v30, v12
    s_nop 0
    v_max_f32 v30, v30, v12
    v_mov_b32 v12, v31
    s_nop 1
    v_permlane32_swap_b32 v31, v12
    s_nop 0
    v_min_f32 v31, v31, v12
    v_mov_b32 v24, 0x3fb8aa3b
    v_mul_f32 v30, 0xbfb8aa3b, v30
    v_mul_f32 v31, 0x3fb8aa3b, v31
    v_fma_f32 v112, v96, v24, v30
    v_fma_f32 v128, -v96, v24, v31
    v_fma_f32 v113, v97, v24, v30
    v_fma_f32 v129, -v97, v24, v31
    v_fma_f32 v114, v98, v24, v30
    v_fma_f32 v130, -v98, v24, v31
    v_fma_f32 v115, v99, v24, v30
    v_fma_f32 v131, -v99, v24, v31
    v_fma_f32 v116, v100, v24, v30
    v_fma_f32 v132, -v100, v24, v31
    v_fma_f32 v117, v101, v24, v30
    v_fma_f32 v133, -v101, v24, v31
    v_fma_f32 v118, v102, v24, v30
    v_fma_f32 v134, -v102, v24, v31
    v_fma_f32 v119, v103, v24, v30
    v_fma_f32 v135, -v103, v24, v31
    v_fma_f32 v120, v104, v24, v30
    v_fma_f32 v136, -v104, v24, v31
    v_fma_f32 v121, v105, v24, v30
    v_fma_f32 v137, -v105, v24, v31
    v_fma_f32 v122, v106, v24, v30
    v_fma_f32 v138, -v106, v24, v31
    v_fma_f32 v123, v107, v24, v30
    v_fma_f32 v139, -v107, v24, v31
    v_fma_f32 v124, v108, v24, v30
    v_fma_f32 v140, -v108, v24, v31
    v_fma_f32 v125, v109, v24, v30
    v_fma_f32 v141, -v109, v24, v31
    v_fma_f32 v126, v110, v24, v30
    v_fma_f32 v142, -v110, v24, v31
    v_fma_f32 v127, v111, v24, v30
    v_fma_f32 v143, -v111, v24, v31
    v_exp_f32 v112, v112
    v_exp_f32 v128, v128
    v_exp_f32 v113, v113
    v_exp_f32 v129, v129
    v_exp_f32 v114, v114
    v_exp_f32 v130, v130
    v_exp_f32 v115, v115
    v_exp_f32 v131, v131
    v_exp_f32 v116, v116
    v_exp_f32 v132, v132
    v_exp_f32 v117, v117
    v_exp_f32 v133, v133
    v_exp_f32 v118, v118
    v_exp_f32 v134, v134
    v_exp_f32 v119, v119
    v_exp_f32 v135, v135
    v_exp_f32 v120, v120
    v_exp_f32 v136, v136
    v_exp_f32 v121, v121
    v_exp_f32 v137, v137
    v_exp_f32 v122, v122
    v_exp_f32 v138, v138
    v_exp_f32 v123, v123
    v_exp_f32 v139, v139
    v_exp_f32 v124, v124
    v_exp_f32 v140, v140
    v_exp_f32 v125, v125
    v_exp_f32 v141, v141
    v_exp_f32 v126, v126
    v_exp_f32 v142, v142
    v_exp_f32 v127, v127
    v_exp_f32 v143, v143
    s_nop 0
    v_cndmask_b32 v124, v124, 0, s[60:61]
    v_cndmask_b32 v140, v140, 0, s[60:61]
    v_cndmask_b32 v125, v125, 0, s[60:61]
    v_cndmask_b32 v141, v141, 0, s[60:61]
    v_cndmask_b32 v126, v126, 0, s[60:61]
    v_cndmask_b32 v142, v142, 0, s[60:61]
    v_cndmask_b32 v127, v127, 0, s[60:61]
    v_cndmask_b32 v143, v143, 0, s[60:61]
    v_add_f32 v30, v112, v113
    v_add_f32 v31, v128, v129
    v_add_f32 v30, v114, v30
    v_add_f32 v31, v130, v31
    v_add_f32 v30, v115, v30
    v_add_f32 v31, v131, v31
    v_add_f32 v30, v116, v30
    v_add_f32 v31, v132, v31
    v_add_f32 v30, v117, v30
    v_add_f32 v31, v133, v31
    v_add_f32 v30, v118, v30
    v_add_f32 v31, v134, v31
    v_add_f32 v30, v119, v30
    v_add_f32 v31, v135, v31
    v_add_f32 v30, v120, v30
    v_add_f32 v31, v136, v31
    v_add_f32 v30, v121, v30
    v_add_f32 v31, v137, v31
    v_add_f32 v30, v122, v30
    v_add_f32 v31, v138, v31
    v_add_f32 v30, v123, v30
    v_add_f32 v31, v139, v31
    v_add_f32 v30, v124, v30
    v_add_f32 v31, v140, v31
    v_add_f32 v30, v125, v30
    v_add_f32 v31, v141, v31
    v_add_f32 v30, v126, v30
    v_add_f32 v31, v142, v31
    v_add_f32 v30, v127, v30
    v_add_f32 v31, v143, v31
    v_mov_b32 v12, v30
    s_nop 1
    v_permlane32_swap_b32 v30, v12
    s_nop 0
    v_add_f32 v30, v30, v12
    v_mov_b32 v12, v31
    s_nop 1
    v_permlane32_swap_b32 v31, v12
    s_nop 0
    v_add_f32 v31, v31, v12
    v_rcp_f32 v30, v30
    v_rcp_f32 v31, v31
    s_nop 0
    v_mul_f32 v112, v30, v112
    v_mul_f32 v128, v31, v128
    v_mul_f32 v113, v30, v113
    v_mul_f32 v129, v31, v129
    v_mul_f32 v114, v30, v114
    v_mul_f32 v130, v31, v130
    v_mul_f32 v115, v30, v115
    v_mul_f32 v131, v31, v131
    v_mul_f32 v116, v30, v116
    v_mul_f32 v132, v31, v132
    v_mul_f32 v117, v30, v117
    v_mul_f32 v133, v31, v133
    v_mul_f32 v118, v30, v118
    v_mul_f32 v134, v31, v134
    v_mul_f32 v119, v30, v119
    v_mul_f32 v135, v31, v135
    v_mul_f32 v120, v30, v120
    v_mul_f32 v136, v31, v136
    v_mul_f32 v121, v30, v121
    v_mul_f32 v137, v31, v137
    v_mul_f32 v122, v30, v122
    v_mul_f32 v138, v31, v138
    v_mul_f32 v123, v30, v123
    v_mul_f32 v139, v31, v139
    v_mul_f32 v124, v30, v124
    v_mul_f32 v140, v31, v140
    v_mul_f32 v125, v30, v125
    v_mul_f32 v141, v31, v141
    v_mul_f32 v126, v30, v126
    v_mul_f32 v142, v31, v142
    v_mul_f32 v127, v30, v127
    v_mul_f32 v143, v31, v143
    v_cvt_pk_bf16_f32 v112, v112, v113
    v_cvt_pk_bf16_f32 v128, v128, v129
    v_cvt_pk_bf16_f32 v113, v114, v115
    v_cvt_pk_bf16_f32 v129, v130, v131
    v_cvt_pk_bf16_f32 v114, v116, v117
    v_cvt_pk_bf16_f32 v130, v132, v133
    v_cvt_pk_bf16_f32 v115, v118, v119
    v_cvt_pk_bf16_f32 v131, v134, v135
    v_cvt_pk_bf16_f32 v116, v120, v121
    v_cvt_pk_bf16_f32 v132, v136, v137
    v_cvt_pk_bf16_f32 v117, v122, v123
    v_cvt_pk_bf16_f32 v133, v138, v139
    v_cvt_pk_bf16_f32 v118, v124, v125
    v_cvt_pk_bf16_f32 v134, v140, v141
    v_cvt_pk_bf16_f32 v119, v126, v127
    v_cvt_pk_bf16_f32 v135, v142, v143
    v_mov_b32 v224, v112
    v_mov_b32 v232, v128
    v_mov_b32 v225, v113
    v_mov_b32 v233, v129
    v_mov_b32 v226, v114
    v_mov_b32 v234, v130
    v_mov_b32 v227, v115
    v_mov_b32 v235, v131
    v_mov_b32 v228, v116
    v_mov_b32 v236, v132
    v_mov_b32 v229, v117
    v_mov_b32 v237, v133
    v_mov_b32 v230, v118
    v_mov_b32 v238, v134
    v_mov_b32 v231, v119
    v_mov_b32 v239, v135
    s_add_u32 s52, s38, 0xc00000
    s_addc_u32 s53, s39, 0
    s_and_b32 s53, s53, 0xffff
    s_mov_b32 s54, 0x200000
    s_mov_b32 s55, 0x20000
    s_and_b32 s13, s2, 15
    s_lshl_b32 s13, s13, 7
    s_add_u32 s13, s13, 6144
    v_lshlrev_b32 v8, 5, v1
    s_lshl_b32 s10, s5, 13
    s_cmp_eq_u32 s3, 3
    s_cbranch_scc0 L_pdone_29
    s_mov_b64 exec, 0x1
    v_lshlrev_b32 v6, 2, v1
L_poll_28:
    buffer_load_dword v5, v6, s[72:75], s13 offen sc1
    s_waitcnt vmcnt(0)
    v_cmp_ne_u32 vcc, s98, v5
    s_cbranch_vccz L_pdone_29_x
    s_sleep 3
    s_branch L_poll_28
L_pdone_29_x:
    s_mov_b64 exec, -1
L_pdone_29:
    s_barrier
    buffer_load_dwordx4 v[64:67], v8, s[56:59], s10 offen offset:0
    buffer_load_dwordx4 v[68:71], v8, s[56:59], s10 offen offset:16
    buffer_load_dwordx4 v[72:75], v8, s[56:59], s10 offen offset:2048
    buffer_load_dwordx4 v[76:79], v8, s[56:59], s10 offen offset:2064
    s_add_u32 s10, s10, 4096
    buffer_load_dwordx4 v[80:83], v8, s[56:59], s10 offen offset:0
    buffer_load_dwordx4 v[84:87], v8, s[56:59], s10 offen offset:16
    buffer_load_dwordx4 v[88:91], v8, s[56:59], s10 offen offset:2048
    buffer_load_dwordx4 v[92:95], v8, s[56:59], s10 offen offset:2064
    s_waitcnt vmcnt(0)
    v_cvt_pk_bf16_f32 v96, v64, v65
    v_cvt_pk_bf16_f32 v97, v66, v67
    v_cvt_pk_bf16_f32 v98, v68, v69
    v_cvt_pk_bf16_f32 v99, v70, v71
    v_cvt_pk_bf16_f32 v100, v72, v73
    v_cvt_pk_bf16_f32 v101, v74, v75
    v_cvt_pk_bf16_f32 v102, v76, v77
    v_cvt_pk_bf16_f32 v103, v78, v79
    v_cvt_pk_bf16_f32 v104, v80, v81
    v_cvt_pk_bf16_f32 v105, v82, v83
    v_cvt_pk_bf16_f32 v106, v84, v85
    v_cvt_pk_bf16_f32 v107, v86, v87
    v_cvt_pk_bf16_f32 v108, v88, v89
    v_cvt_pk_bf16_f32 v109, v90, v91
    v_cvt_pk_bf16_f32 v110, v92, v93
    v_cvt_pk_bf16_f32 v111, v94, v95
    s_nop 1
    v_mfma_f32_32x32x16_bf16 v[176:191], v[96:99], v[224:227], 0
    v_mfma_f32_32x32x16_bf16 v[176:191], v[100:103], v[228:231], v[176:191]
    v_mfma_f32_32x32x16_bf16 v[176:191], v[104:107], v[232:235], v[176:191]
    v_mfma_f32_32x32x16_bf16 v[176:191], v[108:111], v[236:239], v[176:191]
    s_nop 15
    v_mov_b32 v13, v188
    v_mov_b32 v12, v188
    s_nop 1
    v_permlane32_swap_b32 v13, v12
    s_nop 0
    v_add_f32 v12, 0x358637bd, v12
    v_rcp_f32 v12, v12
    s_nop 0
    v_mul_f32 v176, v12, v176
    v_mul_f32 v177, v12, v177
    v_mul_f32 v178, v12, v178
    v_mul_f32 v179, v12, v179
    v_mul_f32 v180, v12, v180
    v_mul_f32 v181, v12, v181
    v_mul_f32 v182, v12, v182
    v_mul_f32 v183, v12, v183
    v_mul_f32 v184, v12, v184
    v_mul_f32 v185, v12, v185
    v_mul_f32 v186, v12, v186
    v_mul_f32 v187, v12, v187
    v_mul_f32 v188, v12, v188
    v_mul_f32 v189, v12, v189
    v_mul_f32 v190, v12, v190
    v_mul_f32 v191, v12, v191
    v_cvt_pk_bf16_f32 v64, v176, v177
    v_cvt_pk_bf16_f32 v65, v178, v179
    v_cvt_pk_bf16_f32 v66, v180, v181
    v_cvt_pk_bf16_f32 v67, v182, v183
    v_cvt_pk_bf16_f32 v68, v184, v185
    v_cvt_pk_bf16_f32 v69, v186, v187
    v_cvt_pk_bf16_f32 v70, v188, v189
    v_cvt_pk_bf16_f32 v71, v190, v191
    s_lshl_b32 s12, s6, 15
    s_lshl_b32 s13, s5, 11
    s_add_u32 s12, s12, s13
    buffer_store_dwordx4 v[64:67], v9, s[52:55], s12 offen sc1
    buffer_store_dwordx4 v[68:71], v9, s[52:55], s12 offen offset:1024 sc1
    s_lshl_b32 s12, s4, 7
    s_lshl_b32 s13, s5, 2
    s_add_u32 s12, s12, s13
    s_add_u32 s12, s12, 22528
    s_waitcnt vmcnt(0) lgkmcnt(0)
    s_barrier
    s_cmp_eq_u32 s3, 0
    s_cbranch_scc0 L_sig_30
    v_mov_b32 v5, s98
    v_mov_b32 v6, 0
    s_mov_b64 exec, 1
    buffer_store_dword v5, v6, s[72:75], s12 offen sc1
    s_mov_b64 exec, -1
L_sig_30:
    s_cmp_ge_u32 s2, 224
    s_cbranch_scc1 k2l1_end
    s_and_b32 s4, s2, 7
    s_lshr_b32 s5, s2, 3
    s_mul_hi_u32 s6, s5, 0x24924925
    s_mul_i32 s7, s6, 7
    s_sub_u32 s5, s5, s7
    s_lshl_b32 s4, s4, 2
    s_add_u32 s4, s4, s6
    s_add_u32 s40, s38, 0x600000
    s_addc_u32 s41, s39, 0
    s_and_b32 s41, s41, 0xffff
    s_mov_b32 s42, 0x1c0000
    s_mov_b32 s43, 0x20000
    s_add_u32 s48, s38, 0xc00000
    s_addc_u32 s49, s39, 0
    s_and_b32 s49, s49, 0xffff
    s_mov_b32 s50, 0x200000
    s_mov_b32 s51, 0x20000
    s_add_u32 s52, s38, 0x400000
    s_addc_u32 s53, s39, 0
    s_and_b32 s53, s53, 0xffff
    s_mov_b32 s54, 0x1c0000
    s_mov_b32 s55, 0x20000
    v_lshlrev_b32 v9, 4, v1
    s_and_b32 s6, s3, 1
    s_lshr_b32 s7, s3, 1
    s_lshl_b32 s8, s4, 1
    s_add_u32 s8, s8, s6
    s_lshl_b32 s15, s5, 1
    s_add_u32 s15, s15, s7
    s_mul_i32 s12, s8, 28672
    s_lshl_b32 s14, s15, 11
    s_add_u32 s12, s12, s14
    s_lshl_b32 s9, s4, 16
    s_lshl_b32 s10, s3, 14
    s_add_u32 s9, s9, s10
    s_lshr_b32 s13, s4, 1
    s_lshl_b32 s13, s13, 7
    s_add_u32 s13, s13, 22528
    s_cmp_eq_u32 s3, 3
    s_cbranch_scc0 L_pdone_32
    s_mov_b64 exec, 0xffff
    v_lshlrev_b32 v6, 2, v1
L_poll_31:
    buffer_load_dword v5, v6, s[72:75], s13 offen sc1
    s_waitcnt vmcnt(0)
    v_cmp_ne_u32 vcc, s98, v5
    s_cbranch_vccz L_pdone_32_x
    s_sleep 2
    s_branch L_poll_31
L_pdone_32_x:
    s_mov_b64 exec, -1
L_pdone_32:
    s_barrier
    s_add_u32 s11, s9, 0
    s_add_u32 m0, s10, 0
    s_nop 0
    buffer_load_dwordx4 v9, s[48:51], s11 offen lds
    s_add_u32 s11, s9, 1024
    s_add_u32 m0, s10, 1024
    s_nop 0
    buffer_load_dwordx4 v9, s[48:51], s11 offen lds
    s_add_u32 s11, s9, 2048
    s_add_u32 m0, s10, 2048
    s_nop 0
    buffer_load_dwordx4 v9, s[48:51], s11 offen lds
    s_add_u32 s11, s9, 3072
    s_add_u32 m0, s10, 3072
    s_nop 0
    buffer_load_dwordx4 v9, s[48:51], s11 offen lds
    s_add_u32 s11, s9, 4096
    s_add_u32 m0, s10, 4096
    s_nop 0
    buffer_load_dwordx4 v9, s[48:51], s11 offen lds
    s_add_u32 s11, s9, 5120
    s_add_u32 m0, s10, 5120
    s_nop 0
    buffer_load_dwordx4 v9, s[48:51], s11 offen lds
    s_add_u32 s11, s9, 6144
    s_add_u32 m0, s10, 6144
    s_nop 0
    buffer_load_dwordx4 v9, s[48:51], s11 offen lds
    s_add_u32 s11, s9, 7168
    s_add_u32 m0, s10, 7168
    s_nop 0
    buffer_load_dwordx4 v9, s[48:51], s11 offen lds
    s_add_u32 s11, s9, 8192
    s_add_u32 m0, s10, 8192
    s_nop 0
    buffer_load_dwordx4 v9, s[48:51], s11 offen lds
    s_add_u32 s11, s9, 9216
    s_add_u32 m0, s10, 9216
    s_nop 0
    buffer_load_dwordx4 v9, s[48:51], s11 offen lds
    s_add_u32 s11, s9, 10240
    s_add_u32 m0, s10, 10240
    s_nop 0
    buffer_load_dwordx4 v9, s[48:51], s11 offen lds
    s_add_u32 s11, s9, 11264
    s_add_u32 m0, s10, 11264
    s_nop 0
    buffer_load_dwordx4 v9, s[48:51], s11 offen lds
    s_add_u32 s11, s9, 12288
    s_add_u32 m0, s10, 12288
    s_nop 0
    buffer_load_dwordx4 v9, s[48:51], s11 offen lds
    s_add_u32 s11, s9, 13312
    s_add_u32 m0, s10, 13312
    s_nop 0
    buffer_load_dwordx4 v9, s[48:51], s11 offen lds
    s_add_u32 s11, s9, 14336
    s_add_u32 m0, s10, 14336
    s_nop 0
    buffer_load_dwordx4 v9, s[48:51], s11 offen lds
    s_add_u32 s11, s9, 15360
    s_add_u32 m0, s10, 15360
    s_nop 0
    buffer_load_dwordx4 v9, s[48:51], s11 offen lds
    buffer_load_dwordx4 v[40:43], v9, s[40:43], s12 offen
    buffer_load_dwordx4 v[44:47], v9, s[40:43], s12 offen offset:1024
    s_lshl_b32 s11, s6, 15
    v_add_u32 v10, s11, v9
    s_lshl_b32 s11, s7, 15
    s_add_u32 s11, s11, 65536
    v_add_u32 v11, s11, v9
    s_waitcnt vmcnt(2)
    s_barrier
    ds_read_b128 v[64:67], v10 offset:0
    ds_read_b128 v[68:71], v11 offset:0
    ds_read_b128 v[72:75], v10 offset:1024
    ds_read_b128 v[76:79], v11 offset:1024
    ds_read_b128 v[80:83], v10 offset:2048
    ds_read_b128 v[84:87], v11 offset:2048
    ds_read_b128 v[88:91], v10 offset:3072
    ds_read_b128 v[92:95], v11 offset:3072
    ds_read_b128 v[96:99], v10 offset:4096
    ds_read_b128 v[100:103], v11 offset:4096
    ds_read_b128 v[104:107], v10 offset:5120
    ds_read_b128 v[108:111], v11 offset:5120
    s_waitcnt lgkmcnt(10)
    v_mfma_f32_32x32x16_bf16 v[16:31], v[68:71], v[64:67], 0
    ds_read_b128 v[64:67], v10 offset:6144
    ds_read_b128 v[68:71], v11 offset:6144
    s_waitcnt lgkmcnt(10)
    v_mfma_f32_32x32x16_bf16 v[16:31], v[76:79], v[72:75], v[16:31]
    ds_read_b128 v[72:75], v10 offset:7168
    ds_read_b128 v[76:79], v11 offset:7168
    s_waitcnt lgkmcnt(10)
    v_mfma_f32_32x32x16_bf16 v[16:31], v[84:87], v[80:83], v[16:31]
    ds_read_b128 v[80:83], v10 offset:8192
    ds_read_b128 v[84:87], v11 offset:8192
    s_waitcnt lgkmcnt(10)
    v_mfma_f32_32x32x16_bf16 v[16:31], v[92:95], v[88:91], v[16:31]
    ds_read_b128 v[88:91], v10 offset:9216
    ds_read_b128 v[92:95], v11 offset:9216
    s_waitcnt lgkmcnt(10)
    v_mfma_f32_32x32x16_bf16 v[16:31], v[100:103], v[96:99], v[16:31]
    ds_read_b128 v[96:99], v10 offset:10240
    ds_read_b128 v[100:103], v11 offset:10240
    s_waitcnt lgkmcnt(10)
    v_mfma_f32_32x32x16_bf16 v[16:31], v[108:111], v[104:107], v[16:31]
    ds_read_b128 v[104:107], v10 offset:11264
    ds_read_b128 v[108:111], v11 offset:11264
    s_waitcnt lgkmcnt(10)
    v_mfma_f32_32x32x16_bf16 v[16:31], v[68:71], v[64:67], v[16:31]
    ds_read_b128 v[64:67], v10 offset:12288
    ds_read_b128 v[68:71], v11 offset:12288
    s_waitcnt lgkmcnt(10)
    v_mfma_f32_32x32x16_bf16 v[16:31], v[76:79], v[72:75], v[16:31]
    ds_read_b128 v[72:75], v10 offset:13312
    ds_read_b128 v[76:79], v11 offset:13312
    s_waitcnt lgkmcnt(10)
    v_mfma_f32_32x32x16_bf16 v[16:31], v[84:87], v[80:83], v[16:31]
    ds_read_b128 v[80:83], v10 offset:14336
    ds_read_b128 v[84:87], v11 offset:14336
    s_waitcnt lgkmcnt(10)
    v_mfma_f32_32x32x16_bf16 v[16:31], v[92:95], v[88:91], v[16:31]
    ds_read_b128 v[88:91], v10 offset:15360
    ds_read_b128 v[92:95], v11 offset:15360
    s_waitcnt lgkmcnt(10)
    v_mfma_f32_32x32x16_bf16 v[16:31], v[100:103], v[96:99], v[16:31]
    ds_read_b128 v[96:99], v10 offset:16384
    ds_read_b128 v[100:103], v11 offset:16384
    s_waitcnt lgkmcnt(10)
    v_mfma_f32_32x32x16_bf16 v[16:31], v[108:111], v[104:107], v[16:31]
    ds_read_b128 v[104:107], v10 offset:17408
    ds_read_b128 v[108:111], v11 offset:17408
    s_waitcnt lgkmcnt(10)
    v_mfma_f32_32x32x16_bf16 v[16:31], v[68:71], v[64:67], v[16:31]
    ds_read_b128 v[64:67], v10 offset:18432
    ds_read_b128 v[68:71], v11 offset:18432
    s_waitcnt lgkmcnt(10)
    v_mfma_f32_32x32x16_bf16 v[16:31], v[76:79], v[72:75], v[16:31]
    ds_read_b128 v[72:75], v10 offset:19456
    ds_read_b128 v[76:79], v11 offset:19456
    s_waitcnt lgkmcnt(10)
    v_mfma_f32_32x32x16_bf16 v[16:31], v[84:87], v[80:83], v[16:31]
    ds_read_b128 v[80:83], v10 offset:20480
    ds_read_b128 v[84:87], v11 offset:20480
    s_waitcnt lgkmcnt(10)
    v_mfma_f32_32x32x16_bf16 v[16:31], v[92:95], v[88:91], v[16:31]
    ds_read_b128 v[88:91], v10 offset:21504
    ds_read_b128 v[92:95], v11 offset:21504
    s_waitcnt lgkmcnt(10)
    v_mfma_f32_32x32x16_bf16 v[16:31], v[100:103], v[96:99], v[16:31]
    ds_read_b128 v[96:99], v10 offset:22528
    ds_read_b128 v[100:103], v11 offset:22528
    s_waitcnt lgkmcnt(10)
    v_mfma_f32_32x32x16_bf16 v[16:31], v[108:111], v[104:107], v[16:31]
    ds_read_b128 v[104:107], v10 offset:23552
    ds_read_b128 v[108:111], v11 offset:23552
    s_waitcnt lgkmcnt(10)
    v_mfma_f32_32x32x16_bf16 v[16:31], v[68:71], v[64:67], v[16:31]
    ds_read_b128 v[64:67], v10 offset:24576
    ds_read_b128 v[68:71], v11 offset:24576
    s_waitcnt lgkmcnt(10)
    v_mfma_f32_32x32x16_bf16 v[16:31], v[76:79], v[72:75], v[16:31]
    ds_read_b128 v[72:75], v10 offset:25600
    ds_read_b128 v[76:79], v11 offset:25600
    s_waitcnt lgkmcnt(10)
    v_mfma_f32_32x32x16_bf16 v[16:31], v[84:87], v[80:83], v[16:31]
    ds_read_b128 v[80:83], v10 offset:26624
    ds_read_b128 v[84:87], v11 offset:26624
    s_waitcnt lgkmcnt(10)
    v_mfma_f32_32x32x16_bf16 v[16:31], v[92:95], v[88:91], v[16:31]
    ds_read_b128 v[88:91], v10 offset:27648
    ds_read_b128 v[92:95], v11 offset:27648
    s_waitcnt lgkmcnt(10)
    v_mfma_f32_32x32x16_bf16 v[16:31], v[100:103], v[96:99], v[16:31]
    ds_read_b128 v[96:99], v10 offset:28672
    ds_read_b128 v[100:103], v11 offset:28672
    s_waitcnt lgkmcnt(10)
    v_mfma_f32_32x32x16_bf16 v[16:31], v[108:111], v[104:107], v[16:31]
    ds_read_b128 v[104:107], v10 offset:29696
    ds_read_b128 v[108:111], v11 offset:29696
    s_waitcnt lgkmcnt(10)
    v_mfma_f32_32x32x16_bf16 v[16:31], v[68:71], v[64:67], v[16:31]
    ds_read_b128 v[64:67], v10 offset:30720
    ds_read_b128 v[68:71], v11 offset:30720
    s_waitcnt lgkmcnt(10)
    v_mfma_f32_32x32x16_bf16 v[16:31], v[76:79], v[72:75], v[16:31]
    ds_read_b128 v[72:75], v10 offset:31744
    ds_read_b128 v[76:79], v11 offset:31744
    s_waitcnt lgkmcnt(10)
    v_mfma_f32_32x32x16_bf16 v[16:31], v[84:87], v[80:83], v[16:31]
    s_waitcnt lgkmcnt(8)
    v_mfma_f32_32x32x16_bf16 v[16:31], v[92:95], v[88:91], v[16:31]
    s_waitcnt lgkmcnt(6)
    v_mfma_f32_32x32x16_bf16 v[16:31], v[100:103], v[96:99], v[16:31]
    s_waitcnt lgkmcnt(4)
    v_mfma_f32_32x32x16_bf16 v[16:31], v[108:111], v[104:107], v[16:31]
    s_waitcnt lgkmcnt(2)
    v_mfma_f32_32x32x16_bf16 v[16:31], v[68:71], v[64:67], v[16:31]
    s_waitcnt lgkmcnt(0)
    v_mfma_f32_32x32x16_bf16 v[16:31], v[76:79], v[72:75], v[16:31]
    s_barrier
    s_waitcnt vmcnt(0)
    v_permlane32_swap_b32 v40, v42
    v_permlane32_swap_b32 v41, v43
    v_permlane32_swap_b32 v44, v46
    v_permlane32_swap_b32 v45, v47
    s_nop 11
    v_lshlrev_b32 v14, 16, v40
    v_and_b32 v15, 0xffff0000, v40
    v_add_f32 v16, v16, v14
    v_add_f32 v17, v17, v15
    v_cvt_pk_bf16_f32 v40, v16, v17
    v_lshlrev_b32 v14, 16, v41
    v_and_b32 v15, 0xffff0000, v41
    v_add_f32 v18, v18, v14
    v_add_f32 v19, v19, v15
    v_cvt_pk_bf16_f32 v41, v18, v19
    v_lshlrev_b32 v14, 16, v42
    v_and_b32 v15, 0xffff0000, v42
    v_add_f32 v20, v20, v14
    v_add_f32 v21, v21, v15
    v_cvt_pk_bf16_f32 v42, v20, v21
    v_lshlrev_b32 v14, 16, v43
    v_and_b32 v15, 0xffff0000, v43
    v_add_f32 v22, v22, v14
    v_add_f32 v23, v23, v15
    v_cvt_pk_bf16_f32 v43, v22, v23
    v_lshlrev_b32 v14, 16, v44
    v_and_b32 v15, 0xffff0000, v44
    v_add_f32 v24, v24, v14
    v_add_f32 v25, v25, v15
    v_cvt_pk_bf16_f32 v44, v24, v25
    v_lshlrev_b32 v14, 16, v45
    v_and_b32 v15, 0xffff0000, v45
    v_add_f32 v26, v26, v14
    v_add_f32 v27, v27, v15
    v_cvt_pk_bf16_f32 v45, v26, v27
    v_lshlrev_b32 v14, 16, v46
    v_and_b32 v15, 0xffff0000, v46
    v_add_f32 v28, v28, v14
    v_add_f32 v29, v29, v15
    v_cvt_pk_bf16_f32 v46, v28, v29
    v_lshlrev_b32 v14, 16, v47
    v_and_b32 v15, 0xffff0000, v47
    v_add_f32 v30, v30, v14
    v_add_f32 v31, v31, v15
    v_cvt_pk_bf16_f32 v47, v30, v31
    s_nop 0
    v_permlane32_swap_b32 v40, v42
    v_permlane32_swap_b32 v41, v43
    v_permlane32_swap_b32 v44, v46
    v_permlane32_swap_b32 v45, v47
    buffer_store_dwordx4 v[40:43], v9, s[52:55], s12 offen offset:0 sc1
    buffer_store_dwordx4 v[44:47], v9, s[52:55], s12 offen offset:1024 sc1
    s_lshr_b32 s62, s4, 1
    s_lshl_b32 s62, s62, 7
    s_and_b32 s63, s4, 1
    s_mul_i32 s63, s63, 7
    s_add_u32 s63, s63, s5
    s_lshl_b32 s63, s63, 2
    s_add_u32 s62, s62, s63
    s_add_u32 s62, s62, 10240
    s_waitcnt vmcnt(0) lgkmcnt(0)
    s_barrier
    s_cmp_eq_u32 s3, 0
    s_cbranch_scc0 L_sig_33
    v_mov_b32 v5, s98
    v_mov_b32 v6, 0
    s_mov_b64 exec, 1
    buffer_store_dword v5, v6, s[72:75], s62 offen sc1
    s_mov_b64 exec, -1
L_sig_33:
    s_lshr_b32 s8, s2, 4
    s_add_u32 s44, s38, 0x2400000
    s_addc_u32 s45, s39, 0
    s_and_b32 s45, s45, 0xffff
    s_mov_b32 s46, 0x188000
    s_mov_b32 s47, 0x20000
    s_mul_i32 s8, s8, 114688
    s_lshl_b32 s10, s3, 10
    s_add_u32 s8, s8, s10
    s_add_u32 s12, s8, 0
    s_add_u32 m0, s10, 0
    s_nop 0
    buffer_load_dwordx4 v9, s[44:47], s12 offen lds
    s_add_u32 s12, s8, 4096
    s_add_u32 m0, s10, 4096
    s_nop 0
    buffer_load_dwordx4 v9, s[44:47], s12 offen lds
    s_add_u32 s12, s8, 8192
    s_add_u32 m0, s10, 8192
    s_nop 0
    buffer_load_dwordx4 v9, s[44:47], s12 offen lds
    s_add_u32 s12, s8, 12288
    s_add_u32 m0, s10, 12288
    s_nop 0
    buffer_load_dwordx4 v9, s[44:47], s12 offen lds
    s_add_u32 s12, s8, 16384
    s_add_u32 m0, s10, 16384
    s_nop 0
    buffer_load_dwordx4 v9, s[44:47], s12 offen lds
    s_add_u32 s12, s8, 20480
    s_add_u32 m0, s10, 20480
    s_nop 0
    buffer_load_dwordx4 v9, s[44:47], s12 offen lds
    s_add_u32 s12, s8, 24576
    s_add_u32 m0, s10, 24576
    s_nop 0
    buffer_load_dwordx4 v9, s[44:47], s12 offen lds
    s_add_u32 s12, s8, 28672
    s_add_u32 m0, s10, 28672
    s_nop 0
    buffer_load_dwordx4 v9, s[44:47], s12 offen lds
    s_add_u32 s12, s8, 32768
    s_add_u32 m0, s10, 32768
    s_nop 0
    buffer_load_dwordx4 v9, s[44:47], s12 offen lds
    s_add_u32 s12, s8, 36864
    s_add_u32 m0, s10, 36864
    s_nop 0
    buffer_load_dwordx4 v9, s[44:47], s12 offen lds
    s_add_u32 s12, s8, 40960
    s_add_u32 m0, s10, 40960
    s_nop 0
    buffer_load_dwordx4 v9, s[44:47], s12 offen lds
    s_add_u32 s12, s8, 45056
    s_add_u32 m0, s10, 45056
    s_nop 0
    buffer_load_dwordx4 v9, s[44:47], s12 offen lds
    s_add_u32 s12, s8, 49152
    s_add_u32 m0, s10, 49152
    s_nop 0
    buffer_load_dwordx4 v9, s[44:47], s12 offen lds
    s_add_u32 s12, s8, 53248
    s_add_u32 m0, s10, 53248
    s_nop 0
    buffer_load_dwordx4 v9, s[44:47], s12 offen lds
    s_add_u32 s12, s8, 57344
    s_add_u32 m0, s10, 57344
    s_nop 0
    buffer_load_dwordx4 v9, s[44:47], s12 offen lds
    s_add_u32 s12, s8, 61440
    s_add_u32 m0, s10, 61440
    s_nop 0
    buffer_load_dwordx4 v9, s[44:47], s12 offen lds
    s_add_u32 s12, s8, 65536
    s_add_u32 m0, s10, 65536
    s_nop 0
    buffer_load_dwordx4 v9, s[44:47], s12 offen lds
    s_add_u32 s12, s8, 69632
    s_add_u32 m0, s10, 69632
    s_nop 0
    buffer_load_dwordx4 v9, s[44:47], s12 offen lds
    s_add_u32 s12, s8, 73728
    s_add_u32 m0, s10, 73728
    s_nop 0
    buffer_load_dwordx4 v9, s[44:47], s12 offen lds
    s_add_u32 s12, s8, 77824
    s_add_u32 m0, s10, 77824
    s_nop 0
    buffer_load_dwordx4 v9, s[44:47], s12 offen lds
    s_add_u32 s12, s8, 81920
    s_add_u32 m0, s10, 81920
    s_nop 0
    buffer_load_dwordx4 v9, s[44:47], s12 offen lds
    s_add_u32 s12, s8, 86016
    s_add_u32 m0, s10, 86016
    s_nop 0
    buffer_load_dwordx4 v9, s[44:47], s12 offen lds
    s_add_u32 s12, s8, 90112
    s_add_u32 m0, s10, 90112
    s_nop 0
    buffer_load_dwordx4 v9, s[44:47], s12 offen lds
    s_add_u32 s12, s8, 94208
    s_add_u32 m0, s10, 94208
    s_nop 0
    buffer_load_dwordx4 v9, s[44:47], s12 offen lds
    s_add_u32 s12, s8, 98304
    s_add_u32 m0, s10, 98304
    s_nop 0
    buffer_load_dwordx4 v9, s[44:47], s12 offen lds
    s_add_u32 s12, s8, 102400
    s_add_u32 m0, s10, 102400
    s_nop 0
    buffer_load_dwordx4 v9, s[44:47], s12 offen lds
    s_add_u32 s12, s8, 106496
    s_add_u32 m0, s10, 106496
    s_nop 0
    buffer_load_dwordx4 v9, s[44:47], s12 offen lds
    s_add_u32 s12, s8, 110592
    s_add_u32 m0, s10, 110592
    s_nop 0
    buffer_load_dwordx4 v9, s[44:47], s12 offen lds
k2l1_end:
    s_cmp_ge_u32 s2, 224
    s_cbranch_scc1 k3l1_end
    s_and_b32 s4, s2, 7
    s_lshr_b32 s5, s2, 3
    s_lshr_b32 s6, s5, 1
    s_and_b32 s5, s5, 1
    s_lshl_b32 s4, s4, 1
    s_add_u32 s4, s4, s5
    s_mov_b32 s5, s6
    s_add_u32 s40, s38, 0x400000
    s_addc_u32 s41, s39, 0
    s_and_b32 s41, s41, 0xffff
    s_mov_b32 s42, 0x1c0000
    s_mov_b32 s43, 0x20000
    s_add_u32 s44, s38, 0x2400000
    s_addc_u32 s45, s39, 0
    s_and_b32 s45, s45, 0xffff
    s_mov_b32 s46, 0x188000
    s_mov_b32 s47, 0x20000
    s_mov_b32 s48, s28
    s_mov_b32 s49, s29
    s_and_b32 s49, s49, 0xffff
    s_mov_b32 s50, 0xe00
    s_mov_b32 s51, 0x20000
    s_add_u32 s52, s38, 0x1a00000
    s_addc_u32 s53, s39, 0
    s_and_b32 s53, s53, 0xffff
    s_mov_b32 s54, 0x700000
    s_mov_b32 s55, 0x20000
    s_add_u32 s56, s38, 0x2902000
    s_addc_u32 s57, s39, 0
    s_and_b32 s57, s57, 0xffff
    s_mov_b32 s58, 0x2000
    s_mov_b32 s59, 0x20000
    v_lshlrev_b32 v9, 4, v1
    s_lshl_b32 s6, s4, 2
    s_add_u32 s6, s6, s3
    v_lshlrev_b32 v8, 3, v4
    s_lshl_b32 s11, s5, 8
    buffer_load_dwordx2 v[32:33], v8, s[48:51], s11 offen offset:0
    buffer_load_dwordx2 v[34:35], v8, s[48:51], s11 offen offset:16
    buffer_load_dwordx2 v[36:37], v8, s[48:51], s11 offen offset:32
    buffer_load_dwordx2 v[38:39], v8, s[48:51], s11 offen offset:48
    buffer_load_dwordx2 v[40:41], v8, s[48:51], s11 offen offset:64
    buffer_load_dwordx2 v[42:43], v8, s[48:51], s11 offen offset:80
    buffer_load_dwordx2 v[44:45], v8, s[48:51], s11 offen offset:96
    buffer_load_dwordx2 v[46:47], v8, s[48:51], s11 offen offset:112
    buffer_load_dwordx2 v[48:49], v8, s[48:51], s11 offen offset:128
    buffer_load_dwordx2 v[50:51], v8, s[48:51], s11 offen offset:144
    buffer_load_dwordx2 v[52:53], v8, s[48:51], s11 offen offset:160
    buffer_load_dwordx2 v[54:55], v8, s[48:51], s11 offen offset:176
    buffer_load_dwordx2 v[56:57], v8, s[48:51], s11 offen offset:192
    buffer_load_dwordx2 v[58:59], v8, s[48:51], s11 offen offset:208
    buffer_load_dwordx2 v[60:61], v8, s[48:51], s11 offen offset:224
    buffer_load_dwordx2 v[62:63], v8, s[48:51], s11 offen offset:240
    v_add_u32 v10, 57344, v9
    v_lshlrev_b32 v7, 4, v4
    s_lshl_b32 s14, s5, 9
    s_lshl_b32 s12, s4, 7
    s_add_u32 s12, s12, 10240
    s_cmp_eq_u32 s3, 3
    s_cbranch_scc0 L_pdone_35
    s_mov_b64 exec, 0x3fff
    v_lshlrev_b32 v6, 2, v1
L_poll_34:
    buffer_load_dword v5, v6, s[72:75], s12 offen sc1
    s_waitcnt vmcnt(0)
    v_cmp_ne_u32 vcc, s98, v5
    s_cbranch_vccz L_pdone_35_x
    s_sleep 2
    s_branch L_poll_34
L_pdone_35_x:
    s_mov_b64 exec, -1
L_pdone_35:
    s_barrier
    s_mul_i32 s7, s6, 28672
    buffer_load_dwordx4 v[64:67], v9, s[40:43], s7 offen offset:0
    buffer_load_dwordx4 v[68:71], v9, s[40:43], s7 offen offset:1024
    buffer_load_dwordx4 v[72:75], v9, s[40:43], s7 offen offset:2048
    buffer_load_dwordx4 v[76:79], v9, s[40:43], s7 offen offset:3072
    s_add_u32 s7, s7, 4096
    buffer_load_dwordx4 v[80:83], v9, s[40:43], s7 offen offset:0
    buffer_load_dwordx4 v[84:87], v9, s[40:43], s7 offen offset:1024
    buffer_load_dwordx4 v[88:91], v9, s[40:43], s7 offen offset:2048
    buffer_load_dwordx4 v[92:95], v9, s[40:43], s7 offen offset:3072
    s_add_u32 s7, s7, 4096
    buffer_load_dwordx4 v[96:99], v9, s[40:43], s7 offen offset:0
    buffer_load_dwordx4 v[100:103], v9, s[40:43], s7 offen offset:1024
    buffer_load_dwordx4 v[104:107], v9, s[40:43], s7 offen offset:2048
    buffer_load_dwordx4 v[108:111], v9, s[40:43], s7 offen offset:3072
    s_add_u32 s7, s7, 4096
    buffer_load_dwordx4 v[112:115], v9, s[40:43], s7 offen offset:0
    buffer_load_dwordx4 v[116:119], v9, s[40:43], s7 offen offset:1024
    buffer_load_dwordx4 v[120:123], v9, s[40:43], s7 offen offset:2048
    buffer_load_dwordx4 v[124:127], v9, s[40:43], s7 offen offset:3072
    s_add_u32 s7, s7, 4096
    buffer_load_dwordx4 v[128:131], v9, s[40:43], s7 offen offset:0
    buffer_load_dwordx4 v[132:135], v9, s[40:43], s7 offen offset:1024
    buffer_load_dwordx4 v[136:139], v9, s[40:43], s7 offen offset:2048
    buffer_load_dwordx4 v[140:143], v9, s[40:43], s7 offen offset:3072
    s_add_u32 s7, s7, 4096
    buffer_load_dwordx4 v[144:147], v9, s[40:43], s7 offen offset:0
    buffer_load_dwordx4 v[148:151], v9, s[40:43], s7 offen offset:1024
    buffer_load_dwordx4 v[152:155], v9, s[40:43], s7 offen offset:2048
    buffer_load_dwordx4 v[156:159], v9, s[40:43], s7 offen offset:3072
    s_add_u32 s7, s7, 4096
    buffer_load_dwordx4 v[160:163], v9, s[40:43], s7 offen offset:0
    buffer_load_dwordx4 v[164:167], v9, s[40:43], s7 offen offset:1024
    buffer_load_dwordx4 v[168:171], v9, s[40:43], s7 offen offset:2048
    buffer_load_dwordx4 v[172:175], v9, s[40:43], s7 offen offset:3072
    v_mov_b32 v21, 0xbdd2d3e8
    s_mul_i32 s15, s6, 114688
    s_lshl_b32 s13, s5, 13
    s_add_u32 s15, s15, s13
    s_add_u32 s63, s15, 4096
    v_mov_b32 v14, 0
    v_mov_b32 v15, 0
    s_waitcnt vmcnt(28)
    s_barrier
    ds_read_b128 v[208:211], v9 offset:0
    ds_read_b128 v[212:215], v9 offset:1024
    ds_read_b128 v[216:219], v9 offset:2048
    buffer_load_dwordx4 v[224:227], v7, s[56:59], s14 offen offset:0
    buffer_load_dwordx4 v[228:231], v7, s[56:59], s14 offen offset:32
    buffer_load_dwordx4 v[232:235], v7, s[56:59], s14 offen offset:64
    buffer_load_dwordx4 v[236:239], v7, s[56:59], s14 offen offset:96
    ds_read_b128 v[220:223], v9 offset:3072
    s_waitcnt vmcnt(31) lgkmcnt(3)
    v_mfma_f32_32x32x16_bf16 v[176:191], v[208:211], v[64:67], 0
    ds_read_b128 v[208:211], v9 offset:4096
    s_waitcnt vmcnt(30) lgkmcnt(3)
    v_mfma_f32_32x32x16_bf16 v[176:191], v[212:215], v[68:71], v[176:191]
    ds_read_b128 v[212:215], v9 offset:5120
    s_waitcnt vmcnt(29) lgkmcnt(3)
    v_mfma_f32_32x32x16_bf16 v[176:191], v[216:219], v[72:75], v[176:191]
    ds_read_b128 v[216:219], v9 offset:6144
    s_waitcnt vmcnt(28) lgkmcnt(3)
    v_mfma_f32_32x32x16_bf16 v[176:191], v[220:223], v[76:79], v[176:191]
    ds_read_b128 v[220:223], v9 offset:7168
    s_waitcnt vmcnt(27) lgkmcnt(3)
    v_mfma_f32_32x32x16_bf16 v[176:191], v[208:211], v[80:83], v[176:191]
    ds_read_b128 v[208:211], v9 offset:8192
    s_waitcnt vmcnt(26) lgkmcnt(3)
    v_mfma_f32_32x32x16_bf16 v[176:191], v[212:215], v[84:87], v[176:191]
    ds_read_b128 v[212:215], v9 offset:9216
    s_waitcnt vmcnt(25) lgkmcnt(3)
    v_mfma_f32_32x32x16_bf16 v[176:191], v[216:219], v[88:91], v[176:191]
    ds_read_b128 v[216:219], v9 offset:10240
    s_waitcnt vmcnt(24) lgkmcnt(3)
    v_mfma_f32_32x32x16_bf16 v[176:191], v[220:223], v[92:95], v[176:191]
    ds_read_b128 v[220:223], v9 offset:11264
    s_waitcnt vmcnt(23) lgkmcnt(3)
    v_mfma_f32_32x32x16_bf16 v[176:191], v[208:211], v[96:99], v[176:191]
    ds_read_b128 v[208:211], v9 offset:12288
    s_waitcnt vmcnt(22) lgkmcnt(3)
    v_mfma_f32_32x32x16_bf16 v[176:191], v[212:215], v[100:103], v[176:191]
    ds_read_b128 v[212:215], v9 offset:13312
    s_waitcnt vmcnt(21) lgkmcnt(3)
    v_mfma_f32_32x32x16_bf16 v[176:191], v[216:219], v[104:107], v[176:191]
    ds_read_b128 v[216:219], v9 offset:14336
    s_waitcnt vmcnt(20) lgkmcnt(3)
    v_mfma_f32_32x32x16_bf16 v[176:191], v[220:223], v[108:111], v[176:191]
    ds_read_b128 v[220:223], v9 offset:15360
    s_waitcnt vmcnt(19) lgkmcnt(3)
    v_mfma_f32_32x32x16_bf16 v[176:191], v[208:211], v[112:115], v[176:191]
    ds_read_b128 v[208:211], v9 offset:16384
    s_waitcnt vmcnt(18) lgkmcnt(3)
    v_mfma_f32_32x32x16_bf16 v[176:191], v[212:215], v[116:119], v[176:191]
    ds_read_b128 v[212:215], v9 offset:17408
    s_waitcnt vmcnt(17) lgkmcnt(3)
    v_mfma_f32_32x32x16_bf16 v[176:191], v[216:219], v[120:123], v[176:191]
    ds_read_b128 v[216:219], v9 offset:18432
    s_waitcnt vmcnt(16) lgkmcnt(3)
    v_mfma_f32_32x32x16_bf16 v[176:191], v[220:223], v[124:127], v[176:191]
    ds_read_b128 v[220:223], v9 offset:19456
    s_waitcnt vmcnt(15) lgkmcnt(3)
    v_mfma_f32_32x32x16_bf16 v[176:191], v[208:211], v[128:131], v[176:191]
    ds_read_b128 v[208:211], v9 offset:20480
    s_waitcnt vmcnt(14) lgkmcnt(3)
    v_mfma_f32_32x32x16_bf16 v[176:191], v[212:215], v[132:135], v[176:191]
    ds_read_b128 v[212:215], v9 offset:21504
    s_waitcnt vmcnt(13) lgkmcnt(3)
    v_mfma_f32_32x32x16_bf16 v[176:191], v[216:219], v[136:139], v[176:191]
    ds_read_b128 v[216:219], v9 offset:22528
    s_waitcnt vmcnt(12) lgkmcnt(3)
    v_mfma_f32_32x32x16_bf16 v[176:191], v[220:223], v[140:143], v[176:191]
    ds_read_b128 v[220:223], v9 offset:23552
    s_waitcnt vmcnt(11) lgkmcnt(3)
    v_mfma_f32_32x32x16_bf16 v[176:191], v[208:211], v[144:147], v[176:191]
    ds_read_b128 v[208:211], v9 offset:24576
    s_waitcnt vmcnt(10) lgkmcnt(3)
    v_mfma_f32_32x32x16_bf16 v[176:191], v[212:215], v[148:151], v[176:191]
    ds_read_b128 v[212:215], v9 offset:25600
    s_waitcnt vmcnt(9) lgkmcnt(3)
    v_mfma_f32_32x32x16_bf16 v[176:191], v[216:219], v[152:155], v[176:191]
    ds_read_b128 v[216:219], v9 offset:26624
    s_waitcnt vmcnt(8) lgkmcnt(3)
    v_mfma_f32_32x32x16_bf16 v[176:191], v[220:223], v[156:159], v[176:191]
    ds_read_b128 v[220:223], v9 offset:27648
    s_waitcnt vmcnt(7) lgkmcnt(3)
    v_mfma_f32_32x32x16_bf16 v[176:191], v[208:211], v[160:163], v[176:191]
    ds_read_b128 v[208:211], v9 offset:28672
    s_waitcnt vmcnt(6) lgkmcnt(3)
    v_mfma_f32_32x32x16_bf16 v[176:191], v[212:215], v[164:167], v[176:191]
    ds_read_b128 v[212:215], v9 offset:29696
    s_waitcnt vmcnt(5) lgkmcnt(3)
    v_mfma_f32_32x32x16_bf16 v[176:191], v[216:219], v[168:171], v[176:191]
    ds_read_b128 v[216:219], v9 offset:30720
    s_waitcnt vmcnt(4) lgkmcnt(3)
    v_mfma_f32_32x32x16_bf16 v[176:191], v[220:223], v[172:175], v[176:191]
    v_mov_b32 v16, 0x3f803f80
    v_mov_b32 v14, 0
    v_mov_b32 v15, 0
    v_dot2_f32_bf16 v14, v64, v16, v14
    v_dot2_f32_bf16 v15, v64, v64, v15
    v_dot2_f32_bf16 v14, v65, v16, v14
    v_dot2_f32_bf16 v15, v65, v65, v15
    v_dot2_f32_bf16 v14, v66, v16, v14
    v_dot2_f32_bf16 v15, v66, v66, v15
    v_dot2_f32_bf16 v14, v67, v16, v14
    v_dot2_f32_bf16 v15, v67, v67, v15
    v_dot2_f32_bf16 v14, v68, v16, v14
    v_dot2_f32_bf16 v15, v68, v68, v15
    v_dot2_f32_bf16 v14, v69, v16, v14
    v_dot2_f32_bf16 v15, v69, v69, v15
    v_dot2_f32_bf16 v14, v70, v16, v14
    v_dot2_f32_bf16 v15, v70, v70, v15
    v_dot2_f32_bf16 v14, v71, v16, v14
    v_dot2_f32_bf16 v15, v71, v71, v15
    v_dot2_f32_bf16 v14, v72, v16, v14
    v_dot2_f32_bf16 v15, v72, v72, v15
    v_dot2_f32_bf16 v14, v73, v16, v14
    v_dot2_f32_bf16 v15, v73, v73, v15
    v_dot2_f32_bf16 v14, v74, v16, v14
    v_dot2_f32_bf16 v15, v74, v74, v15
    v_dot2_f32_bf16 v14, v75, v16, v14
    v_dot2_f32_bf16 v15, v75, v75, v15
    v_dot2_f32_bf16 v14, v76, v16, v14
    v_dot2_f32_bf16 v15, v76, v76, v15
    v_dot2_f32_bf16 v14, v77, v16, v14
    v_dot2_f32_bf16 v15, v77, v77, v15
    v_dot2_f32_bf16 v14, v78, v16, v14
    v_dot2_f32_bf16 v15, v78, v78, v15
    v_dot2_f32_bf16 v14, v79, v16, v14
    v_dot2_f32_bf16 v15, v79, v79, v15
    v_dot2_f32_bf16 v14, v80, v16, v14
    v_dot2_f32_bf16 v15, v80, v80, v15
    v_dot2_f32_bf16 v14, v81, v16, v14
    v_dot2_f32_bf16 v15, v81, v81, v15
    v_dot2_f32_bf16 v14, v82, v16, v14
    v_dot2_f32_bf16 v15, v82, v82, v15
    v_dot2_f32_bf16 v14, v83, v16, v14
    v_dot2_f32_bf16 v15, v83, v83, v15
    v_dot2_f32_bf16 v14, v84, v16, v14
    v_dot2_f32_bf16 v15, v84, v84, v15
    v_dot2_f32_bf16 v14, v85, v16, v14
    v_dot2_f32_bf16 v15, v85, v85, v15
    v_dot2_f32_bf16 v14, v86, v16, v14
    v_dot2_f32_bf16 v15, v86, v86, v15
    v_dot2_f32_bf16 v14, v87, v16, v14
    v_dot2_f32_bf16 v15, v87, v87, v15
    v_dot2_f32_bf16 v14, v88, v16, v14
    v_dot2_f32_bf16 v15, v88, v88, v15
    v_dot2_f32_bf16 v14, v89, v16, v14
    v_dot2_f32_bf16 v15, v89, v89, v15
    v_dot2_f32_bf16 v14, v90, v16, v14
    v_dot2_f32_bf16 v15, v90, v90, v15
    v_dot2_f32_bf16 v14, v91, v16, v14
    v_dot2_f32_bf16 v15, v91, v91, v15
    v_dot2_f32_bf16 v14, v92, v16, v14
    v_dot2_f32_bf16 v15, v92, v92, v15
    v_dot2_f32_bf16 v14, v93, v16, v14
    v_dot2_f32_bf16 v15, v93, v93, v15
    v_dot2_f32_bf16 v14, v94, v16, v14
    v_dot2_f32_bf16 v15, v94, v94, v15
    v_dot2_f32_bf16 v14, v95, v16, v14
    v_dot2_f32_bf16 v15, v95, v95, v15
    v_dot2_f32_bf16 v14, v96, v16, v14
    v_dot2_f32_bf16 v15, v96, v96, v15
    v_dot2_f32_bf16 v14, v97, v16, v14
    v_dot2_f32_bf16 v15, v97, v97, v15
    v_dot2_f32_bf16 v14, v98, v16, v14
    v_dot2_f32_bf16 v15, v98, v98, v15
    v_dot2_f32_bf16 v14, v99, v16, v14
    v_dot2_f32_bf16 v15, v99, v99, v15
    v_dot2_f32_bf16 v14, v100, v16, v14
    v_dot2_f32_bf16 v15, v100, v100, v15
    v_dot2_f32_bf16 v14, v101, v16, v14
    v_dot2_f32_bf16 v15, v101, v101, v15
    v_dot2_f32_bf16 v14, v102, v16, v14
    v_dot2_f32_bf16 v15, v102, v102, v15
    v_dot2_f32_bf16 v14, v103, v16, v14
    v_dot2_f32_bf16 v15, v103, v103, v15
    v_dot2_f32_bf16 v14, v104, v16, v14
    v_dot2_f32_bf16 v15, v104, v104, v15
    v_dot2_f32_bf16 v14, v105, v16, v14
    v_dot2_f32_bf16 v15, v105, v105, v15
    v_dot2_f32_bf16 v14, v106, v16, v14
    v_dot2_f32_bf16 v15, v106, v106, v15
    v_dot2_f32_bf16 v14, v107, v16, v14
    v_dot2_f32_bf16 v15, v107, v107, v15
    v_dot2_f32_bf16 v14, v108, v16, v14
    v_dot2_f32_bf16 v15, v108, v108, v15
    v_dot2_f32_bf16 v14, v109, v16, v14
    v_dot2_f32_bf16 v15, v109, v109, v15
    v_dot2_f32_bf16 v14, v110, v16, v14
    v_dot2_f32_bf16 v15, v110, v110, v15
    v_dot2_f32_bf16 v14, v111, v16, v14
    v_dot2_f32_bf16 v15, v111, v111, v15
    v_dot2_f32_bf16 v14, v112, v16, v14
    v_dot2_f32_bf16 v15, v112, v112, v15
    v_dot2_f32_bf16 v14, v113, v16, v14
    v_dot2_f32_bf16 v15, v113, v113, v15
    v_dot2_f32_bf16 v14, v114, v16, v14
    v_dot2_f32_bf16 v15, v114, v114, v15
    v_dot2_f32_bf16 v14, v115, v16, v14
    v_dot2_f32_bf16 v15, v115, v115, v15
    v_dot2_f32_bf16 v14, v116, v16, v14
    v_dot2_f32_bf16 v15, v116, v116, v15
    v_dot2_f32_bf16 v14, v117, v16, v14
    v_dot2_f32_bf16 v15, v117, v117, v15
    v_dot2_f32_bf16 v14, v118, v16, v14
    v_dot2_f32_bf16 v15, v118, v118, v15
    v_dot2_f32_bf16 v14, v119, v16, v14
    v_dot2_f32_bf16 v15, v119, v119, v15
    v_dot2_f32_bf16 v14, v120, v16, v14
    v_dot2_f32_bf16 v15, v120, v120, v15
    v_dot2_f32_bf16 v14, v121, v16, v14
    v_dot2_f32_bf16 v15, v121, v121, v15
    v_dot2_f32_bf16 v14, v122, v16, v14
    v_dot2_f32_bf16 v15, v122, v122, v15
    v_dot2_f32_bf16 v14, v123, v16, v14
    v_dot2_f32_bf16 v15, v123, v123, v15
    v_dot2_f32_bf16 v14, v124, v16, v14
    v_dot2_f32_bf16 v15, v124, v124, v15
    v_dot2_f32_bf16 v14, v125, v16, v14
    v_dot2_f32_bf16 v15, v125, v125, v15
    v_dot2_f32_bf16 v14, v126, v16, v14
    v_dot2_f32_bf16 v15, v126, v126, v15
    v_dot2_f32_bf16 v14, v127, v16, v14
    v_dot2_f32_bf16 v15, v127, v127, v15
    v_dot2_f32_bf16 v14, v128, v16, v14
    v_dot2_f32_bf16 v15, v128, v128, v15
    v_dot2_f32_bf16 v14, v129, v16, v14
    v_dot2_f32_bf16 v15, v129, v129, v15
    v_dot2_f32_bf16 v14, v130, v16, v14
    v_dot2_f32_bf16 v15, v130, v130, v15
    v_dot2_f32_bf16 v14, v131, v16, v14
    v_dot2_f32_bf16 v15, v131, v131, v15
    v_dot2_f32_bf16 v14, v132, v16, v14
    v_dot2_f32_bf16 v15, v132, v132, v15
    v_dot2_f32_bf16 v14, v133, v16, v14
    v_dot2_f32_bf16 v15, v133, v133, v15
    v_dot2_f32_bf16 v14, v134, v16, v14
    v_dot2_f32_bf16 v15, v134, v134, v15
    v_dot2_f32_bf16 v14, v135, v16, v14
    v_dot2_f32_bf16 v15, v135, v135, v15
    v_dot2_f32_bf16 v14, v136, v16, v14
    v_dot2_f32_bf16 v15, v136, v136, v15
    v_dot2_f32_bf16 v14, v137, v16, v14
    v_dot2_f32_bf16 v15, v137, v137, v15
    v_dot2_f32_bf16 v14, v138, v16, v14
    v_dot2_f32_bf16 v15, v138, v138, v15
    v_dot2_f32_bf16 v14, v139, v16, v14
    v_dot2_f32_bf16 v15, v139, v139, v15
    v_dot2_f32_bf16 v14, v140, v16, v14
    v_dot2_f32_bf16 v15, v140, v140, v15
    v_dot2_f32_bf16 v14, v141, v16, v14
    v_dot2_f32_bf16 v15, v141, v141, v15
    v_dot2_f32_bf16 v14, v142, v16, v14
    v_dot2_f32_bf16 v15, v142, v142, v15
    v_dot2_f32_bf16 v14, v143, v16, v14
    v_dot2_f32_bf16 v15, v143, v143, v15
    v_dot2_f32_bf16 v14, v144, v16, v14
    v_dot2_f32_bf16 v15, v144, v144, v15
    v_dot2_f32_bf16 v14, v145, v16, v14
    v_dot2_f32_bf16 v15, v145, v145, v15
    v_dot2_f32_bf16 v14, v146, v16, v14
    v_dot2_f32_bf16 v15, v146, v146, v15
    v_dot2_f32_bf16 v14, v147, v16, v14
    v_dot2_f32_bf16 v15, v147, v147, v15
    v_dot2_f32_bf16 v14, v148, v16, v14
    v_dot2_f32_bf16 v15, v148, v148, v15
    v_dot2_f32_bf16 v14, v149, v16, v14
    v_dot2_f32_bf16 v15, v149, v149, v15
    v_dot2_f32_bf16 v14, v150, v16, v14
    v_dot2_f32_bf16 v15, v150, v150, v15
    v_dot2_f32_bf16 v14, v151, v16, v14
    v_dot2_f32_bf16 v15, v151, v151, v15
    v_dot2_f32_bf16 v14, v152, v16, v14
    v_dot2_f32_bf16 v15, v152, v152, v15
    v_dot2_f32_bf16 v14, v153, v16, v14
    v_dot2_f32_bf16 v15, v153, v153, v15
    v_dot2_f32_bf16 v14, v154, v16, v14
    v_dot2_f32_bf16 v15, v154, v154, v15
    v_dot2_f32_bf16 v14, v155, v16, v14
    v_dot2_f32_bf16 v15, v155, v155, v15
    v_dot2_f32_bf16 v14, v156, v16, v14
    v_dot2_f32_bf16 v15, v156, v156, v15
    v_dot2_f32_bf16 v14, v157, v16, v14
    v_dot2_f32_bf16 v15, v157, v157, v15
    v_dot2_f32_bf16 v14, v158, v16, v14
    v_dot2_f32_bf16 v15, v158, v158, v15
    v_dot2_f32_bf16 v14, v159, v16, v14
    v_dot2_f32_bf16 v15, v159, v159, v15
    v_dot2_f32_bf16 v14, v160, v16, v14
    v_dot2_f32_bf16 v15, v160, v160, v15
    v_dot2_f32_bf16 v14, v161, v16, v14
    v_dot2_f32_bf16 v15, v161, v161, v15
    v_dot2_f32_bf16 v14, v162, v16, v14
    v_dot2_f32_bf16 v15, v162, v162, v15
    v_dot2_f32_bf16 v14, v163, v16, v14
    v_dot2_f32_bf16 v15, v163, v163, v15
    v_dot2_f32_bf16 v14, v164, v16, v14
    v_dot2_f32_bf16 v15, v164, v164, v15
    v_dot2_f32_bf16 v14, v165, v16, v14
    v_dot2_f32_bf16 v15, v165, v165, v15
    v_dot2_f32_bf16 v14, v166, v16, v14
    v_dot2_f32_bf16 v15, v166, v166, v15
    v_dot2_f32_bf16 v14, v167, v16, v14
    v_dot2_f32_bf16 v15, v167, v167, v15
    v_dot2_f32_bf16 v14, v168, v16, v14
    v_dot2_f32_bf16 v15, v168, v168, v15
    v_dot2_f32_bf16 v14, v169, v16, v14
    v_dot2_f32_bf16 v15, v169, v169, v15
    v_dot2_f32_bf16 v14, v170, v16, v14
    v_dot2_f32_bf16 v15, v170, v170, v15
    v_dot2_f32_bf16 v14, v171, v16, v14
    v_dot2_f32_bf16 v15, v171, v171, v15
    v_dot2_f32_bf16 v14, v172, v16, v14
    v_dot2_f32_bf16 v15, v172, v172, v15
    v_dot2_f32_bf16 v14, v173, v16, v14
    v_dot2_f32_bf16 v15, v173, v173, v15
    v_dot2_f32_bf16 v14, v174, v16, v14
    v_dot2_f32_bf16 v15, v174, v174, v15
    v_dot2_f32_bf16 v14, v175, v16, v14
    v_dot2_f32_bf16 v15, v175, v175, v15
    s_nop 2
    v_mov_b32 v16, v14
    s_nop 1
    v_permlane32_swap_b32 v14, v16
    s_nop 0
    v_add_f32 v14, v14, v16
    v_mov_b32 v16, v15
    s_nop 1
    v_permlane32_swap_b32 v15, v16
    s_nop 0
    v_add_f32 v15, v15, v16
    v_mul_f32 v14, 0x3b124925, v14
    v_mul_f32 v15, 0x3b124925, v15
    v_fma_f32 v15, -v14, v14, v15
    v_max_f32 v15, 0, v15
    v_add_f32 v15, 0x3727c5ac, v15
    v_rsq_f32 v18, v15
    s_nop 0
    v_mul_f32 v17, v14, v18
    v_sub_f32 v17, 0, v17
    s_waitcnt vmcnt(0)
    buffer_load_dwordx4 v[240:243], v7, s[56:59], s14 offen offset:128
    buffer_load_dwordx4 v[244:247], v7, s[56:59], s14 offen offset:160
    buffer_load_dwordx4 v[248:251], v7, s[56:59], s14 offen offset:192
    buffer_load_dwordx4 v[252:255], v7, s[56:59], s14 offen offset:224
    ds_read_b128 v[220:223], v9 offset:31744
    s_waitcnt lgkmcnt(3)
    v_mfma_f32_32x32x16_bf16 v[192:207], v[208:211], v[64:67], 0
    ds_read_b128 v[208:211], v9 offset:32768
    s_waitcnt lgkmcnt(3)
    v_mfma_f32_32x32x16_bf16 v[192:207], v[212:215], v[68:71], v[192:207]
    ds_read_b128 v[212:215], v9 offset:33792
    s_waitcnt lgkmcnt(3)
    v_mfma_f32_32x32x16_bf16 v[192:207], v[216:219], v[72:75], v[192:207]
    v_lshlrev_b32 v22, 16, v32
    v_fma_f32 v22, v224, v17, v22
    v_fma_f32 v176, v176, v18, v22
    v_mul_f32 v22, v176, v176
    v_fmaak_f32 v22, v21, v22, 0xc0135761
    v_mul_f32 v22, v176, v22
    v_exp_f32 v22, v22
    s_nop 0
    ds_read_b128 v[216:219], v9 offset:34816
    s_waitcnt lgkmcnt(3)
    v_mfma_f32_32x32x16_bf16 v[192:207], v[220:223], v[76:79], v[192:207]
    v_add_f32 v22, 1.0, v22
    v_rcp_f32 v22, v22
    s_nop 0
    v_mul_f32 v176, v176, v22
    v_and_b32 v23, 0xffff0000, v32
    v_fma_f32 v23, v225, v17, v23
    v_fma_f32 v177, v177, v18, v23
    v_mul_f32 v23, v177, v177
    ds_read_b128 v[220:223], v9 offset:35840
    s_waitcnt lgkmcnt(3)
    v_mfma_f32_32x32x16_bf16 v[192:207], v[208:211], v[80:83], v[192:207]
    v_fmaak_f32 v23, v21, v23, 0xc0135761
    v_mul_f32 v23, v177, v23
    v_exp_f32 v23, v23
    s_nop 0
    v_add_f32 v23, 1.0, v23
    v_rcp_f32 v23, v23
    s_nop 0
    v_mul_f32 v177, v177, v23
    ds_read_b128 v[208:211], v9 offset:36864
    s_waitcnt lgkmcnt(3)
    v_mfma_f32_32x32x16_bf16 v[192:207], v[212:215], v[84:87], v[192:207]
    v_lshlrev_b32 v22, 16, v33
    v_fma_f32 v22, v226, v17, v22
    v_fma_f32 v178, v178, v18, v22
    v_mul_f32 v22, v178, v178
    v_fmaak_f32 v22, v21, v22, 0xc0135761
    v_mul_f32 v22, v178, v22
    v_exp_f32 v22, v22
    s_nop 0
    ds_read_b128 v[212:215], v9 offset:37888
    s_waitcnt lgkmcnt(3)
    v_mfma_f32_32x32x16_bf16 v[192:207], v[216:219], v[88:91], v[192:207]
    v_add_f32 v22, 1.0, v22
    v_rcp_f32 v22, v22
    s_nop 0
    v_mul_f32 v178, v178, v22
    v_and_b32 v23, 0xffff0000, v33
    v_fma_f32 v23, v227, v17, v23
    v_fma_f32 v179, v179, v18, v23
    v_mul_f32 v23, v179, v179
    ds_read_b128 v[216:219], v9 offset:38912
    s_waitcnt lgkmcnt(3)
    v_mfma_f32_32x32x16_bf16 v[192:207], v[220:223], v[92:95], v[192:207]
    v_fmaak_f32 v23, v21, v23, 0xc0135761
    v_mul_f32 v23, v179, v23
    v_exp_f32 v23, v23
    s_nop 0
    v_add_f32 v23, 1.0, v23
    v_rcp_f32 v23, v23
    s_nop 0
    v_mul_f32 v179, v179, v23
    ds_read_b128 v[220:223], v9 offset:39936
    s_waitcnt lgkmcnt(3)
    v_mfma_f32_32x32x16_bf16 v[192:207], v[208:211], v[96:99], v[192:207]
    v_lshlrev_b32 v22, 16, v34
    v_fma_f32 v22, v228, v17, v22
    v_fma_f32 v180, v180, v18, v22
    v_mul_f32 v22, v180, v180
    v_fmaak_f32 v22, v21, v22, 0xc0135761
    v_mul_f32 v22, v180, v22
    v_exp_f32 v22, v22
    s_nop 0
    ds_read_b128 v[208:211], v9 offset:40960
    s_waitcnt lgkmcnt(3)
    v_mfma_f32_32x32x16_bf16 v[192:207], v[212:215], v[100:103], v[192:207]
    v_add_f32 v22, 1.0, v22
    v_rcp_f32 v22, v22
    s_nop 0
    v_mul_f32 v180, v180, v22
    v_and_b32 v23, 0xffff0000, v34
    v_fma_f32 v23, v229, v17, v23
    v_fma_f32 v181, v181, v18, v23
    v_mul_f32 v23, v181, v181
    ds_read_b128 v[212:215], v9 offset:41984
    s_waitcnt lgkmcnt(3)
    v_mfma_f32_32x32x16_bf16 v[192:207], v[216:219], v[104:107], v[192:207]
    v_fmaak_f32 v23, v21, v23, 0xc0135761
    v_mul_f32 v23, v181, v23
    v_exp_f32 v23, v23
    s_nop 0
    v_add_f32 v23, 1.0, v23
    v_rcp_f32 v23, v23
    s_nop 0
    v_mul_f32 v181, v181, v23
    ds_read_b128 v[216:219], v9 offset:43008
    s_waitcnt lgkmcnt(3)
    v_mfma_f32_32x32x16_bf16 v[192:207], v[220:223], v[108:111], v[192:207]
    v_lshlrev_b32 v22, 16, v35
    v_fma_f32 v22, v230, v17, v22
    v_fma_f32 v182, v182, v18, v22
    v_mul_f32 v22, v182, v182
    v_fmaak_f32 v22, v21, v22, 0xc0135761
    v_mul_f32 v22, v182, v22
    v_exp_f32 v22, v22
    s_nop 0
    ds_read_b128 v[220:223], v9 offset:44032
    s_waitcnt lgkmcnt(3)
    v_mfma_f32_32x32x16_bf16 v[192:207], v[208:211], v[112:115], v[192:207]
    v_add_f32 v22, 1.0, v22
    v_rcp_f32 v22, v22
    s_nop 0
    v_mul_f32 v182, v182, v22
    v_and_b32 v23, 0xffff0000, v35
    v_fma_f32 v23, v231, v17, v23
    v_fma_f32 v183, v183, v18, v23
    v_mul_f32 v23, v183, v183
    ds_read_b128 v[208:211], v9 offset:45056
    s_waitcnt lgkmcnt(3)
    v_mfma_f32_32x32x16_bf16 v[192:207], v[212:215], v[116:119], v[192:207]
    v_fmaak_f32 v23, v21, v23, 0xc0135761
    v_mul_f32 v23, v183, v23
    v_exp_f32 v23, v23
    s_nop 0
    v_add_f32 v23, 1.0, v23
    v_rcp_f32 v23, v23
    s_nop 0
    v_mul_f32 v183, v183, v23
    ds_read_b128 v[212:215], v9 offset:46080
    s_waitcnt lgkmcnt(3)
    v_mfma_f32_32x32x16_bf16 v[192:207], v[216:219], v[120:123], v[192:207]
    v_lshlrev_b32 v22, 16, v36
    v_fma_f32 v22, v232, v17, v22
    v_fma_f32 v184, v184, v18, v22
    v_mul_f32 v22, v184, v184
    v_fmaak_f32 v22, v21, v22, 0xc0135761
    v_mul_f32 v22, v184, v22
    v_exp_f32 v22, v22
    s_nop 0
    ds_read_b128 v[216:219], v9 offset:47104
    s_waitcnt lgkmcnt(3)
    v_mfma_f32_32x32x16_bf16 v[192:207], v[220:223], v[124:127], v[192:207]
    v_add_f32 v22, 1.0, v22
    v_rcp_f32 v22, v22
    s_nop 0
    v_mul_f32 v184, v184, v22
    v_and_b32 v23, 0xffff0000, v36
    v_fma_f32 v23, v233, v17, v23
    v_fma_f32 v185, v185, v18, v23
    v_mul_f32 v23, v185, v185
    ds_read_b128 v[220:223], v9 offset:48128
    s_waitcnt lgkmcnt(3)
    v_mfma_f32_32x32x16_bf16 v[192:207], v[208:211], v[128:131], v[192:207]
    v_fmaak_f32 v23, v21, v23, 0xc0135761
    v_mul_f32 v23, v185, v23
    v_exp_f32 v23, v23
    s_nop 0
    v_add_f32 v23, 1.0, v23
    v_rcp_f32 v23, v23
    s_nop 0
    v_mul_f32 v185, v185, v23
    ds_read_b128 v[208:211], v9 offset:49152
    s_waitcnt lgkmcnt(3)
    v_mfma_f32_32x32x16_bf16 v[192:207], v[212:215], v[132:135], v[192:207]
    v_lshlrev_b32 v22, 16, v37
    v_fma_f32 v22, v234, v17, v22
    v_fma_f32 v186, v186, v18, v22
    v_mul_f32 v22, v186, v186
    v_fmaak_f32 v22, v21, v22, 0xc0135761
    v_mul_f32 v22, v186, v22
    v_exp_f32 v22, v22
    s_nop 0
    ds_read_b128 v[212:215], v9 offset:50176
    s_waitcnt lgkmcnt(3)
    v_mfma_f32_32x32x16_bf16 v[192:207], v[216:219], v[136:139], v[192:207]
    v_add_f32 v22, 1.0, v22
    v_rcp_f32 v22, v22
    s_nop 0
    v_mul_f32 v186, v186, v22
    v_and_b32 v23, 0xffff0000, v37
    v_fma_f32 v23, v235, v17, v23
    v_fma_f32 v187, v187, v18, v23
    v_mul_f32 v23, v187, v187
    ds_read_b128 v[216:219], v9 offset:51200
    s_waitcnt lgkmcnt(3)
    v_mfma_f32_32x32x16_bf16 v[192:207], v[220:223], v[140:143], v[192:207]
    v_fmaak_f32 v23, v21, v23, 0xc0135761
    v_mul_f32 v23, v187, v23
    v_exp_f32 v23, v23
    s_nop 0
    v_add_f32 v23, 1.0, v23
    v_rcp_f32 v23, v23
    s_nop 0
    v_mul_f32 v187, v187, v23
    ds_read_b128 v[220:223], v9 offset:52224
    s_waitcnt lgkmcnt(3)
    v_mfma_f32_32x32x16_bf16 v[192:207], v[208:211], v[144:147], v[192:207]
    v_lshlrev_b32 v22, 16, v38
    v_fma_f32 v22, v236, v17, v22
    v_fma_f32 v188, v188, v18, v22
    v_mul_f32 v22, v188, v188
    v_fmaak_f32 v22, v21, v22, 0xc0135761
    v_mul_f32 v22, v188, v22
    v_exp_f32 v22, v22
    s_nop 0
    ds_read_b128 v[208:211], v9 offset:53248
    s_waitcnt lgkmcnt(3)
    v_mfma_f32_32x32x16_bf16 v[192:207], v[212:215], v[148:151], v[192:207]
    v_add_f32 v22, 1.0, v22
    v_rcp_f32 v22, v22
    s_nop 0
    v_mul_f32 v188, v188, v22
    v_and_b32 v23, 0xffff0000, v38
    v_fma_f32 v23, v237, v17, v23
    v_fma_f32 v189, v189, v18, v23
    v_mul_f32 v23, v189, v189
    ds_read_b128 v[212:215], v9 offset:54272
    s_waitcnt lgkmcnt(3)
    v_mfma_f32_32x32x16_bf16 v[192:207], v[216:219], v[152:155], v[192:207]
    v_fmaak_f32 v23, v21, v23, 0xc0135761
    v_mul_f32 v23, v189, v23
    v_exp_f32 v23, v23
    s_nop 0
    v_add_f32 v23, 1.0, v23
    v_rcp_f32 v23, v23
    s_nop 0
    v_mul_f32 v189, v189, v23
    ds_read_b128 v[216:219], v9 offset:55296
    s_waitcnt lgkmcnt(3)
    v_mfma_f32_32x32x16_bf16 v[192:207], v[220:223], v[156:159], v[192:207]
    v_lshlrev_b32 v22, 16, v39
    v_fma_f32 v22, v238, v17, v22
    v_fma_f32 v190, v190, v18, v22
    v_mul_f32 v22, v190, v190
    v_fmaak_f32 v22, v21, v22, 0xc0135761
    v_mul_f32 v22, v190, v22
    v_exp_f32 v22, v22
    s_nop 0
    ds_read_b128 v[220:223], v9 offset:56320
    s_waitcnt lgkmcnt(3)
    v_mfma_f32_32x32x16_bf16 v[192:207], v[208:211], v[160:163], v[192:207]
    v_add_f32 v22, 1.0, v22
    v_rcp_f32 v22, v22
    s_nop 0
    v_mul_f32 v190, v190, v22
    v_and_b32 v23, 0xffff0000, v39
    v_fma_f32 v23, v239, v17, v23
    v_fma_f32 v191, v191, v18, v23
    v_mul_f32 v23, v191, v191
    ds_read_b128 v[208:211], v10 offset:0
    s_waitcnt lgkmcnt(3)
    v_mfma_f32_32x32x16_bf16 v[192:207], v[212:215], v[164:167], v[192:207]
    v_fmaak_f32 v23, v21, v23, 0xc0135761
    v_mul_f32 v23, v191, v23
    v_exp_f32 v23, v23
    s_nop 0
    v_add_f32 v23, 1.0, v23
    v_rcp_f32 v23, v23
    s_nop 0
    v_mul_f32 v191, v191, v23
    ds_read_b128 v[212:215], v10 offset:1024
    s_waitcnt lgkmcnt(3)
    v_mfma_f32_32x32x16_bf16 v[192:207], v[216:219], v[168:171], v[192:207]
    v_cvt_pk_bf16_f32 v176, v176, v177
    v_cvt_pk_bf16_f32 v177, v178, v179
    v_cvt_pk_bf16_f32 v178, v180, v181
    v_cvt_pk_bf16_f32 v179, v182, v183
    v_cvt_pk_bf16_f32 v180, v184, v185
    v_cvt_pk_bf16_f32 v181, v186, v187
    v_cvt_pk_bf16_f32 v182, v188, v189
    v_cvt_pk_bf16_f32 v183, v190, v191
    s_nop 0
    v_permlane32_swap_b32 v176, v178
    v_permlane32_swap_b32 v177, v179
    v_permlane32_swap_b32 v180, v182
    v_permlane32_swap_b32 v181, v183
    buffer_store_dwordx4 v[176:179], v9, s[52:55], s15 offen offset:0 sc1
    buffer_store_dwordx4 v[180:183], v9, s[52:55], s15 offen offset:1024 sc1
    ds_read_b128 v[216:219], v10 offset:2048
    s_waitcnt lgkmcnt(3)
    v_mfma_f32_32x32x16_bf16 v[192:207], v[220:223], v[172:175], v[192:207]
    s_waitcnt vmcnt(2)
    buffer_load_dwordx4 v[224:227], v7, s[56:59], s14 offen offset:256
    buffer_load_dwordx4 v[228:231], v7, s[56:59], s14 offen offset:288
    buffer_load_dwordx4 v[232:235], v7, s[56:59], s14 offen offset:320
    buffer_load_dwordx4 v[236:239], v7, s[56:59], s14 offen offset:352
    ds_read_b128 v[220:223], v10 offset:3072
    s_waitcnt lgkmcnt(3)
    v_mfma_f32_32x32x16_bf16 v[176:191], v[208:211], v[64:67], 0
    ds_read_b128 v[208:211], v10 offset:4096
    s_waitcnt lgkmcnt(3)
    v_mfma_f32_32x32x16_bf16 v[176:191], v[212:215], v[68:71], v[176:191]
    ds_read_b128 v[212:215], v10 offset:5120
    s_waitcnt lgkmcnt(3)
    v_mfma_f32_32x32x16_bf16 v[176:191], v[216:219], v[72:75], v[176:191]
    v_lshlrev_b32 v22, 16, v40
    v_fma_f32 v22, v240, v17, v22
    v_fma_f32 v192, v192, v18, v22
    v_mul_f32 v22, v192, v192
    v_fmaak_f32 v22, v21, v22, 0xc0135761
    v_mul_f32 v22, v192, v22
    v_exp_f32 v22, v22
    s_nop 0
    ds_read_b128 v[216:219], v10 offset:6144
    s_waitcnt lgkmcnt(3)
    v_mfma_f32_32x32x16_bf16 v[176:191], v[220:223], v[76:79], v[176:191]
    v_add_f32 v22, 1.0, v22
    v_rcp_f32 v22, v22
    s_nop 0
    v_mul_f32 v192, v192, v22
    v_and_b32 v23, 0xffff0000, v40
    v_fma_f32 v23, v241, v17, v23
    v_fma_f32 v193, v193, v18, v23
    v_mul_f32 v23, v193, v193
    ds_read_b128 v[220:223], v10 offset:7168
    s_waitcnt lgkmcnt(3)
    v_mfma_f32_32x32x16_bf16 v[176:191], v[208:211], v[80:83], v[176:191]
    v_fmaak_f32 v23, v21, v23, 0xc0135761
    v_mul_f32 v23, v193, v23
    v_exp_f32 v23, v23
    s_nop 0
    v_add_f32 v23, 1.0, v23
    v_rcp_f32 v23, v23
    s_nop 0
    v_mul_f32 v193, v193, v23
    ds_read_b128 v[208:211], v10 offset:8192
    s_waitcnt lgkmcnt(3)
    v_mfma_f32_32x32x16_bf16 v[176:191], v[212:215], v[84:87], v[176:191]
    v_lshlrev_b32 v22, 16, v41
    v_fma_f32 v22, v242, v17, v22
    v_fma_f32 v194, v194, v18, v22
    v_mul_f32 v22, v194, v194
    v_fmaak_f32 v22, v21, v22, 0xc0135761
    v_mul_f32 v22, v194, v22
    v_exp_f32 v22, v22
    s_nop 0
    ds_read_b128 v[212:215], v10 offset:9216
    s_waitcnt lgkmcnt(3)
    v_mfma_f32_32x32x16_bf16 v[176:191], v[216:219], v[88:91], v[176:191]
    v_add_f32 v22, 1.0, v22
    v_rcp_f32 v22, v22
    s_nop 0
    v_mul_f32 v194, v194, v22
    v_and_b32 v23, 0xffff0000, v41
    v_fma_f32 v23, v243, v17, v23
    v_fma_f32 v195, v195, v18, v23
    v_mul_f32 v23, v195, v195
    ds_read_b128 v[216:219], v10 offset:10240
    s_waitcnt lgkmcnt(3)
    v_mfma_f32_32x32x16_bf16 v[176:191], v[220:223], v[92:95], v[176:191]
    v_fmaak_f32 v23, v21, v23, 0xc0135761
    v_mul_f32 v23, v195, v23
    v_exp_f32 v23, v23
    s_nop 0
    v_add_f32 v23, 1.0, v23
    v_rcp_f32 v23, v23
    s_nop 0
    v_mul_f32 v195, v195, v23
    ds_read_b128 v[220:223], v10 offset:11264
    s_waitcnt lgkmcnt(3)
    v_mfma_f32_32x32x16_bf16 v[176:191], v[208:211], v[96:99], v[176:191]
    v_lshlrev_b32 v22, 16, v42
    v_fma_f32 v22, v244, v17, v22
    v_fma_f32 v196, v196, v18, v22
    v_mul_f32 v22, v196, v196
    v_fmaak_f32 v22, v21, v22, 0xc0135761
    v_mul_f32 v22, v196, v22
    v_exp_f32 v22, v22
    s_nop 0
    ds_read_b128 v[208:211], v10 offset:12288
    s_waitcnt lgkmcnt(3)
    v_mfma_f32_32x32x16_bf16 v[176:191], v[212:215], v[100:103], v[176:191]
    v_add_f32 v22, 1.0, v22
    v_rcp_f32 v22, v22
    s_nop 0
    v_mul_f32 v196, v196, v22
    v_and_b32 v23, 0xffff0000, v42
    v_fma_f32 v23, v245, v17, v23
    v_fma_f32 v197, v197, v18, v23
    v_mul_f32 v23, v197, v197
    ds_read_b128 v[212:215], v10 offset:13312
    s_waitcnt lgkmcnt(3)
    v_mfma_f32_32x32x16_bf16 v[176:191], v[216:219], v[104:107], v[176:191]
    v_fmaak_f32 v23, v21, v23, 0xc0135761
    v_mul_f32 v23, v197, v23
    v_exp_f32 v23, v23
    s_nop 0
    v_add_f32 v23, 1.0, v23
    v_rcp_f32 v23, v23
    s_nop 0
    v_mul_f32 v197, v197, v23
    ds_read_b128 v[216:219], v10 offset:14336
    s_waitcnt lgkmcnt(3)
    v_mfma_f32_32x32x16_bf16 v[176:191], v[220:223], v[108:111], v[176:191]
    v_lshlrev_b32 v22, 16, v43
    v_fma_f32 v22, v246, v17, v22
    v_fma_f32 v198, v198, v18, v22
    v_mul_f32 v22, v198, v198
    v_fmaak_f32 v22, v21, v22, 0xc0135761
    v_mul_f32 v22, v198, v22
    v_exp_f32 v22, v22
    s_nop 0
    ds_read_b128 v[220:223], v10 offset:15360
    s_waitcnt lgkmcnt(3)
    v_mfma_f32_32x32x16_bf16 v[176:191], v[208:211], v[112:115], v[176:191]
    v_add_f32 v22, 1.0, v22
    v_rcp_f32 v22, v22
    s_nop 0
    v_mul_f32 v198, v198, v22
    v_and_b32 v23, 0xffff0000, v43
    v_fma_f32 v23, v247, v17, v23
    v_fma_f32 v199, v199, v18, v23
    v_mul_f32 v23, v199, v199
    ds_read_b128 v[208:211], v10 offset:16384
    s_waitcnt lgkmcnt(3)
    v_mfma_f32_32x32x16_bf16 v[176:191], v[212:215], v[116:119], v[176:191]
    v_fmaak_f32 v23, v21, v23, 0xc0135761
    v_mul_f32 v23, v199, v23
    v_exp_f32 v23, v23
    s_nop 0
    v_add_f32 v23, 1.0, v23
    v_rcp_f32 v23, v23
    s_nop 0
    v_mul_f32 v199, v199, v23
    ds_read_b128 v[212:215], v10 offset:17408
    s_waitcnt lgkmcnt(3)
    v_mfma_f32_32x32x16_bf16 v[176:191], v[216:219], v[120:123], v[176:191]
    v_lshlrev_b32 v22, 16, v44
    v_fma_f32 v22, v248, v17, v22
    v_fma_f32 v200, v200, v18, v22
    v_mul_f32 v22, v200, v200
    v_fmaak_f32 v22, v21, v22, 0xc0135761
    v_mul_f32 v22, v200, v22
    v_exp_f32 v22, v22
    s_nop 0
    ds_read_b128 v[216:219], v10 offset:18432
    s_waitcnt lgkmcnt(3)
    v_mfma_f32_32x32x16_bf16 v[176:191], v[220:223], v[124:127], v[176:191]
    v_add_f32 v22, 1.0, v22
    v_rcp_f32 v22, v22
    s_nop 0
    v_mul_f32 v200, v200, v22
    v_and_b32 v23, 0xffff0000, v44
    v_fma_f32 v23, v249, v17, v23
    v_fma_f32 v201, v201, v18, v23
    v_mul_f32 v23, v201, v201
    ds_read_b128 v[220:223], v10 offset:19456
    s_waitcnt lgkmcnt(3)
    v_mfma_f32_32x32x16_bf16 v[176:191], v[208:211], v[128:131], v[176:191]
    v_fmaak_f32 v23, v21, v23, 0xc0135761
    v_mul_f32 v23, v201, v23
    v_exp_f32 v23, v23
    s_nop 0
    v_add_f32 v23, 1.0, v23
    v_rcp_f32 v23, v23
    s_nop 0
    v_mul_f32 v201, v201, v23
    ds_read_b128 v[208:211], v10 offset:20480
    s_waitcnt lgkmcnt(3)
    v_mfma_f32_32x32x16_bf16 v[176:191], v[212:215], v[132:135], v[176:191]
    v_lshlrev_b32 v22, 16, v45
    v_fma_f32 v22, v250, v17, v22
    v_fma_f32 v202, v202, v18, v22
    v_mul_f32 v22, v202, v202
    v_fmaak_f32 v22, v21, v22, 0xc0135761
    v_mul_f32 v22, v202, v22
    v_exp_f32 v22, v22
    s_nop 0
    ds_read_b128 v[212:215], v10 offset:21504
    s_waitcnt lgkmcnt(3)
    v_mfma_f32_32x32x16_bf16 v[176:191], v[216:219], v[136:139], v[176:191]
    v_add_f32 v22, 1.0, v22
    v_rcp_f32 v22, v22
    s_nop 0
    v_mul_f32 v202, v202, v22
    v_and_b32 v23, 0xffff0000, v45
    v_fma_f32 v23, v251, v17, v23
    v_fma_f32 v203, v203, v18, v23
    v_mul_f32 v23, v203, v203
    ds_read_b128 v[216:219], v10 offset:22528
    s_waitcnt lgkmcnt(3)
    v_mfma_f32_32x32x16_bf16 v[176:191], v[220:223], v[140:143], v[176:191]
    v_fmaak_f32 v23, v21, v23, 0xc0135761
    v_mul_f32 v23, v203, v23
    v_exp_f32 v23, v23
    s_nop 0
    v_add_f32 v23, 1.0, v23
    v_rcp_f32 v23, v23
    s_nop 0
    v_mul_f32 v203, v203, v23
    ds_read_b128 v[220:223], v10 offset:23552
    s_waitcnt lgkmcnt(3)
    v_mfma_f32_32x32x16_bf16 v[176:191], v[208:211], v[144:147], v[176:191]
    v_lshlrev_b32 v22, 16, v46
    v_fma_f32 v22, v252, v17, v22
    v_fma_f32 v204, v204, v18, v22
    v_mul_f32 v22, v204, v204
    v_fmaak_f32 v22, v21, v22, 0xc0135761
    v_mul_f32 v22, v204, v22
    v_exp_f32 v22, v22
    s_nop 0
    ds_read_b128 v[208:211], v10 offset:24576
    s_waitcnt lgkmcnt(3)
    v_mfma_f32_32x32x16_bf16 v[176:191], v[212:215], v[148:151], v[176:191]
    v_add_f32 v22, 1.0, v22
    v_rcp_f32 v22, v22
    s_nop 0
    v_mul_f32 v204, v204, v22
    v_and_b32 v23, 0xffff0000, v46
    v_fma_f32 v23, v253, v17, v23
    v_fma_f32 v205, v205, v18, v23
    v_mul_f32 v23, v205, v205
    ds_read_b128 v[212:215], v10 offset:25600
    s_waitcnt lgkmcnt(3)
    v_mfma_f32_32x32x16_bf16 v[176:191], v[216:219], v[152:155], v[176:191]
    v_fmaak_f32 v23, v21, v23, 0xc0135761
    v_mul_f32 v23, v205, v23
    v_exp_f32 v23, v23
    s_nop 0
    v_add_f32 v23, 1.0, v23
    v_rcp_f32 v23, v23
    s_nop 0
    v_mul_f32 v205, v205, v23
    ds_read_b128 v[216:219], v10 offset:26624
    s_waitcnt lgkmcnt(3)
    v_mfma_f32_32x32x16_bf16 v[176:191], v[220:223], v[156:159], v[176:191]
    v_lshlrev_b32 v22, 16, v47
    v_fma_f32 v22, v254, v17, v22
    v_fma_f32 v206, v206, v18, v22
    v_mul_f32 v22, v206, v206
    v_fmaak_f32 v22, v21, v22, 0xc0135761
    v_mul_f32 v22, v206, v22
    v_exp_f32 v22, v22
    s_nop 0
    ds_read_b128 v[220:223], v10 offset:27648
    s_waitcnt lgkmcnt(3)
    v_mfma_f32_32x32x16_bf16 v[176:191], v[208:211], v[160:163], v[176:191]
    v_add_f32 v22, 1.0, v22
    v_rcp_f32 v22, v22
    s_nop 0
    v_mul_f32 v206, v206, v22
    v_and_b32 v23, 0xffff0000, v47
    v_fma_f32 v23, v255, v17, v23
    v_fma_f32 v207, v207, v18, v23
    v_mul_f32 v23, v207, v207
    ds_read_b128 v[208:211], v10 offset:28672
    s_waitcnt lgkmcnt(3)
    v_mfma_f32_32x32x16_bf16 v[176:191], v[212:215], v[164:167], v[176:191]
    v_fmaak_f32 v23, v21, v23, 0xc0135761
    v_mul_f32 v23, v207, v23
    v_exp_f32 v23, v23
    s_nop 0
    v_add_f32 v23, 1.0, v23
    v_rcp_f32 v23, v23
    s_nop 0
    v_mul_f32 v207, v207, v23
    ds_read_b128 v[212:215], v10 offset:29696
    s_waitcnt lgkmcnt(3)
    v_mfma_f32_32x32x16_bf16 v[176:191], v[216:219], v[168:171], v[176:191]
    v_cvt_pk_bf16_f32 v192, v192, v193
    v_cvt_pk_bf16_f32 v193, v194, v195
    v_cvt_pk_bf16_f32 v194, v196, v197
    v_cvt_pk_bf16_f32 v195, v198, v199
    v_cvt_pk_bf16_f32 v196, v200, v201
    v_cvt_pk_bf16_f32 v197, v202, v203
    v_cvt_pk_bf16_f32 v198, v204, v205
    v_cvt_pk_bf16_f32 v199, v206, v207
    s_nop 0
    v_permlane32_swap_b32 v192, v194
    v_permlane32_swap_b32 v193, v195
    v_permlane32_swap_b32 v196, v198
    v_permlane32_swap_b32 v197, v199
    buffer_store_dwordx4 v[192:195], v9, s[52:55], s15 offen offset:2048 sc1
    buffer_store_dwordx4 v[196:199], v9, s[52:55], s15 offen offset:3072 sc1
    ds_read_b128 v[216:219], v10 offset:30720
    s_waitcnt lgkmcnt(3)
    v_mfma_f32_32x32x16_bf16 v[176:191], v[220:223], v[172:175], v[176:191]
    s_waitcnt vmcnt(2)
    buffer_load_dwordx4 v[240:243], v7, s[56:59], s14 offen offset:384
    buffer_load_dwordx4 v[244:247], v7, s[56:59], s14 offen offset:416
    buffer_load_dwordx4 v[248:251], v7, s[56:59], s14 offen offset:448
    buffer_load_dwordx4 v[252:255], v7, s[56:59], s14 offen offset:480
    ds_read_b128 v[220:223], v10 offset:31744
    s_waitcnt lgkmcnt(3)
    v_mfma_f32_32x32x16_bf16 v[192:207], v[208:211], v[64:67], 0
    ds_read_b128 v[208:211], v10 offset:32768
    s_waitcnt lgkmcnt(3)
    v_mfma_f32_32x32x16_bf16 v[192:207], v[212:215], v[68:71], v[192:207]
    ds_read_b128 v[212:215], v10 offset:33792
    s_waitcnt lgkmcnt(3)
    v_mfma_f32_32x32x16_bf16 v[192:207], v[216:219], v[72:75], v[192:207]
    v_lshlrev_b32 v22, 16, v48
    v_fma_f32 v22, v224, v17, v22
    v_fma_f32 v176, v176, v18, v22
    v_mul_f32 v22, v176, v176
    v_fmaak_f32 v22, v21, v22, 0xc0135761
    v_mul_f32 v22, v176, v22
    v_exp_f32 v22, v22
    s_nop 0
    ds_read_b128 v[216:219], v10 offset:34816
    s_waitcnt lgkmcnt(3)
    v_mfma_f32_32x32x16_bf16 v[192:207], v[220:223], v[76:79], v[192:207]
    v_add_f32 v22, 1.0, v22
    v_rcp_f32 v22, v22
    s_nop 0
    v_mul_f32 v176, v176, v22
    v_and_b32 v23, 0xffff0000, v48
    v_fma_f32 v23, v225, v17, v23
    v_fma_f32 v177, v177, v18, v23
    v_mul_f32 v23, v177, v177
    ds_read_b128 v[220:223], v10 offset:35840
    s_waitcnt lgkmcnt(3)
    v_mfma_f32_32x32x16_bf16 v[192:207], v[208:211], v[80:83], v[192:207]
    v_fmaak_f32 v23, v21, v23, 0xc0135761
    v_mul_f32 v23, v177, v23
    v_exp_f32 v23, v23
    s_nop 0
    v_add_f32 v23, 1.0, v23
    v_rcp_f32 v23, v23
    s_nop 0
    v_mul_f32 v177, v177, v23
    ds_read_b128 v[208:211], v10 offset:36864
    s_waitcnt lgkmcnt(3)
    v_mfma_f32_32x32x16_bf16 v[192:207], v[212:215], v[84:87], v[192:207]
    v_lshlrev_b32 v22, 16, v49
    v_fma_f32 v22, v226, v17, v22
    v_fma_f32 v178, v178, v18, v22
    v_mul_f32 v22, v178, v178
    v_fmaak_f32 v22, v21, v22, 0xc0135761
    v_mul_f32 v22, v178, v22
    v_exp_f32 v22, v22
    s_nop 0
    ds_read_b128 v[212:215], v10 offset:37888
    s_waitcnt lgkmcnt(3)
    v_mfma_f32_32x32x16_bf16 v[192:207], v[216:219], v[88:91], v[192:207]
    v_add_f32 v22, 1.0, v22
    v_rcp_f32 v22, v22
    s_nop 0
    v_mul_f32 v178, v178, v22
    v_and_b32 v23, 0xffff0000, v49
    v_fma_f32 v23, v227, v17, v23
    v_fma_f32 v179, v179, v18, v23
    v_mul_f32 v23, v179, v179
    ds_read_b128 v[216:219], v10 offset:38912
    s_waitcnt lgkmcnt(3)
    v_mfma_f32_32x32x16_bf16 v[192:207], v[220:223], v[92:95], v[192:207]
    v_fmaak_f32 v23, v21, v23, 0xc0135761
    v_mul_f32 v23, v179, v23
    v_exp_f32 v23, v23
    s_nop 0
    v_add_f32 v23, 1.0, v23
    v_rcp_f32 v23, v23
    s_nop 0
    v_mul_f32 v179, v179, v23
    ds_read_b128 v[220:223], v10 offset:39936
    s_waitcnt lgkmcnt(3)
    v_mfma_f32_32x32x16_bf16 v[192:207], v[208:211], v[96:99], v[192:207]
    v_lshlrev_b32 v22, 16, v50
    v_fma_f32 v22, v228, v17, v22
    v_fma_f32 v180, v180, v18, v22
    v_mul_f32 v22, v180, v180
    v_fmaak_f32 v22, v21, v22, 0xc0135761
    v_mul_f32 v22, v180, v22
    v_exp_f32 v22, v22
    s_nop 0
    ds_read_b128 v[208:211], v10 offset:40960
    s_waitcnt lgkmcnt(3)
    v_mfma_f32_32x32x16_bf16 v[192:207], v[212:215], v[100:103], v[192:207]
    v_add_f32 v22, 1.0, v22
    v_rcp_f32 v22, v22
    s_nop 0
    v_mul_f32 v180, v180, v22
    v_and_b32 v23, 0xffff0000, v50
    v_fma_f32 v23, v229, v17, v23
    v_fma_f32 v181, v181, v18, v23
    v_mul_f32 v23, v181, v181
    ds_read_b128 v[212:215], v10 offset:41984
    s_waitcnt lgkmcnt(3)
    v_mfma_f32_32x32x16_bf16 v[192:207], v[216:219], v[104:107], v[192:207]
    v_fmaak_f32 v23, v21, v23, 0xc0135761
    v_mul_f32 v23, v181, v23
    v_exp_f32 v23, v23
    s_nop 0
    v_add_f32 v23, 1.0, v23
    v_rcp_f32 v23, v23
    s_nop 0
    v_mul_f32 v181, v181, v23
    ds_read_b128 v[216:219], v10 offset:43008
    s_waitcnt lgkmcnt(3)
    v_mfma_f32_32x32x16_bf16 v[192:207], v[220:223], v[108:111], v[192:207]
    v_lshlrev_b32 v22, 16, v51
    v_fma_f32 v22, v230, v17, v22
    v_fma_f32 v182, v182, v18, v22
    v_mul_f32 v22, v182, v182
    v_fmaak_f32 v22, v21, v22, 0xc0135761
    v_mul_f32 v22, v182, v22
    v_exp_f32 v22, v22
    s_nop 0
    ds_read_b128 v[220:223], v10 offset:44032
    s_waitcnt lgkmcnt(3)
    v_mfma_f32_32x32x16_bf16 v[192:207], v[208:211], v[112:115], v[192:207]
    v_add_f32 v22, 1.0, v22
    v_rcp_f32 v22, v22
    s_nop 0
    v_mul_f32 v182, v182, v22
    v_and_b32 v23, 0xffff0000, v51
    v_fma_f32 v23, v231, v17, v23
    v_fma_f32 v183, v183, v18, v23
    v_mul_f32 v23, v183, v183
    ds_read_b128 v[208:211], v10 offset:45056
    s_waitcnt lgkmcnt(3)
    v_mfma_f32_32x32x16_bf16 v[192:207], v[212:215], v[116:119], v[192:207]
    v_fmaak_f32 v23, v21, v23, 0xc0135761
    v_mul_f32 v23, v183, v23
    v_exp_f32 v23, v23
    s_nop 0
    v_add_f32 v23, 1.0, v23
    v_rcp_f32 v23, v23
    s_nop 0
    v_mul_f32 v183, v183, v23
    ds_read_b128 v[212:215], v10 offset:46080
    s_waitcnt lgkmcnt(3)
    v_mfma_f32_32x32x16_bf16 v[192:207], v[216:219], v[120:123], v[192:207]
    v_lshlrev_b32 v22, 16, v52
    v_fma_f32 v22, v232, v17, v22
    v_fma_f32 v184, v184, v18, v22
    v_mul_f32 v22, v184, v184
    v_fmaak_f32 v22, v21, v22, 0xc0135761
    v_mul_f32 v22, v184, v22
    v_exp_f32 v22, v22
    s_nop 0
    ds_read_b128 v[216:219], v10 offset:47104
    s_waitcnt lgkmcnt(3)
    v_mfma_f32_32x32x16_bf16 v[192:207], v[220:223], v[124:127], v[192:207]
    v_add_f32 v22, 1.0, v22
    v_rcp_f32 v22, v22
    s_nop 0
    v_mul_f32 v184, v184, v22
    v_and_b32 v23, 0xffff0000, v52
    v_fma_f32 v23, v233, v17, v23
    v_fma_f32 v185, v185, v18, v23
    v_mul_f32 v23, v185, v185
    ds_read_b128 v[220:223], v10 offset:48128
    s_waitcnt lgkmcnt(3)
    v_mfma_f32_32x32x16_bf16 v[192:207], v[208:211], v[128:131], v[192:207]
    v_fmaak_f32 v23, v21, v23, 0xc0135761
    v_mul_f32 v23, v185, v23
    v_exp_f32 v23, v23
    s_nop 0
    v_add_f32 v23, 1.0, v23
    v_rcp_f32 v23, v23
    s_nop 0
    v_mul_f32 v185, v185, v23
    ds_read_b128 v[208:211], v10 offset:49152
    s_waitcnt lgkmcnt(3)
    v_mfma_f32_32x32x16_bf16 v[192:207], v[212:215], v[132:135], v[192:207]
    v_lshlrev_b32 v22, 16, v53
    v_fma_f32 v22, v234, v17, v22
    v_fma_f32 v186, v186, v18, v22
    v_mul_f32 v22, v186, v186
    v_fmaak_f32 v22, v21, v22, 0xc0135761
    v_mul_f32 v22, v186, v22
    v_exp_f32 v22, v22
    s_nop 0
    ds_read_b128 v[212:215], v10 offset:50176
    s_waitcnt lgkmcnt(3)
    v_mfma_f32_32x32x16_bf16 v[192:207], v[216:219], v[136:139], v[192:207]
    v_add_f32 v22, 1.0, v22
    v_rcp_f32 v22, v22
    s_nop 0
    v_mul_f32 v186, v186, v22
    v_and_b32 v23, 0xffff0000, v53
    v_fma_f32 v23, v235, v17, v23
    v_fma_f32 v187, v187, v18, v23
    v_mul_f32 v23, v187, v187
    ds_read_b128 v[216:219], v10 offset:51200
    s_waitcnt lgkmcnt(3)
    v_mfma_f32_32x32x16_bf16 v[192:207], v[220:223], v[140:143], v[192:207]
    v_fmaak_f32 v23, v21, v23, 0xc0135761
    v_mul_f32 v23, v187, v23
    v_exp_f32 v23, v23
    s_nop 0
    v_add_f32 v23, 1.0, v23
    v_rcp_f32 v23, v23
    s_nop 0
    v_mul_f32 v187, v187, v23
    ds_read_b128 v[220:223], v10 offset:52224
    s_waitcnt lgkmcnt(3)
    v_mfma_f32_32x32x16_bf16 v[192:207], v[208:211], v[144:147], v[192:207]
    v_lshlrev_b32 v22, 16, v54
    v_fma_f32 v22, v236, v17, v22
    v_fma_f32 v188, v188, v18, v22
    v_mul_f32 v22, v188, v188
    v_fmaak_f32 v22, v21, v22, 0xc0135761
    v_mul_f32 v22, v188, v22
    v_exp_f32 v22, v22
    s_nop 0
    ds_read_b128 v[208:211], v10 offset:53248
    s_waitcnt lgkmcnt(3)
    v_mfma_f32_32x32x16_bf16 v[192:207], v[212:215], v[148:151], v[192:207]
    v_add_f32 v22, 1.0, v22
    v_rcp_f32 v22, v22
    s_nop 0
    v_mul_f32 v188, v188, v22
    v_and_b32 v23, 0xffff0000, v54
    v_fma_f32 v23, v237, v17, v23
    v_fma_f32 v189, v189, v18, v23
    v_mul_f32 v23, v189, v189
    ds_read_b128 v[212:215], v10 offset:54272
    s_waitcnt lgkmcnt(3)
    v_mfma_f32_32x32x16_bf16 v[192:207], v[216:219], v[152:155], v[192:207]
    v_fmaak_f32 v23, v21, v23, 0xc0135761
    v_mul_f32 v23, v189, v23
    v_exp_f32 v23, v23
    s_nop 0
    v_add_f32 v23, 1.0, v23
    v_rcp_f32 v23, v23
    s_nop 0
    v_mul_f32 v189, v189, v23
    ds_read_b128 v[216:219], v10 offset:55296
    s_waitcnt lgkmcnt(3)
    v_mfma_f32_32x32x16_bf16 v[192:207], v[220:223], v[156:159], v[192:207]
    v_lshlrev_b32 v22, 16, v55
    v_fma_f32 v22, v238, v17, v22
    v_fma_f32 v190, v190, v18, v22
    v_mul_f32 v22, v190, v190
    v_fmaak_f32 v22, v21, v22, 0xc0135761
    v_mul_f32 v22, v190, v22
    v_exp_f32 v22, v22
    s_nop 0
    ds_read_b128 v[220:223], v10 offset:56320
    s_waitcnt lgkmcnt(3)
    v_mfma_f32_32x32x16_bf16 v[192:207], v[208:211], v[160:163], v[192:207]
    v_add_f32 v22, 1.0, v22
    v_rcp_f32 v22, v22
    s_nop 0
    v_mul_f32 v190, v190, v22
    v_and_b32 v23, 0xffff0000, v55
    v_fma_f32 v23, v239, v17, v23
    v_fma_f32 v191, v191, v18, v23
    v_mul_f32 v23, v191, v191
    s_waitcnt lgkmcnt(2)
    v_mfma_f32_32x32x16_bf16 v[192:207], v[212:215], v[164:167], v[192:207]
    v_fmaak_f32 v23, v21, v23, 0xc0135761
    v_mul_f32 v23, v191, v23
    v_exp_f32 v23, v23
    s_nop 0
    v_add_f32 v23, 1.0, v23
    v_rcp_f32 v23, v23
    s_nop 0
    v_mul_f32 v191, v191, v23
    s_waitcnt lgkmcnt(1)
    v_mfma_f32_32x32x16_bf16 v[192:207], v[216:219], v[168:171], v[192:207]
    v_cvt_pk_bf16_f32 v176, v176, v177
    v_cvt_pk_bf16_f32 v177, v178, v179
    v_cvt_pk_bf16_f32 v178, v180, v181
    v_cvt_pk_bf16_f32 v179, v182, v183
    v_cvt_pk_bf16_f32 v180, v184, v185
    v_cvt_pk_bf16_f32 v181, v186, v187
    v_cvt_pk_bf16_f32 v182, v188, v189
    v_cvt_pk_bf16_f32 v183, v190, v191
    s_nop 0
    v_permlane32_swap_b32 v176, v178
    v_permlane32_swap_b32 v177, v179
    v_permlane32_swap_b32 v180, v182
    v_permlane32_swap_b32 v181, v183
    buffer_store_dwordx4 v[176:179], v9, s[52:55], s63 offen offset:0 sc1
    buffer_store_dwordx4 v[180:183], v9, s[52:55], s63 offen offset:1024 sc1
    s_waitcnt lgkmcnt(0)
    v_mfma_f32_32x32x16_bf16 v[192:207], v[220:223], v[172:175], v[192:207]
    s_waitcnt vmcnt(2)
    s_barrier
    s_nop 13
    v_lshlrev_b32 v22, 16, v56
    v_fma_f32 v22, v240, v17, v22
    v_fma_f32 v192, v192, v18, v22
    v_mul_f32 v22, v192, v192
    v_fmaak_f32 v22, v21, v22, 0xc0135761
    v_mul_f32 v22, v192, v22
    v_exp_f32 v22, v22
    s_nop 0
    v_add_f32 v22, 1.0, v22
    v_rcp_f32 v22, v22
    s_nop 0
    v_mul_f32 v192, v192, v22
    v_and_b32 v23, 0xffff0000, v56
    v_fma_f32 v23, v241, v17, v23
    v_fma_f32 v193, v193, v18, v23
    v_mul_f32 v23, v193, v193
    v_fmaak_f32 v23, v21, v23, 0xc0135761
    v_mul_f32 v23, v193, v23
    v_exp_f32 v23, v23
    s_nop 0
    v_add_f32 v23, 1.0, v23
    v_rcp_f32 v23, v23
    s_nop 0
    v_mul_f32 v193, v193, v23
    v_lshlrev_b32 v22, 16, v57
    v_fma_f32 v22, v242, v17, v22
    v_fma_f32 v194, v194, v18, v22
    v_mul_f32 v22, v194, v194
    v_fmaak_f32 v22, v21, v22, 0xc0135761
    v_mul_f32 v22, v194, v22
    v_exp_f32 v22, v22
    s_nop 0
    v_add_f32 v22, 1.0, v22
    v_rcp_f32 v22, v22
    s_nop 0
    v_mul_f32 v194, v194, v22
    v_and_b32 v23, 0xffff0000, v57
    v_fma_f32 v23, v243, v17, v23
    v_fma_f32 v195, v195, v18, v23
    v_mul_f32 v23, v195, v195
    v_fmaak_f32 v23, v21, v23, 0xc0135761
    v_mul_f32 v23, v195, v23
    v_exp_f32 v23, v23
    s_nop 0
    v_add_f32 v23, 1.0, v23
    v_rcp_f32 v23, v23
    s_nop 0
    v_mul_f32 v195, v195, v23
    v_lshlrev_b32 v22, 16, v58
    v_fma_f32 v22, v244, v17, v22
    v_fma_f32 v196, v196, v18, v22
    v_mul_f32 v22, v196, v196
    v_fmaak_f32 v22, v21, v22, 0xc0135761
    v_mul_f32 v22, v196, v22
    v_exp_f32 v22, v22
    s_nop 0
    v_add_f32 v22, 1.0, v22
    v_rcp_f32 v22, v22
    s_nop 0
    v_mul_f32 v196, v196, v22
    v_and_b32 v23, 0xffff0000, v58
    v_fma_f32 v23, v245, v17, v23
    v_fma_f32 v197, v197, v18, v23
    v_mul_f32 v23, v197, v197
    v_fmaak_f32 v23, v21, v23, 0xc0135761
    v_mul_f32 v23, v197, v23
    v_exp_f32 v23, v23
    s_nop 0
    v_add_f32 v23, 1.0, v23
    v_rcp_f32 v23, v23
    s_nop 0
    v_mul_f32 v197, v197, v23
    v_lshlrev_b32 v22, 16, v59
    v_fma_f32 v22, v246, v17, v22
    v_fma_f32 v198, v198, v18, v22
    v_mul_f32 v22, v198, v198
    v_fmaak_f32 v22, v21, v22, 0xc0135761
    v_mul_f32 v22, v198, v22
    v_exp_f32 v22, v22
    s_nop 0
    v_add_f32 v22, 1.0, v22
    v_rcp_f32 v22, v22
    s_nop 0
    v_mul_f32 v198, v198, v22
    v_and_b32 v23, 0xffff0000, v59
    v_fma_f32 v23, v247, v17, v23
    v_fma_f32 v199, v199, v18, v23
    v_mul_f32 v23, v199, v199
    v_fmaak_f32 v23, v21, v23, 0xc0135761
    v_mul_f32 v23, v199, v23
    v_exp_f32 v23, v23
    s_nop 0
    v_add_f32 v23, 1.0, v23
    v_rcp_f32 v23, v23
    s_nop 0
    v_mul_f32 v199, v199, v23
    v_lshlrev_b32 v22, 16, v60
    v_fma_f32 v22, v248, v17, v22
    v_fma_f32 v200, v200, v18, v22
    v_mul_f32 v22, v200, v200
    v_fmaak_f32 v22, v21, v22, 0xc0135761
    v_mul_f32 v22, v200, v22
    v_exp_f32 v22, v22
    s_nop 0
    v_add_f32 v22, 1.0, v22
    v_rcp_f32 v22, v22
    s_nop 0
    v_mul_f32 v200, v200, v22
    v_and_b32 v23, 0xffff0000, v60
    v_fma_f32 v23, v249, v17, v23
    v_fma_f32 v201, v201, v18, v23
    v_mul_f32 v23, v201, v201
    v_fmaak_f32 v23, v21, v23, 0xc0135761
    v_mul_f32 v23, v201, v23
    v_exp_f32 v23, v23
    s_nop 0
    v_add_f32 v23, 1.0, v23
    v_rcp_f32 v23, v23
    s_nop 0
    v_mul_f32 v201, v201, v23
    v_lshlrev_b32 v22, 16, v61
    v_fma_f32 v22, v250, v17, v22
    v_fma_f32 v202, v202, v18, v22
    v_mul_f32 v22, v202, v202
    v_fmaak_f32 v22, v21, v22, 0xc0135761
    v_mul_f32 v22, v202, v22
    v_exp_f32 v22, v22
    s_nop 0
    v_add_f32 v22, 1.0, v22
    v_rcp_f32 v22, v22
    s_nop 0
    v_mul_f32 v202, v202, v22
    v_and_b32 v23, 0xffff0000, v61
    v_fma_f32 v23, v251, v17, v23
    v_fma_f32 v203, v203, v18, v23
    v_mul_f32 v23, v203, v203
    v_fmaak_f32 v23, v21, v23, 0xc0135761
    v_mul_f32 v23, v203, v23
    v_exp_f32 v23, v23
    s_nop 0
    v_add_f32 v23, 1.0, v23
    v_rcp_f32 v23, v23
    s_nop 0
    v_mul_f32 v203, v203, v23
    v_lshlrev_b32 v22, 16, v62
    v_fma_f32 v22, v252, v17, v22
    v_fma_f32 v204, v204, v18, v22
    v_mul_f32 v22, v204, v204
    v_fmaak_f32 v22, v21, v22, 0xc0135761
    v_mul_f32 v22, v204, v22
    v_exp_f32 v22, v22
    s_nop 0
    v_add_f32 v22, 1.0, v22
    v_rcp_f32 v22, v22
    s_nop 0
    v_mul_f32 v204, v204, v22
    v_and_b32 v23, 0xffff0000, v62
    v_fma_f32 v23, v253, v17, v23
    v_fma_f32 v205, v205, v18, v23
    v_mul_f32 v23, v205, v205
    v_fmaak_f32 v23, v21, v23, 0xc0135761
    v_mul_f32 v23, v205, v23
    v_exp_f32 v23, v23
    s_nop 0
    v_add_f32 v23, 1.0, v23
    v_rcp_f32 v23, v23
    s_nop 0
    v_mul_f32 v205, v205, v23
    v_lshlrev_b32 v22, 16, v63
    v_fma_f32 v22, v254, v17, v22
    v_fma_f32 v206, v206, v18, v22
    v_mul_f32 v22, v206, v206
    v_fmaak_f32 v22, v21, v22, 0xc0135761
    v_mul_f32 v22, v206, v22
    v_exp_f32 v22, v22
    s_nop 0
    v_add_f32 v22, 1.0, v22
    v_rcp_f32 v22, v22
    s_nop 0
    v_mul_f32 v206, v206, v22
    v_and_b32 v23, 0xffff0000, v63
    v_fma_f32 v23, v255, v17, v23
    v_fma_f32 v207, v207, v18, v23
    v_mul_f32 v23, v207, v207
    v_fmaak_f32 v23, v21, v23, 0xc0135761
    v_mul_f32 v23, v207, v23
    v_exp_f32 v23, v23
    s_nop 0
    v_add_f32 v23, 1.0, v23
    v_rcp_f32 v23, v23
    s_nop 0
    v_mul_f32 v207, v207, v23
    v_cvt_pk_bf16_f32 v192, v192, v193
    v_cvt_pk_bf16_f32 v193, v194, v195
    v_cvt_pk_bf16_f32 v194, v196, v197
    v_cvt_pk_bf16_f32 v195, v198, v199
    v_cvt_pk_bf16_f32 v196, v200, v201
    v_cvt_pk_bf16_f32 v197, v202, v203
    v_cvt_pk_bf16_f32 v198, v204, v205
    v_cvt_pk_bf16_f32 v199, v206, v207
    s_nop 0
    v_permlane32_swap_b32 v192, v194
    v_permlane32_swap_b32 v193, v195
    v_permlane32_swap_b32 v196, v198
    v_permlane32_swap_b32 v197, v199
    buffer_store_dwordx4 v[192:195], v9, s[52:55], s63 offen offset:2048 sc1
    buffer_store_dwordx4 v[196:199], v9, s[52:55], s63 offen offset:3072 sc1
    s_lshl_b32 s62, s4, 7
    s_lshl_b32 s63, s5, 2
    s_add_u32 s62, s62, s63
    s_add_u32 s62, s62, 14336
    s_waitcnt vmcnt(0) lgkmcnt(0)
    s_barrier
    s_cmp_eq_u32 s3, 0
    s_cbranch_scc0 L_sig_36
    v_mov_b32 v5, s98
    v_mov_b32 v6, 0
    s_mov_b64 exec, 1
    buffer_store_dword v5, v6, s[72:75], s62 offen sc1
    s_mov_b64 exec, -1
L_sig_36:
    s_lshr_b32 s13, s2, 3
    s_mul_hi_u32 s14, s13, 0x24924925
    s_mul_i32 s14, s14, 7
    s_sub_u32 s13, s13, s14
    s_add_u32 s44, s38, 0x2700000
    s_addc_u32 s45, s39, 0
    s_and_b32 s45, s45, 0xffff
    s_mov_b32 s46, 0x188000
    s_mov_b32 s47, 0x20000
    s_and_b32 s8, s3, 1
    s_lshr_b32 s9, s3, 1
    s_lshl_b32 s9, s9, 11
    s_lshl_b32 s10, s13, 1
    s_add_u32 s10, s10, s8
    s_mul_i32 s10, s10, 114688
    s_add_u32 s10, s10, s9
    s_lshl_b32 s12, s8, 12
    s_add_u32 s12, s12, s9
    s_add_u32 s14, s10, 0
    s_add_u32 m0, s12, 81920
    s_nop 0
    buffer_load_dwordx4 v9, s[44:47], s14 offen lds
    s_add_u32 s14, s10, 1024
    s_add_u32 m0, s12, 82944
    s_nop 0
    buffer_load_dwordx4 v9, s[44:47], s14 offen lds
    s_add_u32 s14, s10, 4096
    s_add_u32 m0, s12, 90112
    s_nop 0
    buffer_load_dwordx4 v9, s[44:47], s14 offen lds
    s_add_u32 s14, s10, 5120
    s_add_u32 m0, s12, 91136
    s_nop 0
    buffer_load_dwordx4 v9, s[44:47], s14 offen lds
    s_add_u32 s14, s10, 8192
    s_add_u32 m0, s12, 98304
    s_nop 0
    buffer_load_dwordx4 v9, s[44:47], s14 offen lds
    s_add_u32 s14, s10, 9216
    s_add_u32 m0, s12, 99328
    s_nop 0
    buffer_load_dwordx4 v9, s[44:47], s14 offen lds
    s_add_u32 s14, s10, 12288
    s_add_u32 m0, s12, 106496
    s_nop 0
    buffer_load_dwordx4 v9, s[44:47], s14 offen lds
    s_add_u32 s14, s10, 13312
    s_add_u32 m0, s12, 107520
    s_nop 0
    buffer_load_dwordx4 v9, s[44:47], s14 offen lds
    s_add_u32 s14, s10, 16384
    s_add_u32 m0, s12, 114688
    s_nop 0
    buffer_load_dwordx4 v9, s[44:47], s14 offen lds
    s_add_u32 s14, s10, 17408
    s_add_u32 m0, s12, 115712
    s_nop 0
    buffer_load_dwordx4 v9, s[44:47], s14 offen lds
    s_add_u32 s14, s10, 20480
    s_add_u32 m0, s12, 122880
    s_nop 0
    buffer_load_dwordx4 v9, s[44:47], s14 offen lds
    s_add_u32 s14, s10, 21504
    s_add_u32 m0, s12, 123904
    s_nop 0
    buffer_load_dwordx4 v9, s[44:47], s14 offen lds
    s_add_u32 s14, s10, 24576
    s_add_u32 m0, s12, 131072
    s_nop 0
    buffer_load_dwordx4 v9, s[44:47], s14 offen lds
    s_add_u32 s14, s10, 25600
    s_add_u32 m0, s12, 132096
    s_nop 0
    buffer_load_dwordx4 v9, s[44:47], s14 offen lds
    s_add_u32 s14, s10, 28672
    s_add_u32 m0, s12, 139264
    s_nop 0
    buffer_load_dwordx4 v9, s[44:47], s14 offen lds
    s_add_u32 s14, s10, 29696
    s_add_u32 m0, s12, 140288
    s_nop 0
    buffer_load_dwordx4 v9, s[44:47], s14 offen lds
    s_add_u32 s14, s10, 32768
    s_add_u32 m0, s12, 147456
    s_nop 0
    buffer_load_dwordx4 v9, s[44:47], s14 offen lds
    s_add_u32 s14, s10, 33792
    s_add_u32 m0, s12, 148480
    s_nop 0
    buffer_load_dwordx4 v9, s[44:47], s14 offen lds
k3l1_end:
    s_cmp_ge_u32 s2, 224
    s_cbranch_scc1 k4l1_end
    s_and_b32 s4, s2, 7
    s_lshr_b32 s5, s2, 3
    s_mul_hi_u32 s6, s5, 0x24924925
    s_mul_i32 s7, s6, 7
    s_sub_u32 s5, s5, s7
    s_lshl_b32 s4, s4, 2
    s_add_u32 s4, s4, s6
    s_add_u32 s40, s38, 0x1a00000
    s_addc_u32 s41, s39, 0
    s_and_b32 s41, s41, 0xffff
    s_mov_b32 s42, 0x700000
    s_mov_b32 s43, 0x20000
    s_add_u32 s44, s38, 0x2700000
    s_addc_u32 s45, s39, 0
    s_and_b32 s45, s45, 0xffff
    s_mov_b32 s46, 0x188000
    s_mov_b32 s47, 0x20000
    s_add_u32 s48, s38, 0x400000
    s_addc_u32 s49, s39, 0
    s_and_b32 s49, s49, 0xffff
    s_mov_b32 s50, 0x1c0000
    s_mov_b32 s51, 0x20000
    s_mov_b32 s52, s34
    s_mov_b32 s53, s35
    s_and_b32 s53, s53, 0xffff
    s_mov_b32 s54, 0x1c0000
    s_mov_b32 s55, 0x20000
    s_mov_b32 s56, s32
    s_mov_b32 s57, s33
    s_and_b32 s57, s57, 0xffff
    s_mov_b32 s58, 0x380
    s_mov_b32 s59, 0x20000
    v_lshlrev_b32 v9, 4, v1
    s_and_b32 s6, s3, 1
    s_lshr_b32 s7, s3, 1
    s_lshl_b32 s8, s4, 1
    s_add_u32 s8, s8, s6
    s_mul_i32 s8, s8, 114688
    s_lshl_b32 s9, s7, 11
    s_add_u32 s8, s8, s9
    s_lshl_b32 s10, s5, 1
    s_add_u32 s10, s10, s6
    s_mul_i32 s10, s10, 114688
    s_add_u32 s10, s10, s9
    s_lshl_b32 s12, s6, 12
    s_add_u32 s12, s12, s9
    s_lshl_b32 s13, s4, 1
    s_add_u32 s13, s13, s6
    s_lshl_b32 s15, s5, 1
    s_add_u32 s15, s15, s7
    s_mul_i32 s60, s13, 28672
    s_lshl_b32 s61, s15, 11
    s_add_u32 s60, s60, s61
    v_lshlrev_b32 v12, 3, v4
    s_lshl_b32 s61, s15, 6
    buffer_load_dwordx2 v[40:41], v12, s[56:59], s61 offen offset:0
    buffer_load_dwordx2 v[42:43], v12, s[56:59], s61 offen offset:16
    buffer_load_dwordx2 v[44:45], v12, s[56:59], s61 offen offset:32
    buffer_load_dwordx2 v[46:47], v12, s[56:59], s61 offen offset:48
    s_lshl_b32 s62, s3, 10
    v_add_u32 v13, s62, v9
    s_add_u32 s62, s62, 81920
    v_add_u32 v14, s62, v9
    v_add_u32 v16, 40960, v14
    v_add_u32 v15, 40960, v13
    s_lshr_b32 s62, s4, 1
    s_lshl_b32 s62, s62, 7
    s_add_u32 s62, s62, 14336
    s_cmp_eq_u32 s3, 3
    s_cbranch_scc0 L_pdone_38
    s_mov_b64 exec, 0x3fff
    v_lshlrev_b32 v6, 2, v1
L_poll_37:
    buffer_load_dword v5, v6, s[72:75], s62 offen sc1
    s_waitcnt vmcnt(0)
    v_cmp_ne_u32 vcc, s98, v5
    s_cbranch_vccz L_pdone_38_x
    s_sleep 2
    s_branch L_poll_37
L_pdone_38_x:
    s_mov_b64 exec, -1
L_pdone_38:
    s_barrier
    buffer_load_dwordx4 v[32:35], v9, s[48:51], s60 offen
    buffer_load_dwordx4 v[36:39], v9, s[48:51], s60 offen offset:1024
    s_add_u32 s14, s8, 0
    s_add_u32 m0, s12, 0
    s_nop 0
    buffer_load_dwordx4 v9, s[40:43], s14 offen lds
    s_add_u32 s14, s8, 1024
    s_add_u32 m0, s12, 1024
    s_nop 0
    buffer_load_dwordx4 v9, s[40:43], s14 offen lds
    s_add_u32 s14, s8, 4096
    s_add_u32 m0, s12, 8192
    s_nop 0
    buffer_load_dwordx4 v9, s[40:43], s14 offen lds
    s_add_u32 s14, s8, 5120
    s_add_u32 m0, s12, 9216
    s_nop 0
    buffer_load_dwordx4 v9, s[40:43], s14 offen lds
    s_add_u32 s14, s8, 8192
    s_add_u32 m0, s12, 16384
    s_nop 0
    buffer_load_dwordx4 v9, s[40:43], s14 offen lds
    s_add_u32 s14, s8, 9216
    s_add_u32 m0, s12, 17408
    s_nop 0
    buffer_load_dwordx4 v9, s[40:43], s14 offen lds
    s_add_u32 s14, s8, 12288
    s_add_u32 m0, s12, 24576
    s_nop 0
    buffer_load_dwordx4 v9, s[40:43], s14 offen lds
    s_add_u32 s14, s8, 13312
    s_add_u32 m0, s12, 25600
    s_nop 0
    buffer_load_dwordx4 v9, s[40:43], s14 offen lds
    s_add_u32 s14, s8, 16384
    s_add_u32 m0, s12, 32768
    s_nop 0
    buffer_load_dwordx4 v9, s[40:43], s14 offen lds
    s_add_u32 s14, s8, 17408
    s_add_u32 m0, s12, 33792
    s_nop 0
    buffer_load_dwordx4 v9, s[40:43], s14 offen lds
    s_add_u32 s14, s8, 20480
    s_add_u32 m0, s12, 40960
    s_nop 0
    buffer_load_dwordx4 v9, s[40:43], s14 offen lds
    s_add_u32 s14, s8, 21504
    s_add_u32 m0, s12, 41984
    s_nop 0
    buffer_load_dwordx4 v9, s[40:43], s14 offen lds
    s_add_u32 s14, s8, 24576
    s_add_u32 m0, s12, 49152
    s_nop 0
    buffer_load_dwordx4 v9, s[40:43], s14 offen lds
    s_add_u32 s14, s8, 25600
    s_add_u32 m0, s12, 50176
    s_nop 0
    buffer_load_dwordx4 v9, s[40:43], s14 offen lds
    s_add_u32 s14, s8, 28672
    s_add_u32 m0, s12, 57344
    s_nop 0
    buffer_load_dwordx4 v9, s[40:43], s14 offen lds
    s_add_u32 s14, s8, 29696
    s_add_u32 m0, s12, 58368
    s_nop 0
    buffer_load_dwordx4 v9, s[40:43], s14 offen lds
    s_add_u32 s14, s8, 32768
    s_add_u32 m0, s12, 65536
    s_nop 0
    buffer_load_dwordx4 v9, s[40:43], s14 offen lds
    s_add_u32 s14, s8, 33792
    s_add_u32 m0, s12, 66560
    s_nop 0
    buffer_load_dwordx4 v9, s[40:43], s14 offen lds
    s_waitcnt vmcnt(16)
    s_barrier
    ds_read_b128 v[80:83], v13 offset:0
    ds_read_b128 v[88:91], v14 offset:0
    ds_read_b128 v[84:87], v13 offset:4096
    ds_read_b128 v[92:95], v14 offset:4096
    s_waitcnt vmcnt(14)
    s_barrier
    ds_read_b128 v[96:99], v13 offset:8192
    ds_read_b128 v[104:107], v14 offset:8192
    ds_read_b128 v[100:103], v13 offset:12288
    ds_read_b128 v[108:111], v14 offset:12288
    s_waitcnt lgkmcnt(4)
    v_mfma_f32_32x32x16_bf16 v[128:143], v[88:91], v[80:83], 0
    v_mfma_f32_32x32x16_bf16 v[160:175], v[92:95], v[80:83], 0
    v_mfma_f32_32x32x16_bf16 v[144:159], v[88:91], v[84:87], 0
    v_mfma_f32_32x32x16_bf16 v[176:191], v[92:95], v[84:87], 0
    s_waitcnt vmcnt(12)
    s_barrier
    ds_read_b128 v[80:83], v13 offset:16384
    ds_read_b128 v[88:91], v14 offset:16384
    ds_read_b128 v[84:87], v13 offset:20480
    ds_read_b128 v[92:95], v14 offset:20480
    s_add_u32 s14, s8, 36864
    s_add_u32 m0, s12, 73728
    s_nop 0
    buffer_load_dwordx4 v9, s[40:43], s14 offen lds
    s_add_u32 s14, s8, 37888
    s_add_u32 m0, s12, 74752
    s_nop 0
    buffer_load_dwordx4 v9, s[40:43], s14 offen lds
    s_add_u32 s14, s10, 36864
    s_add_u32 m0, s12, 155648
    s_nop 0
    buffer_load_dwordx4 v9, s[44:47], s14 offen lds
    s_add_u32 s14, s10, 37888
    s_add_u32 m0, s12, 156672
    s_nop 0
    buffer_load_dwordx4 v9, s[44:47], s14 offen lds
    s_waitcnt lgkmcnt(4)
    v_mfma_f32_32x32x16_bf16 v[128:143], v[104:107], v[96:99], v[128:143]
    v_mfma_f32_32x32x16_bf16 v[160:175], v[108:111], v[96:99], v[160:175]
    v_mfma_f32_32x32x16_bf16 v[144:159], v[104:107], v[100:103], v[144:159]
    v_mfma_f32_32x32x16_bf16 v[176:191], v[108:111], v[100:103], v[176:191]
    s_waitcnt vmcnt(14)
    s_barrier
    ds_read_b128 v[96:99], v13 offset:24576
    ds_read_b128 v[104:107], v14 offset:24576
    ds_read_b128 v[100:103], v13 offset:28672
    ds_read_b128 v[108:111], v14 offset:28672
    s_add_u32 s14, s8, 40960
    s_add_u32 m0, s12, 0
    s_nop 0
    buffer_load_dwordx4 v9, s[40:43], s14 offen lds
    s_add_u32 s14, s8, 41984
    s_add_u32 m0, s12, 1024
    s_nop 0
    buffer_load_dwordx4 v9, s[40:43], s14 offen lds
    s_add_u32 s14, s10, 40960
    s_add_u32 m0, s12, 81920
    s_nop 0
    buffer_load_dwordx4 v9, s[44:47], s14 offen lds
    s_add_u32 s14, s10, 41984
    s_add_u32 m0, s12, 82944
    s_nop 0
    buffer_load_dwordx4 v9, s[44:47], s14 offen lds
    s_waitcnt lgkmcnt(4)
    v_mfma_f32_32x32x16_bf16 v[128:143], v[88:91], v[80:83], v[128:143]
    v_mfma_f32_32x32x16_bf16 v[160:175], v[92:95], v[80:83], v[160:175]
    v_mfma_f32_32x32x16_bf16 v[144:159], v[88:91], v[84:87], v[144:159]
    v_mfma_f32_32x32x16_bf16 v[176:191], v[92:95], v[84:87], v[176:191]
    s_waitcnt vmcnt(16)
    s_barrier
    ds_read_b128 v[80:83], v13 offset:32768
    ds_read_b128 v[88:91], v14 offset:32768
    ds_read_b128 v[84:87], v13 offset:36864
    ds_read_b128 v[92:95], v14 offset:36864
    s_add_u32 s14, s8, 45056
    s_add_u32 m0, s12, 8192
    s_nop 0
    buffer_load_dwordx4 v9, s[40:43], s14 offen lds
    s_add_u32 s14, s8, 46080
    s_add_u32 m0, s12, 9216
    s_nop 0
    buffer_load_dwordx4 v9, s[40:43], s14 offen lds
    s_add_u32 s14, s10, 45056
    s_add_u32 m0, s12, 90112
    s_nop 0
    buffer_load_dwordx4 v9, s[44:47], s14 offen lds
    s_add_u32 s14, s10, 46080
    s_add_u32 m0, s12, 91136
    s_nop 0
    buffer_load_dwordx4 v9, s[44:47], s14 offen lds
    s_waitcnt lgkmcnt(4)
    v_mfma_f32_32x32x16_bf16 v[128:143], v[104:107], v[96:99], v[128:143]
    v_mfma_f32_32x32x16_bf16 v[160:175], v[108:111], v[96:99], v[160:175]
    v_mfma_f32_32x32x16_bf16 v[144:159], v[104:107], v[100:103], v[144:159]
    v_mfma_f32_32x32x16_bf16 v[176:191], v[108:111], v[100:103], v[176:191]
    s_waitcnt vmcnt(18)
    s_barrier
    ds_read_b128 v[96:99], v15 offset:0
    ds_read_b128 v[104:107], v16 offset:0
    ds_read_b128 v[100:103], v15 offset:4096
    ds_read_b128 v[108:111], v16 offset:4096
    s_add_u32 s14, s8, 49152
    s_add_u32 m0, s12, 16384
    s_nop 0
    buffer_load_dwordx4 v9, s[40:43], s14 offen lds
    s_add_u32 s14, s8, 50176
    s_add_u32 m0, s12, 17408
    s_nop 0
    buffer_load_dwordx4 v9, s[40:43], s14 offen lds
    s_add_u32 s14, s10, 49152
    s_add_u32 m0, s12, 98304
    s_nop 0
    buffer_load_dwordx4 v9, s[44:47], s14 offen lds
    s_add_u32 s14, s10, 50176
    s_add_u32 m0, s12, 99328
    s_nop 0
    buffer_load_dwordx4 v9, s[44:47], s14 offen lds
    s_waitcnt lgkmcnt(4)
    v_mfma_f32_32x32x16_bf16 v[128:143], v[88:91], v[80:83], v[128:143]
    v_mfma_f32_32x32x16_bf16 v[160:175], v[92:95], v[80:83], v[160:175]
    v_mfma_f32_32x32x16_bf16 v[144:159], v[88:91], v[84:87], v[144:159]
    v_mfma_f32_32x32x16_bf16 v[176:191], v[92:95], v[84:87], v[176:191]
    s_waitcnt vmcnt(20)
    s_barrier
    ds_read_b128 v[80:83], v15 offset:8192
    ds_read_b128 v[88:91], v16 offset:8192
    ds_read_b128 v[84:87], v15 offset:12288
    ds_read_b128 v[92:95], v16 offset:12288
    s_add_u32 s14, s8, 53248
    s_add_u32 m0, s12, 24576
    s_nop 0
    buffer_load_dwordx4 v9, s[40:43], s14 offen lds
    s_add_u32 s14, s8, 54272
    s_add_u32 m0, s12, 25600
    s_nop 0
    buffer_load_dwordx4 v9, s[40:43], s14 offen lds
    s_add_u32 s14, s10, 53248
    s_add_u32 m0, s12, 106496
    s_nop 0
    buffer_load_dwordx4 v9, s[44:47], s14 offen lds
    s_add_u32 s14, s10, 54272
    s_add_u32 m0, s12, 107520
    s_nop 0
    buffer_load_dwordx4 v9, s[44:47], s14 offen lds
    s_waitcnt lgkmcnt(4)
    v_mfma_f32_32x32x16_bf16 v[128:143], v[104:107], v[96:99], v[128:143]
    v_mfma_f32_32x32x16_bf16 v[160:175], v[108:111], v[96:99], v[160:175]
    v_mfma_f32_32x32x16_bf16 v[144:159], v[104:107], v[100:103], v[144:159]
    v_mfma_f32_32x32x16_bf16 v[176:191], v[108:111], v[100:103], v[176:191]
    s_waitcnt vmcnt(22)
    s_barrier
    ds_read_b128 v[96:99], v15 offset:16384
    ds_read_b128 v[104:107], v16 offset:16384
    ds_read_b128 v[100:103], v15 offset:20480
    ds_read_b128 v[108:111], v16 offset:20480
    s_add_u32 s14, s8, 57344
    s_add_u32 m0, s12, 32768
    s_nop 0
    buffer_load_dwordx4 v9, s[40:43], s14 offen lds
    s_add_u32 s14, s8, 58368
    s_add_u32 m0, s12, 33792
    s_nop 0
    buffer_load_dwordx4 v9, s[40:43], s14 offen lds
    s_add_u32 s14, s10, 57344
    s_add_u32 m0, s12, 114688
    s_nop 0
    buffer_load_dwordx4 v9, s[44:47], s14 offen lds
    s_add_u32 s14, s10, 58368
    s_add_u32 m0, s12, 115712
    s_nop 0
    buffer_load_dwordx4 v9, s[44:47], s14 offen lds
    s_waitcnt lgkmcnt(4)
    v_mfma_f32_32x32x16_bf16 v[128:143], v[88:91], v[80:83], v[128:143]
    v_mfma_f32_32x32x16_bf16 v[160:175], v[92:95], v[80:83], v[160:175]
    v_mfma_f32_32x32x16_bf16 v[144:159], v[88:91], v[84:87], v[144:159]
    v_mfma_f32_32x32x16_bf16 v[176:191], v[92:95], v[84:87], v[176:191]
    s_waitcnt vmcnt(24)
    s_barrier
    ds_read_b128 v[80:83], v15 offset:24576
    ds_read_b128 v[88:91], v16 offset:24576
    ds_read_b128 v[84:87], v15 offset:28672
    ds_read_b128 v[92:95], v16 offset:28672
    s_add_u32 s14, s8, 61440
    s_add_u32 m0, s12, 40960
    s_nop 0
    buffer_load_dwordx4 v9, s[40:43], s14 offen lds
    s_add_u32 s14, s8, 62464
    s_add_u32 m0, s12, 41984
    s_nop 0
    buffer_load_dwordx4 v9, s[40:43], s14 offen lds
    s_add_u32 s14, s10, 61440
    s_add_u32 m0, s12, 122880
    s_nop 0
    buffer_load_dwordx4 v9, s[44:47], s14 offen lds
    s_add_u32 s14, s10, 62464
    s_add_u32 m0, s12, 123904
    s_nop 0
    buffer_load_dwordx4 v9, s[44:47], s14 offen lds
    s_waitcnt lgkmcnt(4)
    v_mfma_f32_32x32x16_bf16 v[128:143], v[104:107], v[96:99], v[128:143]
    v_mfma_f32_32x32x16_bf16 v[160:175], v[108:111], v[96:99], v[160:175]
    v_mfma_f32_32x32x16_bf16 v[144:159], v[104:107], v[100:103], v[144:159]
    v_mfma_f32_32x32x16_bf16 v[176:191], v[108:111], v[100:103], v[176:191]
    s_waitcnt vmcnt(24)
    s_barrier
    ds_read_b128 v[96:99], v15 offset:32768
    ds_read_b128 v[104:107], v16 offset:32768
    ds_read_b128 v[100:103], v15 offset:36864
    ds_read_b128 v[108:111], v16 offset:36864
    s_add_u32 s14, s8, 65536
    s_add_u32 m0, s12, 49152
    s_nop 0
    buffer_load_dwordx4 v9, s[40:43], s14 offen lds
    s_add_u32 s14, s8, 66560
    s_add_u32 m0, s12, 50176
    s_nop 0
    buffer_load_dwordx4 v9, s[40:43], s14 offen lds
    s_add_u32 s14, s10, 65536
    s_add_u32 m0, s12, 131072
    s_nop 0
    buffer_load_dwordx4 v9, s[44:47], s14 offen lds
    s_add_u32 s14, s10, 66560
    s_add_u32 m0, s12, 132096
    s_nop 0
    buffer_load_dwordx4 v9, s[44:47], s14 offen lds
    s_waitcnt lgkmcnt(4)
    v_mfma_f32_32x32x16_bf16 v[128:143], v[88:91], v[80:83], v[128:143]
    v_mfma_f32_32x32x16_bf16 v[160:175], v[92:95], v[80:83], v[160:175]
    v_mfma_f32_32x32x16_bf16 v[144:159], v[88:91], v[84:87], v[144:159]
    v_mfma_f32_32x32x16_bf16 v[176:191], v[92:95], v[84:87], v[176:191]
    s_waitcnt vmcnt(24)
    s_barrier
    ds_read_b128 v[80:83], v13 offset:0
    ds_read_b128 v[88:91], v14 offset:0
    ds_read_b128 v[84:87], v13 offset:4096
    ds_read_b128 v[92:95], v14 offset:4096
    s_add_u32 s14, s8, 69632
    s_add_u32 m0, s12, 57344
    s_nop 0
    buffer_load_dwordx4 v9, s[40:43], s14 offen lds
    s_add_u32 s14, s8, 70656
    s_add_u32 m0, s12, 58368
    s_nop 0
    buffer_load_dwordx4 v9, s[40:43], s14 offen lds
    s_add_u32 s14, s10, 69632
    s_add_u32 m0, s12, 139264
    s_nop 0
    buffer_load_dwordx4 v9, s[44:47], s14 offen lds
    s_add_u32 s14, s10, 70656
    s_add_u32 m0, s12, 140288
    s_nop 0
    buffer_load_dwordx4 v9, s[44:47], s14 offen lds
    s_waitcnt lgkmcnt(4)
    v_mfma_f32_32x32x16_bf16 v[128:143], v[104:107], v[96:99], v[128:143]
    v_mfma_f32_32x32x16_bf16 v[160:175], v[108:111], v[96:99], v[160:175]
    v_mfma_f32_32x32x16_bf16 v[144:159], v[104:107], v[100:103], v[144:159]
    v_mfma_f32_32x32x16_bf16 v[176:191], v[108:111], v[100:103], v[176:191]
    s_waitcnt vmcnt(24)
    s_barrier
    ds_read_b128 v[96:99], v13 offset:8192
    ds_read_b128 v[104:107], v14 offset:8192
    ds_read_b128 v[100:103], v13 offset:12288
    ds_read_b128 v[108:111], v14 offset:12288
    s_add_u32 s14, s8, 73728
    s_add_u32 m0, s12, 65536
    s_nop 0
    buffer_load_dwordx4 v9, s[40:43], s14 offen lds
    s_add_u32 s14, s8, 74752
    s_add_u32 m0, s12, 66560
    s_nop 0
    buffer_load_dwordx4 v9, s[40:43], s14 offen lds
    s_add_u32 s14, s10, 73728
    s_add_u32 m0, s12, 147456
    s_nop 0
    buffer_load_dwordx4 v9, s[44:47], s14 offen lds
    s_add_u32 s14, s10, 74752
    s_add_u32 m0, s12, 148480
    s_nop 0
    buffer_load_dwordx4 v9, s[44:47], s14 offen lds
    s_waitcnt lgkmcnt(4)
    v_mfma_f32_32x32x16_bf16 v[128:143], v[88:91], v[80:83], v[128:143]
    v_mfma_f32_32x32x16_bf16 v[160:175], v[92:95], v[80:83], v[160:175]
    v_mfma_f32_32x32x16_bf16 v[144:159], v[88:91], v[84:87], v[144:159]
    v_mfma_f32_32x32x16_bf16 v[176:191], v[92:95], v[84:87], v[176:191]
    s_waitcnt vmcnt(24)
    s_barrier
    ds_read_b128 v[80:83], v13 offset:16384
    ds_read_b128 v[88:91], v14 offset:16384
    ds_read_b128 v[84:87], v13 offset:20480
    ds_read_b128 v[92:95], v14 offset:20480
    s_add_u32 s14, s8, 77824
    s_add_u32 m0, s12, 73728
    s_nop 0
    buffer_load_dwordx4 v9, s[40:43], s14 offen lds
    s_add_u32 s14, s8, 78848
    s_add_u32 m0, s12, 74752
    s_nop 0
    buffer_load_dwordx4 v9, s[40:43], s14 offen lds
    s_add_u32 s14, s10, 77824
    s_add_u32 m0, s12, 155648
    s_nop 0
    buffer_load_dwordx4 v9, s[44:47], s14 offen lds
    s_add_u32 s14, s10, 78848
    s_add_u32 m0, s12, 156672
    s_nop 0
    buffer_load_dwordx4 v9, s[44:47], s14 offen lds
    s_waitcnt lgkmcnt(4)
    v_mfma_f32_32x32x16_bf16 v[128:143], v[104:107], v[96:99], v[128:143]
    v_mfma_f32_32x32x16_bf16 v[160:175], v[108:111], v[96:99], v[160:175]
    v_mfma_f32_32x32x16_bf16 v[144:159], v[104:107], v[100:103], v[144:159]
    v_mfma_f32_32x32x16_bf16 v[176:191], v[108:111], v[100:103], v[176:191]
    s_waitcnt vmcnt(24)
    s_barrier
    ds_read_b128 v[96:99], v13 offset:24576
    ds_read_b128 v[104:107], v14 offset:24576
    ds_read_b128 v[100:103], v13 offset:28672
    ds_read_b128 v[108:111], v14 offset:28672
    s_add_u32 s14, s8, 81920
    s_add_u32 m0, s12, 0
    s_nop 0
    buffer_load_dwordx4 v9, s[40:43], s14 offen lds
    s_add_u32 s14, s8, 82944
    s_add_u32 m0, s12, 1024
    s_nop 0
    buffer_load_dwordx4 v9, s[40:43], s14 offen lds
    s_add_u32 s14, s10, 81920
    s_add_u32 m0, s12, 81920
    s_nop 0
    buffer_load_dwordx4 v9, s[44:47], s14 offen lds
    s_add_u32 s14, s10, 82944
    s_add_u32 m0, s12, 82944
    s_nop 0
    buffer_load_dwordx4 v9, s[44:47], s14 offen lds
    s_waitcnt lgkmcnt(4)
    v_mfma_f32_32x32x16_bf16 v[128:143], v[88:91], v[80:83], v[128:143]
    v_mfma_f32_32x32x16_bf16 v[160:175], v[92:95], v[80:83], v[160:175]
    v_mfma_f32_32x32x16_bf16 v[144:159], v[88:91], v[84:87], v[144:159]
    v_mfma_f32_32x32x16_bf16 v[176:191], v[92:95], v[84:87], v[176:191]
    s_waitcnt vmcnt(24)
    s_barrier
    ds_read_b128 v[80:83], v13 offset:32768
    ds_read_b128 v[88:91], v14 offset:32768
    ds_read_b128 v[84:87], v13 offset:36864
    ds_read_b128 v[92:95], v14 offset:36864
    s_add_u32 s14, s8, 86016
    s_add_u32 m0, s12, 8192
    s_nop 0
    buffer_load_dwordx4 v9, s[40:43], s14 offen lds
    s_add_u32 s14, s8, 87040
    s_add_u32 m0, s12, 9216
    s_nop 0
    buffer_load_dwordx4 v9, s[40:43], s14 offen lds
    s_add_u32 s14, s10, 86016
    s_add_u32 m0, s12, 90112
    s_nop 0
    buffer_load_dwordx4 v9, s[44:47], s14 offen lds
    s_add_u32 s14, s10, 87040
    s_add_u32 m0, s12, 91136
    s_nop 0
    buffer_load_dwordx4 v9, s[44:47], s14 offen lds
    s_waitcnt lgkmcnt(4)
    v_mfma_f32_32x32x16_bf16 v[128:143], v[104:107], v[96:99], v[128:143]
    v_mfma_f32_32x32x16_bf16 v[160:175], v[108:111], v[96:99], v[160:175]
    v_mfma_f32_32x32x16_bf16 v[144:159], v[104:107], v[100:103], v[144:159]
    v_mfma_f32_32x32x16_bf16 v[176:191], v[108:111], v[100:103], v[176:191]
    s_waitcnt vmcnt(24)
    s_barrier
    ds_read_b128 v[96:99], v15 offset:0
    ds_read_b128 v[104:107], v16 offset:0
    ds_read_b128 v[100:103], v15 offset:4096
    ds_read_b128 v[108:111], v16 offset:4096
    s_add_u32 s14, s8, 90112
    s_add_u32 m0, s12, 16384
    s_nop 0
    buffer_load_dwordx4 v9, s[40:43], s14 offen lds
    s_add_u32 s14, s8, 91136
    s_add_u32 m0, s12, 17408
    s_nop 0
    buffer_load_dwordx4 v9, s[40:43], s14 offen lds
    s_add_u32 s14, s10, 90112
    s_add_u32 m0, s12, 98304
    s_nop 0
    buffer_load_dwordx4 v9, s[44:47], s14 offen lds
    s_add_u32 s14, s10, 91136
    s_add_u32 m0, s12, 99328
    s_nop 0
    buffer_load_dwordx4 v9, s[44:47], s14 offen lds
    s_waitcnt lgkmcnt(4)
    v_mfma_f32_32x32x16_bf16 v[128:143], v[88:91], v[80:83], v[128:143]
    v_mfma_f32_32x32x16_bf16 v[160:175], v[92:95], v[80:83], v[160:175]
    v_mfma_f32_32x32x16_bf16 v[144:159], v[88:91], v[84:87], v[144:159]
    v_mfma_f32_32x32x16_bf16 v[176:191], v[92:95], v[84:87], v[176:191]
    s_waitcnt vmcnt(24)
    s_barrier
    ds_read_b128 v[80:83], v15 offset:8192
    ds_read_b128 v[88:91], v16 offset:8192
    ds_read_b128 v[84:87], v15 offset:12288
    ds_read_b128 v[92:95], v16 offset:12288
    s_add_u32 s14, s8, 94208
    s_add_u32 m0, s12, 24576
    s_nop 0
    buffer_load_dwordx4 v9, s[40:43], s14 offen lds
    s_add_u32 s14, s8, 95232
    s_add_u32 m0, s12, 25600
    s_nop 0
    buffer_load_dwordx4 v9, s[40:43], s14 offen lds
    s_add_u32 s14, s10, 94208
    s_add_u32 m0, s12, 106496
    s_nop 0
    buffer_load_dwordx4 v9, s[44:47], s14 offen lds
    s_add_u32 s14, s10, 95232
    s_add_u32 m0, s12, 107520
    s_nop 0
    buffer_load_dwordx4 v9, s[44:47], s14 offen lds
    s_waitcnt lgkmcnt(4)
    v_mfma_f32_32x32x16_bf16 v[128:143], v[104:107], v[96:99], v[128:143]
    v_mfma_f32_32x32x16_bf16 v[160:175], v[108:111], v[96:99], v[160:175]
    v_mfma_f32_32x32x16_bf16 v[144:159], v[104:107], v[100:103], v[144:159]
    v_mfma_f32_32x32x16_bf16 v[176:191], v[108:111], v[100:103], v[176:191]
    s_waitcnt vmcnt(24)
    s_barrier
    ds_read_b128 v[96:99], v15 offset:16384
    ds_read_b128 v[104:107], v16 offset:16384
    ds_read_b128 v[100:103], v15 offset:20480
    ds_read_b128 v[108:111], v16 offset:20480
    s_add_u32 s14, s8, 98304
    s_add_u32 m0, s12, 32768
    s_nop 0
    buffer_load_dwordx4 v9, s[40:43], s14 offen lds
    s_add_u32 s14, s8, 99328
    s_add_u32 m0, s12, 33792
    s_nop 0
    buffer_load_dwordx4 v9, s[40:43], s14 offen lds
    s_add_u32 s14, s10, 98304
    s_add_u32 m0, s12, 114688
    s_nop 0
    buffer_load_dwordx4 v9, s[44:47], s14 offen lds
    s_add_u32 s14, s10, 99328
    s_add_u32 m0, s12, 115712
    s_nop 0
    buffer_load_dwordx4 v9, s[44:47], s14 offen lds
    s_waitcnt lgkmcnt(4)
    v_mfma_f32_32x32x16_bf16 v[128:143], v[88:91], v[80:83], v[128:143]
    v_mfma_f32_32x32x16_bf16 v[160:175], v[92:95], v[80:83], v[160:175]
    v_mfma_f32_32x32x16_bf16 v[144:159], v[88:91], v[84:87], v[144:159]
    v_mfma_f32_32x32x16_bf16 v[176:191], v[92:95], v[84:87], v[176:191]
    s_waitcnt vmcnt(24)
    s_barrier
    ds_read_b128 v[80:83], v15 offset:24576
    ds_read_b128 v[88:91], v16 offset:24576
    ds_read_b128 v[84:87], v15 offset:28672
    ds_read_b128 v[92:95], v16 offset:28672
    s_add_u32 s14, s8, 102400
    s_add_u32 m0, s12, 40960
    s_nop 0
    buffer_load_dwordx4 v9, s[40:43], s14 offen lds
    s_add_u32 s14, s8, 103424
    s_add_u32 m0, s12, 41984
    s_nop 0
    buffer_load_dwordx4 v9, s[40:43], s14 offen lds
    s_add_u32 s14, s10, 102400
    s_add_u32 m0, s12, 122880
    s_nop 0
    buffer_load_dwordx4 v9, s[44:47], s14 offen lds
    s_add_u32 s14, s10, 103424
    s_add_u32 m0, s12, 123904
    s_nop 0
    buffer_load_dwordx4 v9, s[44:47], s14 offen lds
    s_waitcnt lgkmcnt(4)
    v_mfma_f32_32x32x16_bf16 v[128:143], v[104:107], v[96:99], v[128:143]
    v_mfma_f32_32x32x16_bf16 v[160:175], v[108:111], v[96:99], v[160:175]
    v_mfma_f32_32x32x16_bf16 v[144:159], v[104:107], v[100:103], v[144:159]
    v_mfma_f32_32x32x16_bf16 v[176:191], v[108:111], v[100:103], v[176:191]
    s_waitcnt vmcnt(24)
    s_barrier
    ds_read_b128 v[96:99], v15 offset:32768
    ds_read_b128 v[104:107], v16 offset:32768
    ds_read_b128 v[100:103], v15 offset:36864
    ds_read_b128 v[108:111], v16 offset:36864
    s_add_u32 s14, s8, 106496
    s_add_u32 m0, s12, 49152
    s_nop 0
    buffer_load_dwordx4 v9, s[40:43], s14 offen lds
    s_add_u32 s14, s8, 107520
    s_add_u32 m0, s12, 50176
    s_nop 0
    buffer_load_dwordx4 v9, s[40:43], s14 offen lds
    s_add_u32 s14, s10, 106496
    s_add_u32 m0, s12, 131072
    s_nop 0
    buffer_load_dwordx4 v9, s[44:47], s14 offen lds
    s_add_u32 s14, s10, 107520
    s_add_u32 m0, s12, 132096
    s_nop 0
    buffer_load_dwordx4 v9, s[44:47], s14 offen lds
    s_waitcnt lgkmcnt(4)
    v_mfma_f32_32x32x16_bf16 v[128:143], v[88:91], v[80:83], v[128:143]
    v_mfma_f32_32x32x16_bf16 v[160:175], v[92:95], v[80:83], v[160:175]
    v_mfma_f32_32x32x16_bf16 v[144:159], v[88:91], v[84:87], v[144:159]
    v_mfma_f32_32x32x16_bf16 v[176:191], v[92:95], v[84:87], v[176:191]
    s_waitcnt vmcnt(24)
    s_barrier
    ds_read_b128 v[80:83], v13 offset:0
    ds_read_b128 v[88:91], v14 offset:0
    ds_read_b128 v[84:87], v13 offset:4096
    ds_read_b128 v[92:95], v14 offset:4096
    s_add_u32 s14, s8, 110592
    s_add_u32 m0, s12, 57344
    s_nop 0
    buffer_load_dwordx4 v9, s[40:43], s14 offen lds
    s_add_u32 s14, s8, 111616
    s_add_u32 m0, s12, 58368
    s_nop 0
    buffer_load_dwordx4 v9, s[40:43], s14 offen lds
    s_add_u32 s14, s10, 110592
    s_add_u32 m0, s12, 139264
    s_nop 0
    buffer_load_dwordx4 v9, s[44:47], s14 offen lds
    s_add_u32 s14, s10, 111616
    s_add_u32 m0, s12, 140288
    s_nop 0
    buffer_load_dwordx4 v9, s[44:47], s14 offen lds
    s_waitcnt lgkmcnt(4)
    v_mfma_f32_32x32x16_bf16 v[128:143], v[104:107], v[96:99], v[128:143]
    v_mfma_f32_32x32x16_bf16 v[160:175], v[108:111], v[96:99], v[160:175]
    v_mfma_f32_32x32x16_bf16 v[144:159], v[104:107], v[100:103], v[144:159]
    v_mfma_f32_32x32x16_bf16 v[176:191], v[108:111], v[100:103], v[176:191]
    s_waitcnt vmcnt(24)
    s_barrier
    ds_read_b128 v[96:99], v13 offset:8192
    ds_read_b128 v[104:107], v14 offset:8192
    ds_read_b128 v[100:103], v13 offset:12288
    ds_read_b128 v[108:111], v14 offset:12288
    s_waitcnt lgkmcnt(4)
    v_mfma_f32_32x32x16_bf16 v[128:143], v[88:91], v[80:83], v[128:143]
    v_mfma_f32_32x32x16_bf16 v[160:175], v[92:95], v[80:83], v[160:175]
    v_mfma_f32_32x32x16_bf16 v[144:159], v[88:91], v[84:87], v[144:159]
    v_mfma_f32_32x32x16_bf16 v[176:191], v[92:95], v[84:87], v[176:191]
    s_waitcnt vmcnt(20)
    s_barrier
    ds_read_b128 v[80:83], v13 offset:16384
    ds_read_b128 v[88:91], v14 offset:16384
    ds_read_b128 v[84:87], v13 offset:20480
    ds_read_b128 v[92:95], v14 offset:20480
    s_waitcnt lgkmcnt(4)
    v_mfma_f32_32x32x16_bf16 v[128:143], v[104:107], v[96:99], v[128:143]
    v_mfma_f32_32x32x16_bf16 v[160:175], v[108:111], v[96:99], v[160:175]
    v_mfma_f32_32x32x16_bf16 v[144:159], v[104:107], v[100:103], v[144:159]
    v_mfma_f32_32x32x16_bf16 v[176:191], v[108:111], v[100:103], v[176:191]
    s_waitcnt vmcnt(16)
    s_barrier
    ds_read_b128 v[96:99], v13 offset:24576
    ds_read_b128 v[104:107], v14 offset:24576
    ds_read_b128 v[100:103], v13 offset:28672
    ds_read_b128 v[108:111], v14 offset:28672
    s_waitcnt lgkmcnt(4)
    v_mfma_f32_32x32x16_bf16 v[128:143], v[88:91], v[80:83], v[128:143]
    v_mfma_f32_32x32x16_bf16 v[160:175], v[92:95], v[80:83], v[160:175]
    v_mfma_f32_32x32x16_bf16 v[144:159], v[88:91], v[84:87], v[144:159]
    v_mfma_f32_32x32x16_bf16 v[176:191], v[92:95], v[84:87], v[176:191]
    s_waitcnt vmcnt(12)
    s_barrier
    ds_read_b128 v[80:83], v13 offset:32768
    ds_read_b128 v[88:91], v14 offset:32768
    ds_read_b128 v[84:87], v13 offset:36864
    ds_read_b128 v[92:95], v14 offset:36864
    s_waitcnt lgkmcnt(4)
    v_mfma_f32_32x32x16_bf16 v[128:143], v[104:107], v[96:99], v[128:143]
    v_mfma_f32_32x32x16_bf16 v[160:175], v[108:111], v[96:99], v[160:175]
    v_mfma_f32_32x32x16_bf16 v[144:159], v[104:107], v[100:103], v[144:159]
    v_mfma_f32_32x32x16_bf16 v[176:191], v[108:111], v[100:103], v[176:191]
    s_waitcnt vmcnt(8)
    s_barrier
    ds_read_b128 v[96:99], v15 offset:0
    ds_read_b128 v[104:107], v16 offset:0
    ds_read_b128 v[100:103], v15 offset:4096
    ds_read_b128 v[108:111], v16 offset:4096
    s_waitcnt lgkmcnt(4)
    v_mfma_f32_32x32x16_bf16 v[128:143], v[88:91], v[80:83], v[128:143]
    v_mfma_f32_32x32x16_bf16 v[160:175], v[92:95], v[80:83], v[160:175]
    v_mfma_f32_32x32x16_bf16 v[144:159], v[88:91], v[84:87], v[144:159]
    v_mfma_f32_32x32x16_bf16 v[176:191], v[92:95], v[84:87], v[176:191]
    s_waitcnt vmcnt(4)
    s_barrier
    ds_read_b128 v[80:83], v15 offset:8192
    ds_read_b128 v[88:91], v16 offset:8192
    ds_read_b128 v[84:87], v15 offset:12288
    ds_read_b128 v[92:95], v16 offset:12288
    s_waitcnt lgkmcnt(4)
    v_mfma_f32_32x32x16_bf16 v[128:143], v[104:107], v[96:99], v[128:143]
    v_mfma_f32_32x32x16_bf16 v[160:175], v[108:111], v[96:99], v[160:175]
    v_mfma_f32_32x32x16_bf16 v[144:159], v[104:107], v[100:103], v[144:159]
    v_mfma_f32_32x32x16_bf16 v[176:191], v[108:111], v[100:103], v[176:191]
    s_waitcnt vmcnt(0)
    s_barrier
    ds_read_b128 v[96:99], v15 offset:16384
    ds_read_b128 v[104:107], v16 offset:16384
    ds_read_b128 v[100:103], v15 offset:20480
    ds_read_b128 v[108:111], v16 offset:20480
    s_waitcnt lgkmcnt(4)
    v_mfma_f32_32x32x16_bf16 v[128:143], v[88:91], v[80:83], v[128:143]
    v_mfma_f32_32x32x16_bf16 v[160:175], v[92:95], v[80:83], v[160:175]
    v_mfma_f32_32x32x16_bf16 v[144:159], v[88:91], v[84:87], v[144:159]
    v_mfma_f32_32x32x16_bf16 v[176:191], v[92:95], v[84:87], v[176:191]
    s_waitcnt lgkmcnt(0)
    v_mfma_f32_32x32x16_bf16 v[128:143], v[104:107], v[96:99], v[128:143]
    v_mfma_f32_32x32x16_bf16 v[160:175], v[108:111], v[96:99], v[160:175]
    v_mfma_f32_32x32x16_bf16 v[144:159], v[104:107], v[100:103], v[144:159]
    v_mfma_f32_32x32x16_bf16 v[176:191], v[108:111], v[100:103], v[176:191]
    s_barrier
    s_nop 13
    s_lshl_b32 s62, s3, 12
    v_add_u32 v17, s62, v9
    ds_write_b128 v17, v[128:131] offset:0
    ds_write_b128 v17, v[132:135] offset:1024
    ds_write_b128 v17, v[136:139] offset:2048
    ds_write_b128 v17, v[140:143] offset:3072
    ds_write_b128 v17, v[144:147] offset:16384
    ds_write_b128 v17, v[148:151] offset:17408
    ds_write_b128 v17, v[152:155] offset:18432
    ds_write_b128 v17, v[156:159] offset:19456
    ds_write_b128 v17, v[160:163] offset:32768
    ds_write_b128 v17, v[164:167] offset:33792
    ds_write_b128 v17, v[168:171] offset:34816
    ds_write_b128 v17, v[172:175] offset:35840
    ds_write_b128 v17, v[176:179] offset:49152
    ds_write_b128 v17, v[180:183] offset:50176
    ds_write_b128 v17, v[184:187] offset:51200
    ds_write_b128 v17, v[188:191] offset:52224
    s_lshl_b32 s62, s3, 14
    v_add_u32 v17, s62, v9
    s_waitcnt lgkmcnt(0)
    s_barrier
    ds_read_b128 v[128:131], v17 offset:0
    ds_read_b128 v[132:135], v17 offset:1024
    ds_read_b128 v[136:139], v17 offset:2048
    ds_read_b128 v[140:143], v17 offset:3072
    ds_read_b128 v[144:147], v17 offset:4096
    ds_read_b128 v[148:151], v17 offset:5120
    ds_read_b128 v[152:155], v17 offset:6144
    ds_read_b128 v[156:159], v17 offset:7168
    ds_read_b128 v[160:163], v17 offset:8192
    ds_read_b128 v[164:167], v17 offset:9216
    ds_read_b128 v[168:171], v17 offset:10240
    ds_read_b128 v[172:175], v17 offset:11264
    ds_read_b128 v[176:179], v17 offset:12288
    ds_read_b128 v[180:183], v17 offset:13312
    ds_read_b128 v[184:187], v17 offset:14336
    ds_read_b128 v[188:191], v17 offset:15360
    s_waitcnt lgkmcnt(0)
    v_add_f32 v128, v128, v144
    v_add_f32 v160, v160, v176
    v_add_f32 v64, v128, v160
    v_add_f32 v129, v129, v145
    v_add_f32 v161, v161, v177
    v_add_f32 v65, v129, v161
    v_add_f32 v130, v130, v146
    v_add_f32 v162, v162, v178
    v_add_f32 v66, v130, v162
    v_add_f32 v131, v131, v147
    v_add_f32 v163, v163, v179
    v_add_f32 v67, v131, v163
    v_add_f32 v132, v132, v148
    v_add_f32 v164, v164, v180
    v_add_f32 v68, v132, v164
    v_add_f32 v133, v133, v149
    v_add_f32 v165, v165, v181
    v_add_f32 v69, v133, v165
    v_add_f32 v134, v134, v150
    v_add_f32 v166, v166, v182
    v_add_f32 v70, v134, v166
    v_add_f32 v135, v135, v151
    v_add_f32 v167, v167, v183
    v_add_f32 v71, v135, v167
    v_add_f32 v136, v136, v152
    v_add_f32 v168, v168, v184
    v_add_f32 v72, v136, v168
    v_add_f32 v137, v137, v153
    v_add_f32 v169, v169, v185
    v_add_f32 v73, v137, v169
    v_add_f32 v138, v138, v154
    v_add_f32 v170, v170, v186
    v_add_f32 v74, v138, v170
    v_add_f32 v139, v139, v155
    v_add_f32 v171, v171, v187
    v_add_f32 v75, v139, v171
    v_add_f32 v140, v140, v156
    v_add_f32 v172, v172, v188
    v_add_f32 v76, v140, v172
    v_add_f32 v141, v141, v157
    v_add_f32 v173, v173, v189
    v_add_f32 v77, v141, v173
    v_add_f32 v142, v142, v158
    v_add_f32 v174, v174, v190
    v_add_f32 v78, v142, v174
    v_add_f32 v143, v143, v159
    v_add_f32 v175, v175, v191
    v_add_f32 v79, v143, v175
    s_barrier
    v_permlane32_swap_b32 v32, v34
    v_permlane32_swap_b32 v33, v35
    v_permlane32_swap_b32 v36, v38
    v_permlane32_swap_b32 v37, v39
    s_nop 11
    v_lshlrev_b32 v20, 16, v32
    v_and_b32 v21, 0xffff0000, v32
    v_lshlrev_b32 v22, 16, v40
    v_and_b32 v23, 0xffff0000, v40
    v_add_f32 v64, v64, v22
    v_add_f32 v65, v65, v23
    v_add_f32 v64, v64, v20
    v_add_f32 v65, v65, v21
    v_cvt_pk_bf16_f32 v32, v64, v65
    v_lshlrev_b32 v20, 16, v33
    v_and_b32 v21, 0xffff0000, v33
    v_lshlrev_b32 v22, 16, v41
    v_and_b32 v23, 0xffff0000, v41
    v_add_f32 v66, v66, v22
    v_add_f32 v67, v67, v23
    v_add_f32 v66, v66, v20
    v_add_f32 v67, v67, v21
    v_cvt_pk_bf16_f32 v33, v66, v67
    v_lshlrev_b32 v20, 16, v34
    v_and_b32 v21, 0xffff0000, v34
    v_lshlrev_b32 v22, 16, v42
    v_and_b32 v23, 0xffff0000, v42
    v_add_f32 v68, v68, v22
    v_add_f32 v69, v69, v23
    v_add_f32 v68, v68, v20
    v_add_f32 v69, v69, v21
    v_cvt_pk_bf16_f32 v34, v68, v69
    v_lshlrev_b32 v20, 16, v35
    v_and_b32 v21, 0xffff0000, v35
    v_lshlrev_b32 v22, 16, v43
    v_and_b32 v23, 0xffff0000, v43
    v_add_f32 v70, v70, v22
    v_add_f32 v71, v71, v23
    v_add_f32 v70, v70, v20
    v_add_f32 v71, v71, v21
    v_cvt_pk_bf16_f32 v35, v70, v71
    v_lshlrev_b32 v20, 16, v36
    v_and_b32 v21, 0xffff0000, v36
    v_lshlrev_b32 v22, 16, v44
    v_and_b32 v23, 0xffff0000, v44
    v_add_f32 v72, v72, v22
    v_add_f32 v73, v73, v23
    v_add_f32 v72, v72, v20
    v_add_f32 v73, v73, v21
    v_cvt_pk_bf16_f32 v36, v72, v73
    v_lshlrev_b32 v20, 16, v37
    v_and_b32 v21, 0xffff0000, v37
    v_lshlrev_b32 v22, 16, v45
    v_and_b32 v23, 0xffff0000, v45
    v_add_f32 v74, v74, v22
    v_add_f32 v75, v75, v23
    v_add_f32 v74, v74, v20
    v_add_f32 v75, v75, v21
    v_cvt_pk_bf16_f32 v37, v74, v75
    v_lshlrev_b32 v20, 16, v38
    v_and_b32 v21, 0xffff0000, v38
    v_lshlrev_b32 v22, 16, v46
    v_and_b32 v23, 0xffff0000, v46
    v_add_f32 v76, v76, v22
    v_add_f32 v77, v77, v23
    v_add_f32 v76, v76, v20
    v_add_f32 v77, v77, v21
    v_cvt_pk_bf16_f32 v38, v76, v77
    v_lshlrev_b32 v20, 16, v39
    v_and_b32 v21, 0xffff0000, v39
    v_lshlrev_b32 v22, 16, v47
    v_and_b32 v23, 0xffff0000, v47
    v_add_f32 v78, v78, v22
    v_add_f32 v79, v79, v23
    v_add_f32 v78, v78, v20
    v_add_f32 v79, v79, v21
    v_cvt_pk_bf16_f32 v39, v78, v79
    s_nop 0
    v_permlane32_swap_b32 v32, v34
    v_permlane32_swap_b32 v33, v35
    v_permlane32_swap_b32 v36, v38
    v_permlane32_swap_b32 v37, v39
    s_lshl_b32 s62, s13, 5
    v_add_u32 v17, s62, v3
    v_mul_u32_u24 v17, 896, v17
    v_lshl_add_u32 v17, v4, 4, v17
    buffer_store_dwordx4 v[32:35], v17, s[52:55], s61 offen offset:0
    buffer_store_dwordx4 v[36:39], v17, s[52:55], s61 offen offset:32
k4l1_end:
fused_kernel_end:
    s_endpgm
.section .rodata,"a"
.p2align 6
.amdhsa_kernel fused_kernel
  .amdhsa_next_free_vgpr 256
  .amdhsa_next_free_sgpr 100
  .amdhsa_accum_offset 256
  .amdhsa_group_segment_fixed_size 0
  .amdhsa_kernarg_size 96
  .amdhsa_user_sgpr_count 2
  .amdhsa_user_sgpr_kernarg_segment_ptr 1
  .amdhsa_system_sgpr_workgroup_id_x 1
.end_amdhsa_kernel
```
